```python
import torch

def _softmax(x, axis=-1):
    return torch.softmax(x, dim=axis)

def _gelu(x):
    return torch.nn.functional.gelu(x, approximate='tanh')

def _silu(x):
    return torch.nn.functional.silu(x)

def _sigmoid(x):
    return torch.sigmoid(x)

def _layernorm(x, axis=-1, eps=1e-05):
    m = x.mean(dim=axis, keepdim=True)
    v = x.var(dim=axis, keepdim=True, unbiased=False)
    return (x - m) / torch.sqrt(v + eps)

def _scatter_add(tgt, idx, src, axis=0):
    return tgt.clone().index_add_(axis, idx, src)

def _segment_sum(src, seg, n):
    out = torch.zeros((n,) + src.shape[1:], dtype=src.dtype)
    return out.index_add_(0, seg, src)

def _pad(x, pw):
    flat = tuple((v for pair in reversed(pw) for v in pair))
    return torch.nn.functional.pad(x, flat)
kernel_name = 'gated_mix__sliding_block__mixer_gmlp__prompt'

def setup_inputs():

    _w = lambda a: (lambda t: t.to(torch.bfloat16) if t.is_floating_point() else t)(torch.as_tensor(a))

    def _A_setup():
        B, S, D = (1, 2048, 512)
        return {'x': _w((lambda *s: torch.randn(*s, dtype=torch.bfloat16) * 0.05)(B, S, D)), 'wqkv': _w((lambda *s: torch.randn(*s, dtype=torch.bfloat16) * 1.6)(D, 3 * D)), 'wo': _w((lambda *s: torch.randn(*s, dtype=torch.bfloat16) * 0.05)(D, D))}
    _A_in = _A_setup()

    def _B_setup():
        B, S, D, F = (1, 2048, 512, 1792)
        Fh = F // 2
        return {'x': _w((lambda *s: torch.randn(*s, dtype=torch.bfloat16) * 0.05)(B, S, D)), 'w_in': _w((lambda *s: torch.randn(*s, dtype=torch.bfloat16) * 0.8)(D, 2 * Fh)), 'w_sp': _w(0.01 * (lambda *s: torch.randn(*s, dtype=torch.bfloat16) * 0.8)(S, S)), 'b_sp': _w(1.0 + 0.01 * (lambda *s: torch.randn(*s, dtype=torch.bfloat16) * 0.1)(S)), 'w_out': _w((lambda *s: torch.randn(*s, dtype=torch.bfloat16) * 0.1)(Fh, D))}
    _B_in = _B_setup()
    return {'A_x': _A_in['x'], 'A_wqkv': _A_in['wqkv'], 'A_wo': _A_in['wo'], 'B_x': _B_in['x'], 'B_w_in': _B_in['w_in'], 'B_w_sp': _B_in['w_sp'], 'B_b_sp': _B_in['b_sp'], 'B_w_out': _B_in['w_out'], 'gate_w': _w((lambda *s: torch.randn(*s, dtype=torch.bfloat16) * 0.05)(512) * 16.0)}

def reference(A_x, A_wqkv, A_wo, B_x, B_w_in, B_w_sp, B_b_sp, B_w_out, gate_w):

    def _A_ref(x, wqkv, wo):
        B, S, D = x.shape
        H = 32
        Dh = D // H
        W = 256
        qkv = (lambda x, *d: x.permute(*d))((x @ wqkv).reshape(B, S, 3, H, Dh), 2, 0, 3, 1, 4)
        q, k, v = (qkv[0], qkv[1], qkv[2])
        scores = torch.einsum('bhqd,bhkd->bhqk', q, k) * Dh ** (-0.5)
        idx = torch.arange(S)
        mask = (idx[:, None] - idx[None, :] >= 0) & (idx[:, None] - idx[None, :] < W)
        scores = torch.where(mask[None, None], scores, -1000000000.0)
        p = _softmax(scores, axis=-1)
        o = torch.einsum('bhqk,bhkd->bhqd', p, v)
        return (lambda x, *d: x.permute(*d))(o, 0, 2, 1, 3).reshape(B, S, D) @ wo

    def _B_ref(x, w_in, w_sp, b_sp, w_out):
        B, S, D = x.shape
        F = w_in.shape[-1]
        Fh = F // 2
        z = _gelu(torch.einsum('bsd,df->bsf', x, w_in))
        z1 = z[..., :Fh].clone()
        z2 = _layernorm(z[..., Fh:], axis=-1)
        g = torch.einsum('ts,bsf->btf', w_sp, z2) + b_sp[None, :, None]
        return torch.einsum('bsf,fd->bsd', z1 * g, w_out)
    x = A_x
    g = _sigmoid((x * gate_w).sum(-1, keepdims=True))
    a = _A_ref(x, A_wqkv, A_wo)
    b = _B_ref(x, B_w_in, B_w_sp, B_b_sp, B_w_out)
    return g * a + (1 - g) * b
```

```asm
; @launch grid=(256,1,1) block=(512,1,1) lds=163840
.amdgcn_target "amdgcn-amd-amdhsa--gfx950"
.text
.globl gated_mix__sliding_block__mixer_gmlp__prompt_kernel
.p2align 8
.type gated_mix__sliding_block__mixer_gmlp__prompt_kernel,@function
gated_mix__sliding_block__mixer_gmlp__prompt_kernel:
  s_cmp_ge_u32 s2, 256
  s_cbranch_scc1 L_exit
  s_load_dwordx16 s[16:31], s[0:1], 0
  s_load_dwordx8 s[32:39], s[0:1], 64
  v_lshrrev_b32 v1, 6, v0
  v_and_b32 v0, 63, v0
  v_readfirstlane_b32 s3, v1
  s_and_b32 s4, s2, 7
  s_lshr_b32 s5, s2, 3
  s_lshr_b32 s6, s4, 1
  s_and_b32 s7, s4, 1
  s_lshr_b32 s8, s5, 2
  s_lshl_b32 s9, s6, 3
  s_add_u32 s8, s8, s9
  s_and_b32 s9, s5, 3
  s_lshl_b32 s10, s7, 2
  s_add_u32 s9, s9, s10
  s_and_b32 s10, s5, 15
  s_lshl_b32 s11, s7, 4
  s_add_u32 s10, s10, s11
  s_lshr_b32 s11, s5, 4
  s_lshl_b32 s12, s6, 1
  s_add_u32 s11, s11, s12
  s_cmp_eq_u32 s9, 7
  s_cselect_b32 s13, 0, -1
  s_sub_u32 s4, s3, 4
  s_lshl_b32 s5, s4, 11
  s_lshl_b32 s69, s8, 16
  s_lshl_b32 s71, s9, 8
  s_add_u32 s70, s71, 1792
  s_lshl_b32 s72, s9, 7
  s_and_b32 s73, s8, 7
  s_and_b32 s74, s9, 3
  s_lshl_b32 s75, s74, 1
  s_add_u32 s75, s75, s73
  s_and_b32 s75, s75, 7
  s_mov_b32 s84, s75
  v_lshrrev_b32 v1, 3, v0
  s_lshl_b32 s6, s4, 4
  v_add_u32 v1, s6, v1
  s_mov_b32 s6, 1024
  v_mul_lo_u32 v1, v1, s6
  v_lshrrev_b32 v2, 4, v0
  v_and_b32 v3, 7, v0
  v_xor_b32 v2, v2, v3
  v_lshl_add_u32 v5, v2, 4, v1
  v_xor_b32 v2, 4, v2
  v_lshl_add_u32 v6, v2, 4, v1
  v_add_u32 v6, 7168, v6
  v_lshrrev_b32 v1, 4, v0
  v_and_b32 v2, 15, v0
  v_lshrrev_b32 v3, 2, v2
  v_xor_b32 v3, v3, v1
  v_lshlrev_b32 v3, 2, v3
  v_and_b32 v2, 3, v2
  v_or_b32 v2, v2, v3
  s_lshl_b32 s6, s4, 3
  v_add_u32 v1, s6, v1
  s_mov_b32 s6, 3584
  v_mul_lo_u32 v1, v1, s6
  v_lshl_add_u32 v7, v2, 4, v1
  v_add_u32 v8, 13312, v7
  s_cmp_ge_u32 s3, 4
  s_waitcnt lgkmcnt(0)
  s_cbranch_scc1 L_entryL
  s_load_dword s12, s[38:39], 0
  s_mov_b32 s40, s16
  s_and_b32 s41, s17, 0xffff
  s_mov_b32 s42, 2097152
  s_mov_b32 s43, 0x20000
  s_mov_b32 s44, s24
  s_and_b32 s45, s25, 0xffff
  s_and_b32 s46, s13, 1835008
  s_mov_b32 s47, 0x20000
  s_mov_b32 s48, s18
  s_and_b32 s49, s19, 0xffff
  s_mov_b32 s50, 1572864
  s_mov_b32 s51, 0x20000
  s_lshr_b32 s52, s3, 1
  s_and_b32 s53, s3, 1
  v_and_b32 v5, 31, v0
  v_lshrrev_b32 v6, 5, v0
  s_getpc_b64 s[88:89]
L_pc_here:
  s_sub_u32 s88, s88, L_pc_here-gated_mix__sliding_block__mixer_gmlp__prompt_kernel
  s_subb_u32 s89, s89, 0
  s_and_b32 s89, s89, 0xffff
  s_mov_b32 s90, L_code_end-gated_mix__sliding_block__mixer_gmlp__prompt_kernel
  s_mov_b32 s91, 0x20000
  s_lshr_b32 s54, s2, 3
  s_lshl_b32 s54, s54, 2
  s_add_u32 s54, s54, s3
  s_lshl_b32 s54, s54, 9
  v_lshlrev_b32 v1, 7, v0
  v_cmp_gt_u32 vcc, 4, v0
  s_nop 1
  v_cndmask_b32_e64 v1, -1, v1, vcc
  buffer_load_dword v10, v1, s[88:91], s54 offen
  s_mov_b32 s56, s38
  s_and_b32 s57, s39, 0xffff
  s_mov_b32 s58, 33554432
  s_mov_b32 s59, 0x20000
  s_mov_b32 s80, s38
  s_and_b32 s81, s39, 0xffff
  s_and_b32 s82, s13, 33554432
  s_mov_b32 s83, 0x20000
  s_mov_b32 s60, s20
  s_and_b32 s61, s21, 0xffff
  s_mov_b32 s62, 524288
  s_mov_b32 s63, 0x20000
  s_mov_b32 s64, s30
  s_and_b32 s65, s31, 0xffff
  s_mov_b32 s66, 917504
  s_mov_b32 s67, 0x20000
  s_mov_b32 s68, s28
  s_and_b32 s69, s29, 0xffff
  s_mov_b32 s70, 4096
  s_mov_b32 s71, 0x20000
  s_mov_b32 s72, s34
  s_and_b32 s73, s35, 0xffff
  s_mov_b32 s74, 2097152
  s_mov_b32 s75, 0x20000
  s_mov_b32 s84, s26
  s_and_b32 s85, s27, 0xffff
  s_mov_b32 s86, 8388608
  s_mov_b32 s87, 0x20000
  s_mov_b32 s4, s24
  s_and_b32 s5, s25, 0xffff
  s_mov_b32 s6, 1835008
  s_mov_b32 s7, 0x20000
  s_waitcnt lgkmcnt(0)
  s_mul_i32 s12, s12, 0x9E3779B1
  s_add_u32 s12, s12, 0x7F4A7C15
  v_mov_b32 v7, s12
  v_mov_b32 v8, 0
  s_lshl_b32 s54, s8, 7
  s_lshl_b32 s55, s52, 6
  s_add_u32 s54, s54, s55
  v_lshlrev_b32 v1, 1, v5
  buffer_load_ushort v11, v1, s[68:71], s54 offen
  v_lshrrev_b32 v1, 1, v5
  v_and_b32 v1, 7, v1
  v_xor_b32 v1, v1, v6
  v_lshlrev_b32 v1, 4, v1
  v_lshl_add_u32 v1, v5, 7, v1
  s_lshl_b32 s54, s52, 12
  v_add_u32 v1, s54, v1
  v_xor_b32 v12, 0, v1
  v_add_u32 v13, 0x10000, v12
  v_add_u32 v14, 0x20000, v12
  v_xor_b32 v15, 32, v1
  v_add_u32 v16, 0x10000, v15
  v_add_u32 v17, 0x20000, v15
  v_xor_b32 v18, 64, v1
  v_add_u32 v19, 0x10000, v18
  v_add_u32 v20, 0x20000, v18
  v_xor_b32 v21, 96, v1
  v_add_u32 v22, 0x10000, v21
  v_add_u32 v23, 0x20000, v21
  v_lshrrev_b32 v1, 4, v0
  v_and_b32 v2, 15, v0
  v_lshrrev_b32 v3, 1, v1
  v_lshlrev_b32 v3, 3, v3
  v_lshrrev_b32 v4, 2, v2
  v_add_u32 v24, v3, v4
  v_and_b32 v3, 1, v1
  v_lshlrev_b32 v3, 5, v3
  v_and_b32 v4, 3, v2
  v_lshlrev_b32 v4, 3, v4
  v_add_u32 v25, v3, v4
  s_lshl_b32 s54, s53, 1
  s_add_u32 s54, s54, 0
  v_lshrrev_b32 v3, 2, v2
  v_xor_b32 v3, s54, v3
  v_lshlrev_b32 v3, 6, v3
  v_lshl_add_u32 v26, v24, 8, v3
  v_add_u32 v26, v26, v25
  v_add_u32 v27, 0x10000, v26
  v_add_u32 v28, 0x20000, v26
  s_lshl_b32 s54, s53, 1
  s_add_u32 s54, s54, 1
  v_lshrrev_b32 v3, 2, v2
  v_xor_b32 v3, s54, v3
  v_lshlrev_b32 v3, 6, v3
  v_lshl_add_u32 v29, v24, 8, v3
  v_add_u32 v29, v29, v25
  v_add_u32 v30, 0x10000, v29
  v_add_u32 v31, 0x20000, v29
  v_lshrrev_b32 v3, 3, v2
  v_xor_b32 v3, s53, v3
  v_lshlrev_b32 v3, 6, v3
  v_lshl_add_u32 v32, v24, 7, v3
  v_add_u32 v32, v32, v25
  v_add_u32 v33, 0x10000, v32
  v_add_u32 v34, 0x20000, v32
  v_mov_b32 v132, 0xc0135761
  v_mov_b32 v134, 0xbdd2d3e8
  v_mov_b32 v136, 1.0
  v_mov_b32 v133, 0xc0135761
  v_mov_b32 v135, 0xbdd2d3e8
  v_mov_b32 v137, 1.0
  s_cmp_eq_u32 s9, 7
  s_cbranch_scc1 L_C7
  s_barrier
  ds_read_b128 v[68:71], v12 offset:0
  ds_read_b64_tr_b16 v[72:73], v26 offset:8192
  ds_read_b64_tr_b16 v[74:75], v26 offset:9216
  ds_read_b64_tr_b16 v[76:77], v29 offset:8192
  ds_read_b64_tr_b16 v[78:79], v29 offset:9216
  ds_read_b128 v[84:87], v15 offset:0
  ds_read_b64_tr_b16 v[88:89], v26 offset:12288
  ds_read_b64_tr_b16 v[90:91], v26 offset:13312
  ds_read_b64_tr_b16 v[92:93], v29 offset:12288
  ds_read_b64_tr_b16 v[94:95], v29 offset:13312
  s_waitcnt lgkmcnt(5)
  v_mfma_f32_32x32x16_bf16 a[0:15], v[72:75], v[68:71], 0
  ds_read_b128 v[100:103], v18 offset:0
  ds_read_b64_tr_b16 v[104:105], v26 offset:16384
  ds_read_b64_tr_b16 v[106:107], v26 offset:17408
  v_mfma_f32_32x32x16_bf16 a[16:31], v[76:79], v[68:71], 0
  ds_read_b64_tr_b16 v[108:109], v29 offset:16384
  ds_read_b64_tr_b16 v[110:111], v29 offset:17408
  s_waitcnt lgkmcnt(5)
  v_mfma_f32_32x32x16_bf16 a[0:15], v[88:91], v[84:87], a[0:15]
  ds_read_b128 v[116:119], v21 offset:0
  ds_read_b64_tr_b16 v[120:121], v26 offset:20480
  ds_read_b64_tr_b16 v[122:123], v26 offset:21504
  v_mfma_f32_32x32x16_bf16 a[16:31], v[92:95], v[84:87], a[16:31]
  ds_read_b64_tr_b16 v[124:125], v29 offset:20480
  ds_read_b64_tr_b16 v[126:127], v29 offset:21504
  s_barrier
  s_waitcnt lgkmcnt(5)
  v_mfma_f32_32x32x16_bf16 a[0:15], v[104:107], v[100:103], a[0:15]
  ds_read_b128 v[68:71], v12 offset:24576
  ds_read_b64_tr_b16 v[72:73], v26 offset:32768
  ds_read_b64_tr_b16 v[74:75], v26 offset:33792
  v_mfma_f32_32x32x16_bf16 a[16:31], v[108:111], v[100:103], a[16:31]
  ds_read_b64_tr_b16 v[76:77], v29 offset:32768
  ds_read_b64_tr_b16 v[78:79], v29 offset:33792
  s_waitcnt lgkmcnt(5)
  v_mfma_f32_32x32x16_bf16 a[0:15], v[120:123], v[116:119], a[0:15]
  ds_read_b128 v[84:87], v15 offset:24576
  ds_read_b64_tr_b16 v[88:89], v26 offset:36864
  ds_read_b64_tr_b16 v[90:91], v26 offset:37888
  v_mfma_f32_32x32x16_bf16 a[16:31], v[124:127], v[116:119], a[16:31]
  ds_read_b64_tr_b16 v[92:93], v29 offset:36864
  ds_read_b64_tr_b16 v[94:95], v29 offset:37888
  s_waitcnt lgkmcnt(5)
  v_mfma_f32_32x32x16_bf16 a[0:15], v[72:75], v[68:71], a[0:15]
  ds_read_b128 v[100:103], v18 offset:24576
  ds_read_b64_tr_b16 v[104:105], v26 offset:40960
  ds_read_b64_tr_b16 v[106:107], v26 offset:41984
  v_mfma_f32_32x32x16_bf16 a[16:31], v[76:79], v[68:71], a[16:31]
  ds_read_b64_tr_b16 v[108:109], v29 offset:40960
  ds_read_b64_tr_b16 v[110:111], v29 offset:41984
  s_waitcnt lgkmcnt(5)
  v_mfma_f32_32x32x16_bf16 a[0:15], v[88:91], v[84:87], a[0:15]
  ds_read_b128 v[116:119], v21 offset:24576
  ds_read_b64_tr_b16 v[120:121], v26 offset:45056
  ds_read_b64_tr_b16 v[122:123], v26 offset:46080
  v_mfma_f32_32x32x16_bf16 a[16:31], v[92:95], v[84:87], a[16:31]
  ds_read_b64_tr_b16 v[124:125], v29 offset:45056
  ds_read_b64_tr_b16 v[126:127], v29 offset:46080
  s_barrier
  s_waitcnt lgkmcnt(5)
  v_mfma_f32_32x32x16_bf16 a[0:15], v[104:107], v[100:103], a[0:15]
  ds_read_b128 v[68:71], v12 offset:49152
  ds_read_b64_tr_b16 v[72:73], v26 offset:57344
  ds_read_b64_tr_b16 v[74:75], v26 offset:58368
  v_mfma_f32_32x32x16_bf16 a[16:31], v[108:111], v[100:103], a[16:31]
  ds_read_b64_tr_b16 v[76:77], v29 offset:57344
  ds_read_b64_tr_b16 v[78:79], v29 offset:58368
  s_waitcnt lgkmcnt(5)
  v_mfma_f32_32x32x16_bf16 a[0:15], v[120:123], v[116:119], a[0:15]
  ds_read_b128 v[84:87], v15 offset:49152
  ds_read_b64_tr_b16 v[88:89], v26 offset:61440
  ds_read_b64_tr_b16 v[90:91], v26 offset:62464
  v_mfma_f32_32x32x16_bf16 a[16:31], v[124:127], v[116:119], a[16:31]
  ds_read_b64_tr_b16 v[92:93], v29 offset:61440
  ds_read_b64_tr_b16 v[94:95], v29 offset:62464
  s_waitcnt lgkmcnt(5)
  v_mfma_f32_32x32x16_bf16 a[0:15], v[72:75], v[68:71], a[0:15]
  ds_read_b128 v[100:103], v18 offset:49152
  ds_read_b64_tr_b16 v[104:105], v27 offset:0
  ds_read_b64_tr_b16 v[106:107], v27 offset:1024
  v_mfma_f32_32x32x16_bf16 a[16:31], v[76:79], v[68:71], a[16:31]
  ds_read_b64_tr_b16 v[108:109], v30 offset:0
  ds_read_b64_tr_b16 v[110:111], v30 offset:1024
  s_waitcnt lgkmcnt(5)
  v_mfma_f32_32x32x16_bf16 a[0:15], v[88:91], v[84:87], a[0:15]
  ds_read_b128 v[116:119], v21 offset:49152
  ds_read_b64_tr_b16 v[120:121], v27 offset:4096
  ds_read_b64_tr_b16 v[122:123], v27 offset:5120
  v_mfma_f32_32x32x16_bf16 a[16:31], v[92:95], v[84:87], a[16:31]
  ds_read_b64_tr_b16 v[124:125], v30 offset:4096
  ds_read_b64_tr_b16 v[126:127], v30 offset:5120
  s_barrier
  s_waitcnt lgkmcnt(5)
  v_mfma_f32_32x32x16_bf16 a[0:15], v[104:107], v[100:103], a[0:15]
  ds_read_b128 v[68:71], v13 offset:8192
  ds_read_b64_tr_b16 v[72:73], v27 offset:16384
  ds_read_b64_tr_b16 v[74:75], v27 offset:17408
  v_mfma_f32_32x32x16_bf16 a[16:31], v[108:111], v[100:103], a[16:31]
  ds_read_b64_tr_b16 v[76:77], v30 offset:16384
  ds_read_b64_tr_b16 v[78:79], v30 offset:17408
  s_waitcnt lgkmcnt(5)
  v_mfma_f32_32x32x16_bf16 a[0:15], v[120:123], v[116:119], a[0:15]
  ds_read_b128 v[84:87], v16 offset:8192
  ds_read_b64_tr_b16 v[88:89], v27 offset:20480
  ds_read_b64_tr_b16 v[90:91], v27 offset:21504
  v_mfma_f32_32x32x16_bf16 a[16:31], v[124:127], v[116:119], a[16:31]
  ds_read_b64_tr_b16 v[92:93], v30 offset:20480
  ds_read_b64_tr_b16 v[94:95], v30 offset:21504
  s_waitcnt lgkmcnt(5)
  v_mfma_f32_32x32x16_bf16 a[0:15], v[72:75], v[68:71], a[0:15]
  ds_read_b128 v[100:103], v19 offset:8192
  ds_read_b64_tr_b16 v[104:105], v27 offset:24576
  ds_read_b64_tr_b16 v[106:107], v27 offset:25600
  v_mfma_f32_32x32x16_bf16 a[16:31], v[76:79], v[68:71], a[16:31]
  ds_read_b64_tr_b16 v[108:109], v30 offset:24576
  ds_read_b64_tr_b16 v[110:111], v30 offset:25600
  s_waitcnt lgkmcnt(5)
  v_mfma_f32_32x32x16_bf16 a[0:15], v[88:91], v[84:87], a[0:15]
  ds_read_b128 v[116:119], v22 offset:8192
  ds_read_b64_tr_b16 v[120:121], v27 offset:28672
  ds_read_b64_tr_b16 v[122:123], v27 offset:29696
  v_mfma_f32_32x32x16_bf16 a[16:31], v[92:95], v[84:87], a[16:31]
  ds_read_b64_tr_b16 v[124:125], v30 offset:28672
  ds_read_b64_tr_b16 v[126:127], v30 offset:29696
  s_barrier
  s_waitcnt lgkmcnt(5)
  v_mfma_f32_32x32x16_bf16 a[0:15], v[104:107], v[100:103], a[0:15]
  ds_read_b128 v[68:71], v13 offset:32768
  ds_read_b64_tr_b16 v[72:73], v27 offset:40960
  ds_read_b64_tr_b16 v[74:75], v27 offset:41984
  v_mfma_f32_32x32x16_bf16 a[16:31], v[108:111], v[100:103], a[16:31]
  ds_read_b64_tr_b16 v[76:77], v30 offset:40960
  ds_read_b64_tr_b16 v[78:79], v30 offset:41984
  s_waitcnt lgkmcnt(5)
  v_mfma_f32_32x32x16_bf16 a[0:15], v[120:123], v[116:119], a[0:15]
  ds_read_b128 v[84:87], v16 offset:32768
  ds_read_b64_tr_b16 v[88:89], v27 offset:45056
  ds_read_b64_tr_b16 v[90:91], v27 offset:46080
  v_mfma_f32_32x32x16_bf16 a[16:31], v[124:127], v[116:119], a[16:31]
  ds_read_b64_tr_b16 v[92:93], v30 offset:45056
  ds_read_b64_tr_b16 v[94:95], v30 offset:46080
  s_waitcnt lgkmcnt(5)
  v_mfma_f32_32x32x16_bf16 a[0:15], v[72:75], v[68:71], a[0:15]
  ds_read_b128 v[100:103], v19 offset:32768
  ds_read_b64_tr_b16 v[104:105], v27 offset:49152
  ds_read_b64_tr_b16 v[106:107], v27 offset:50176
  v_mfma_f32_32x32x16_bf16 a[16:31], v[76:79], v[68:71], a[16:31]
  ds_read_b64_tr_b16 v[108:109], v30 offset:49152
  ds_read_b64_tr_b16 v[110:111], v30 offset:50176
  s_waitcnt lgkmcnt(5)
  v_mfma_f32_32x32x16_bf16 a[0:15], v[88:91], v[84:87], a[0:15]
  ds_read_b128 v[116:119], v22 offset:32768
  ds_read_b64_tr_b16 v[120:121], v27 offset:53248
  ds_read_b64_tr_b16 v[122:123], v27 offset:54272
  v_mfma_f32_32x32x16_bf16 a[16:31], v[92:95], v[84:87], a[16:31]
  ds_read_b64_tr_b16 v[124:125], v30 offset:53248
  ds_read_b64_tr_b16 v[126:127], v30 offset:54272
  s_barrier
  s_waitcnt lgkmcnt(5)
  v_mfma_f32_32x32x16_bf16 a[0:15], v[104:107], v[100:103], a[0:15]
  ds_read_b128 v[68:71], v13 offset:57344
  ds_read_b64_tr_b16 v[72:73], v28 offset:0
  ds_read_b64_tr_b16 v[74:75], v28 offset:1024
  v_mfma_f32_32x32x16_bf16 a[16:31], v[108:111], v[100:103], a[16:31]
  ds_read_b64_tr_b16 v[76:77], v31 offset:0
  ds_read_b64_tr_b16 v[78:79], v31 offset:1024
  s_waitcnt lgkmcnt(5)
  v_mfma_f32_32x32x16_bf16 a[0:15], v[120:123], v[116:119], a[0:15]
  ds_read_b128 v[84:87], v16 offset:57344
  ds_read_b64_tr_b16 v[88:89], v28 offset:4096
  ds_read_b64_tr_b16 v[90:91], v28 offset:5120
  v_mfma_f32_32x32x16_bf16 a[16:31], v[124:127], v[116:119], a[16:31]
  ds_read_b64_tr_b16 v[92:93], v31 offset:4096
  ds_read_b64_tr_b16 v[94:95], v31 offset:5120
  s_waitcnt lgkmcnt(5)
  v_mfma_f32_32x32x16_bf16 a[0:15], v[72:75], v[68:71], a[0:15]
  ds_read_b128 v[100:103], v19 offset:57344
  ds_read_b64_tr_b16 v[104:105], v26 offset:8192
  ds_read_b64_tr_b16 v[106:107], v26 offset:9216
  v_mfma_f32_32x32x16_bf16 a[16:31], v[76:79], v[68:71], a[16:31]
  ds_read_b64_tr_b16 v[108:109], v29 offset:8192
  ds_read_b64_tr_b16 v[110:111], v29 offset:9216
  s_waitcnt lgkmcnt(5)
  v_mfma_f32_32x32x16_bf16 a[0:15], v[88:91], v[84:87], a[0:15]
  ds_read_b128 v[116:119], v22 offset:57344
  ds_read_b64_tr_b16 v[120:121], v26 offset:12288
  ds_read_b64_tr_b16 v[122:123], v26 offset:13312
  v_mfma_f32_32x32x16_bf16 a[16:31], v[92:95], v[84:87], a[16:31]
  ds_read_b64_tr_b16 v[124:125], v29 offset:12288
  ds_read_b64_tr_b16 v[126:127], v29 offset:13312
  s_barrier
  s_waitcnt lgkmcnt(5)
  v_mfma_f32_32x32x16_bf16 a[0:15], v[104:107], v[100:103], a[0:15]
  ds_read_b128 v[68:71], v14 offset:8192
  ds_read_b64_tr_b16 v[72:73], v26 offset:16384
  ds_read_b64_tr_b16 v[74:75], v26 offset:17408
  v_mfma_f32_32x32x16_bf16 a[16:31], v[108:111], v[100:103], a[16:31]
  ds_read_b64_tr_b16 v[76:77], v29 offset:16384
  ds_read_b64_tr_b16 v[78:79], v29 offset:17408
  s_waitcnt lgkmcnt(5)
  v_mfma_f32_32x32x16_bf16 a[0:15], v[120:123], v[116:119], a[0:15]
  ds_read_b128 v[84:87], v17 offset:8192
  ds_read_b64_tr_b16 v[88:89], v26 offset:20480
  ds_read_b64_tr_b16 v[90:91], v26 offset:21504
  v_mfma_f32_32x32x16_bf16 a[16:31], v[124:127], v[116:119], a[16:31]
  ds_read_b64_tr_b16 v[92:93], v29 offset:20480
  ds_read_b64_tr_b16 v[94:95], v29 offset:21504
  s_waitcnt lgkmcnt(5)
  v_mfma_f32_32x32x16_bf16 a[0:15], v[72:75], v[68:71], a[0:15]
  ds_read_b128 v[100:103], v20 offset:8192
  ds_read_b64_tr_b16 v[104:105], v28 offset:16384
  ds_read_b64_tr_b16 v[106:107], v28 offset:17408
  v_mfma_f32_32x32x16_bf16 a[16:31], v[76:79], v[68:71], a[16:31]
  ds_read_b64_tr_b16 v[108:109], v31 offset:16384
  ds_read_b64_tr_b16 v[110:111], v31 offset:17408
  s_waitcnt lgkmcnt(5)
  v_mfma_f32_32x32x16_bf16 a[0:15], v[88:91], v[84:87], a[0:15]
  ds_read_b128 v[116:119], v23 offset:8192
  ds_read_b64_tr_b16 v[120:121], v28 offset:20480
  ds_read_b64_tr_b16 v[122:123], v28 offset:21504
  v_mfma_f32_32x32x16_bf16 a[16:31], v[92:95], v[84:87], a[16:31]
  ds_read_b64_tr_b16 v[124:125], v31 offset:20480
  ds_read_b64_tr_b16 v[126:127], v31 offset:21504
  s_barrier
  s_waitcnt lgkmcnt(5)
  v_mfma_f32_32x32x16_bf16 a[0:15], v[104:107], v[100:103], a[0:15]
  ds_read_b128 v[68:71], v12 offset:57344
  ds_read_b64_tr_b16 v[72:73], v26 offset:32768
  ds_read_b64_tr_b16 v[74:75], v26 offset:33792
  v_mfma_f32_32x32x16_bf16 a[16:31], v[108:111], v[100:103], a[16:31]
  ds_read_b64_tr_b16 v[76:77], v29 offset:32768
  ds_read_b64_tr_b16 v[78:79], v29 offset:33792
  s_waitcnt lgkmcnt(5)
  v_mfma_f32_32x32x16_bf16 a[0:15], v[120:123], v[116:119], a[0:15]
  ds_read_b128 v[84:87], v15 offset:57344
  ds_read_b64_tr_b16 v[88:89], v26 offset:36864
  ds_read_b64_tr_b16 v[90:91], v26 offset:37888
  v_mfma_f32_32x32x16_bf16 a[16:31], v[124:127], v[116:119], a[16:31]
  ds_read_b64_tr_b16 v[92:93], v29 offset:36864
  ds_read_b64_tr_b16 v[94:95], v29 offset:37888
  s_waitcnt lgkmcnt(5)
  v_mfma_f32_32x32x16_bf16 a[0:15], v[72:75], v[68:71], a[0:15]
  ds_read_b128 v[100:103], v18 offset:57344
  ds_read_b64_tr_b16 v[104:105], v26 offset:40960
  ds_read_b64_tr_b16 v[106:107], v26 offset:41984
  v_mfma_f32_32x32x16_bf16 a[16:31], v[76:79], v[68:71], a[16:31]
  ds_read_b64_tr_b16 v[108:109], v29 offset:40960
  ds_read_b64_tr_b16 v[110:111], v29 offset:41984
  s_waitcnt lgkmcnt(5)
  v_mfma_f32_32x32x16_bf16 a[0:15], v[88:91], v[84:87], a[0:15]
  ds_read_b128 v[116:119], v21 offset:57344
  ds_read_b64_tr_b16 v[120:121], v26 offset:45056
  ds_read_b64_tr_b16 v[122:123], v26 offset:46080
  v_mfma_f32_32x32x16_bf16 a[16:31], v[92:95], v[84:87], a[16:31]
  ds_read_b64_tr_b16 v[124:125], v29 offset:45056
  ds_read_b64_tr_b16 v[126:127], v29 offset:46080
  s_barrier
  s_waitcnt lgkmcnt(5)
  v_mfma_f32_32x32x16_bf16 a[0:15], v[104:107], v[100:103], a[0:15]
  ds_read_b128 v[68:71], v12 offset:0
  ds_read_b64_tr_b16 v[72:73], v33 offset:0
  ds_read_b64_tr_b16 v[74:75], v33 offset:512
  ds_read_b64_tr_b16 v[76:77], v33 offset:16384
  v_mfma_f32_32x32x16_bf16 a[16:31], v[108:111], v[100:103], a[16:31]
  ds_read_b64_tr_b16 v[78:79], v33 offset:16896
  ds_read_b64_tr_b16 v[80:81], v33 offset:24576
  ds_read_b64_tr_b16 v[82:83], v33 offset:25088
  s_waitcnt lgkmcnt(7)
  v_mfma_f32_32x32x16_bf16 a[0:15], v[120:123], v[116:119], a[0:15]
  ds_read_b128 v[84:87], v15 offset:0
  ds_read_b64_tr_b16 v[88:89], v33 offset:2048
  ds_read_b64_tr_b16 v[90:91], v33 offset:2560
  ds_read_b64_tr_b16 v[92:93], v33 offset:18432
  v_mfma_f32_32x32x16_bf16 a[16:31], v[124:127], v[116:119], a[16:31]
  ds_read_b64_tr_b16 v[94:95], v33 offset:18944
  ds_read_b64_tr_b16 v[96:97], v33 offset:26624
  ds_read_b64_tr_b16 v[98:99], v33 offset:27136
  s_nop 3
  v_accvgpr_read_b32 v36, a0
  v_accvgpr_read_b32 v37, a1
  v_accvgpr_read_b32 v38, a2
  v_accvgpr_read_b32 v39, a3
  v_accvgpr_read_b32 v40, a4
  v_accvgpr_read_b32 v41, a5
  v_accvgpr_read_b32 v42, a6
  v_accvgpr_read_b32 v43, a7
  v_accvgpr_read_b32 v44, a8
  v_accvgpr_read_b32 v45, a9
  v_accvgpr_read_b32 v46, a10
  v_accvgpr_read_b32 v47, a11
  v_accvgpr_read_b32 v48, a12
  v_accvgpr_read_b32 v49, a13
  v_accvgpr_read_b32 v50, a14
  v_accvgpr_read_b32 v51, a15
  v_accvgpr_read_b32 v52, a16
  v_accvgpr_read_b32 v53, a17
  v_accvgpr_read_b32 v54, a18
  v_accvgpr_read_b32 v55, a19
  v_accvgpr_read_b32 v56, a20
  v_accvgpr_read_b32 v57, a21
  v_accvgpr_read_b32 v58, a22
  v_accvgpr_read_b32 v59, a23
  v_accvgpr_read_b32 v60, a24
  v_accvgpr_read_b32 v61, a25
  v_accvgpr_read_b32 v62, a26
  v_accvgpr_read_b32 v63, a27
  v_accvgpr_read_b32 v64, a28
  v_accvgpr_read_b32 v65, a29
  v_accvgpr_read_b32 v66, a30
  v_accvgpr_read_b32 v67, a31
  v_pk_mul_f32 v[138:139], v[36:37], v[36:37]
  v_pk_mul_f32 v[140:141], v[38:39], v[38:39]
  v_pk_mul_f32 v[142:143], v[40:41], v[40:41]
  v_pk_mul_f32 v[144:145], v[42:43], v[42:43]
  v_pk_fma_f32 v[138:139], v[138:139], v[134:135], v[132:133]
  v_pk_fma_f32 v[140:141], v[140:141], v[134:135], v[132:133]
  v_pk_fma_f32 v[142:143], v[142:143], v[134:135], v[132:133]
  v_pk_fma_f32 v[144:145], v[144:145], v[134:135], v[132:133]
  v_pk_mul_f32 v[138:139], v[138:139], v[36:37]
  v_pk_mul_f32 v[140:141], v[140:141], v[38:39]
  v_pk_mul_f32 v[142:143], v[142:143], v[40:41]
  v_pk_mul_f32 v[144:145], v[144:145], v[42:43]
  v_exp_f32 v138, v138
  v_exp_f32 v139, v139
  v_exp_f32 v140, v140
  v_exp_f32 v141, v141
  v_exp_f32 v142, v142
  v_exp_f32 v143, v143
  v_exp_f32 v144, v144
  v_exp_f32 v145, v145
  v_pk_add_f32 v[138:139], v[138:139], v[136:137]
  v_pk_add_f32 v[140:141], v[140:141], v[136:137]
  v_pk_add_f32 v[142:143], v[142:143], v[136:137]
  v_pk_add_f32 v[144:145], v[144:145], v[136:137]
  v_rcp_f32 v138, v138
  v_rcp_f32 v139, v139
  v_rcp_f32 v140, v140
  v_rcp_f32 v141, v141
  v_rcp_f32 v142, v142
  v_rcp_f32 v143, v143
  v_rcp_f32 v144, v144
  v_rcp_f32 v145, v145
  v_pk_mul_f32 v[36:37], v[36:37], v[138:139]
  v_pk_mul_f32 v[38:39], v[38:39], v[140:141]
  v_pk_mul_f32 v[40:41], v[40:41], v[142:143]
  v_pk_mul_f32 v[42:43], v[42:43], v[144:145]
  v_pk_mul_f32 v[138:139], v[44:45], v[44:45]
  v_pk_mul_f32 v[140:141], v[46:47], v[46:47]
  v_pk_mul_f32 v[142:143], v[48:49], v[48:49]
  v_pk_mul_f32 v[144:145], v[50:51], v[50:51]
  v_pk_fma_f32 v[138:139], v[138:139], v[134:135], v[132:133]
  v_pk_fma_f32 v[140:141], v[140:141], v[134:135], v[132:133]
  v_pk_fma_f32 v[142:143], v[142:143], v[134:135], v[132:133]
  v_pk_fma_f32 v[144:145], v[144:145], v[134:135], v[132:133]
  v_pk_mul_f32 v[138:139], v[138:139], v[44:45]
  v_pk_mul_f32 v[140:141], v[140:141], v[46:47]
  v_pk_mul_f32 v[142:143], v[142:143], v[48:49]
  v_pk_mul_f32 v[144:145], v[144:145], v[50:51]
  v_exp_f32 v138, v138
  v_exp_f32 v139, v139
  v_exp_f32 v140, v140
  v_exp_f32 v141, v141
  v_exp_f32 v142, v142
  v_exp_f32 v143, v143
  v_exp_f32 v144, v144
  v_exp_f32 v145, v145
  v_pk_add_f32 v[138:139], v[138:139], v[136:137]
  v_pk_add_f32 v[140:141], v[140:141], v[136:137]
  v_pk_add_f32 v[142:143], v[142:143], v[136:137]
  v_pk_add_f32 v[144:145], v[144:145], v[136:137]
  v_rcp_f32 v138, v138
  v_rcp_f32 v139, v139
  v_rcp_f32 v140, v140
  v_rcp_f32 v141, v141
  v_rcp_f32 v142, v142
  v_rcp_f32 v143, v143
  v_rcp_f32 v144, v144
  v_rcp_f32 v145, v145
  v_pk_mul_f32 v[44:45], v[44:45], v[138:139]
  v_pk_mul_f32 v[46:47], v[46:47], v[140:141]
  v_pk_mul_f32 v[48:49], v[48:49], v[142:143]
  v_pk_mul_f32 v[50:51], v[50:51], v[144:145]
  v_pk_mul_f32 v[138:139], v[52:53], v[52:53]
  v_pk_mul_f32 v[140:141], v[54:55], v[54:55]
  v_pk_mul_f32 v[142:143], v[56:57], v[56:57]
  v_pk_mul_f32 v[144:145], v[58:59], v[58:59]
  v_pk_fma_f32 v[138:139], v[138:139], v[134:135], v[132:133]
  v_pk_fma_f32 v[140:141], v[140:141], v[134:135], v[132:133]
  v_pk_fma_f32 v[142:143], v[142:143], v[134:135], v[132:133]
  v_pk_fma_f32 v[144:145], v[144:145], v[134:135], v[132:133]
  v_pk_mul_f32 v[138:139], v[138:139], v[52:53]
  v_pk_mul_f32 v[140:141], v[140:141], v[54:55]
  v_pk_mul_f32 v[142:143], v[142:143], v[56:57]
  v_pk_mul_f32 v[144:145], v[144:145], v[58:59]
  v_exp_f32 v138, v138
  v_exp_f32 v139, v139
  v_exp_f32 v140, v140
  v_exp_f32 v141, v141
  v_exp_f32 v142, v142
  v_exp_f32 v143, v143
  v_exp_f32 v144, v144
  v_exp_f32 v145, v145
  v_pk_add_f32 v[138:139], v[138:139], v[136:137]
  v_pk_add_f32 v[140:141], v[140:141], v[136:137]
  v_pk_add_f32 v[142:143], v[142:143], v[136:137]
  v_pk_add_f32 v[144:145], v[144:145], v[136:137]
  v_rcp_f32 v138, v138
  v_rcp_f32 v139, v139
  v_rcp_f32 v140, v140
  v_rcp_f32 v141, v141
  v_rcp_f32 v142, v142
  v_rcp_f32 v143, v143
  v_rcp_f32 v144, v144
  v_rcp_f32 v145, v145
  v_pk_mul_f32 v[52:53], v[52:53], v[138:139]
  v_pk_mul_f32 v[54:55], v[54:55], v[140:141]
  v_pk_mul_f32 v[56:57], v[56:57], v[142:143]
  v_pk_mul_f32 v[58:59], v[58:59], v[144:145]
  v_pk_mul_f32 v[138:139], v[60:61], v[60:61]
  v_pk_mul_f32 v[140:141], v[62:63], v[62:63]
  v_pk_mul_f32 v[142:143], v[64:65], v[64:65]
  v_pk_mul_f32 v[144:145], v[66:67], v[66:67]
  v_pk_fma_f32 v[138:139], v[138:139], v[134:135], v[132:133]
  v_pk_fma_f32 v[140:141], v[140:141], v[134:135], v[132:133]
  v_pk_fma_f32 v[142:143], v[142:143], v[134:135], v[132:133]
  v_pk_fma_f32 v[144:145], v[144:145], v[134:135], v[132:133]
  v_pk_mul_f32 v[138:139], v[138:139], v[60:61]
  v_pk_mul_f32 v[140:141], v[140:141], v[62:63]
  v_pk_mul_f32 v[142:143], v[142:143], v[64:65]
  v_pk_mul_f32 v[144:145], v[144:145], v[66:67]
  v_exp_f32 v138, v138
  v_exp_f32 v139, v139
  v_exp_f32 v140, v140
  v_exp_f32 v141, v141
  v_exp_f32 v142, v142
  v_exp_f32 v143, v143
  v_exp_f32 v144, v144
  v_exp_f32 v145, v145
  v_pk_add_f32 v[138:139], v[138:139], v[136:137]
  v_pk_add_f32 v[140:141], v[140:141], v[136:137]
  v_pk_add_f32 v[142:143], v[142:143], v[136:137]
  v_pk_add_f32 v[144:145], v[144:145], v[136:137]
  v_rcp_f32 v138, v138
  v_rcp_f32 v139, v139
  v_rcp_f32 v140, v140
  v_rcp_f32 v141, v141
  v_rcp_f32 v142, v142
  v_rcp_f32 v143, v143
  v_rcp_f32 v144, v144
  v_rcp_f32 v145, v145
  v_pk_mul_f32 v[60:61], v[60:61], v[138:139]
  v_pk_mul_f32 v[62:63], v[62:63], v[140:141]
  v_pk_mul_f32 v[64:65], v[64:65], v[142:143]
  v_pk_mul_f32 v[66:67], v[66:67], v[144:145]
  v_pk_add_f32 v[138:139], v[36:37], v[38:39]
  v_pk_mul_f32 v[140:141], v[36:37], v[36:37]
  v_pk_fma_f32 v[140:141], v[38:39], v[38:39], v[140:141]
  v_pk_add_f32 v[138:139], v[138:139], v[40:41]
  v_pk_fma_f32 v[140:141], v[40:41], v[40:41], v[140:141]
  v_pk_add_f32 v[138:139], v[138:139], v[42:43]
  v_pk_fma_f32 v[140:141], v[42:43], v[42:43], v[140:141]
  v_pk_add_f32 v[138:139], v[138:139], v[44:45]
  v_pk_fma_f32 v[140:141], v[44:45], v[44:45], v[140:141]
  v_pk_add_f32 v[138:139], v[138:139], v[46:47]
  v_pk_fma_f32 v[140:141], v[46:47], v[46:47], v[140:141]
  v_pk_add_f32 v[138:139], v[138:139], v[48:49]
  v_pk_fma_f32 v[140:141], v[48:49], v[48:49], v[140:141]
  v_pk_add_f32 v[138:139], v[138:139], v[50:51]
  v_pk_fma_f32 v[140:141], v[50:51], v[50:51], v[140:141]
  v_pk_add_f32 v[138:139], v[138:139], v[52:53]
  v_pk_fma_f32 v[140:141], v[52:53], v[52:53], v[140:141]
  v_pk_add_f32 v[138:139], v[138:139], v[54:55]
  v_pk_fma_f32 v[140:141], v[54:55], v[54:55], v[140:141]
  v_pk_add_f32 v[138:139], v[138:139], v[56:57]
  v_pk_fma_f32 v[140:141], v[56:57], v[56:57], v[140:141]
  v_pk_add_f32 v[138:139], v[138:139], v[58:59]
  v_pk_fma_f32 v[140:141], v[58:59], v[58:59], v[140:141]
  v_pk_add_f32 v[138:139], v[138:139], v[60:61]
  v_pk_fma_f32 v[140:141], v[60:61], v[60:61], v[140:141]
  v_pk_add_f32 v[138:139], v[138:139], v[62:63]
  v_pk_fma_f32 v[140:141], v[62:63], v[62:63], v[140:141]
  v_pk_add_f32 v[138:139], v[138:139], v[64:65]
  v_pk_fma_f32 v[140:141], v[64:65], v[64:65], v[140:141]
  v_pk_add_f32 v[138:139], v[138:139], v[66:67]
  v_pk_fma_f32 v[140:141], v[66:67], v[66:67], v[140:141]
  v_add_f32 v148, v138, v139
  v_add_f32 v149, v140, v141
  v_mov_b32 v142, v148
  s_nop 1
  v_permlane32_swap_b32 v142, v148
  v_add_f32 v148, v148, v142
  v_mov_b32 v143, v149
  s_nop 1
  v_permlane32_swap_b32 v143, v149
  v_add_f32 v149, v149, v143
  v_mov_b32 v150, s12
  v_mov_b32 v151, 0
  s_mul_i32 s54, s8, 14
  s_lshl_b32 s55, s9, 1
  s_add_u32 s54, s54, s55
  s_add_u32 s54, s54, s53
  s_lshl_b32 s54, s54, 1
  s_add_u32 s54, s54, s52
  s_lshl_b32 s54, s54, 9
  s_add_u32 s54, s54, 524288
  v_lshlrev_b32 v144, 4, v5
  s_mov_b32 exec_hi, 0
  buffer_store_dwordx4 v[148:151], v144, s[80:83], s54 offen sc1
  s_mov_b32 exec_hi, -1
  s_waitcnt lgkmcnt(7)
  v_mfma_f32_32x32x16_bf16 a[0:15], v[72:75], v[68:71], 0
  ds_read_b128 v[100:103], v18 offset:0
  ds_read_b64_tr_b16 v[104:105], v33 offset:4096
  ds_read_b64_tr_b16 v[106:107], v33 offset:4608
  v_mfma_f32_32x32x16_bf16 a[16:31], v[76:79], v[68:71], 0
  ds_read_b64_tr_b16 v[108:109], v33 offset:20480
  ds_read_b64_tr_b16 v[110:111], v33 offset:20992
  ds_read_b64_tr_b16 v[112:113], v33 offset:28672
  v_mfma_f32_32x32x16_bf16 a[32:47], v[68:71], v[80:83], 0
  ds_read_b64_tr_b16 v[114:115], v33 offset:29184
  s_waitcnt lgkmcnt(7)
  v_mfma_f32_32x32x16_bf16 a[0:15], v[88:91], v[84:87], a[0:15]
  ds_read_b128 v[116:119], v21 offset:0
  ds_read_b64_tr_b16 v[120:121], v33 offset:6144
  ds_read_b64_tr_b16 v[122:123], v33 offset:6656
  v_mfma_f32_32x32x16_bf16 a[16:31], v[92:95], v[84:87], a[16:31]
  ds_read_b64_tr_b16 v[124:125], v33 offset:22528
  ds_read_b64_tr_b16 v[126:127], v33 offset:23040
  ds_read_b64_tr_b16 v[128:129], v33 offset:30720
  v_mfma_f32_32x32x16_bf16 a[32:47], v[84:87], v[96:99], a[32:47]
  ds_read_b64_tr_b16 v[130:131], v33 offset:31232
  s_barrier
  s_waitcnt lgkmcnt(7)
  v_mfma_f32_32x32x16_bf16 a[0:15], v[104:107], v[100:103], a[0:15]
  ds_read_b128 v[68:71], v12 offset:24576
  ds_read_b64_tr_b16 v[72:73], v33 offset:40960
  ds_read_b64_tr_b16 v[74:75], v33 offset:41472
  v_mfma_f32_32x32x16_bf16 a[16:31], v[108:111], v[100:103], a[16:31]
  ds_read_b64_tr_b16 v[76:77], v33 offset:49152
  ds_read_b64_tr_b16 v[78:79], v33 offset:49664
  ds_read_b64_tr_b16 v[80:81], v32 offset:8192
  v_mfma_f32_32x32x16_bf16 a[32:47], v[100:103], v[112:115], a[32:47]
  ds_read_b64_tr_b16 v[82:83], v32 offset:8704
  s_waitcnt lgkmcnt(7)
  v_mfma_f32_32x32x16_bf16 a[0:15], v[120:123], v[116:119], a[0:15]
  ds_read_b128 v[84:87], v15 offset:24576
  ds_read_b64_tr_b16 v[88:89], v33 offset:43008
  ds_read_b64_tr_b16 v[90:91], v33 offset:43520
  v_mfma_f32_32x32x16_bf16 a[16:31], v[124:127], v[116:119], a[16:31]
  ds_read_b64_tr_b16 v[92:93], v33 offset:51200
  ds_read_b64_tr_b16 v[94:95], v33 offset:51712
  ds_read_b64_tr_b16 v[96:97], v32 offset:10240
  v_mfma_f32_32x32x16_bf16 a[32:47], v[116:119], v[128:131], a[32:47]
  ds_read_b64_tr_b16 v[98:99], v32 offset:10752
  s_waitcnt lgkmcnt(7)
  v_mfma_f32_32x32x16_bf16 a[0:15], v[72:75], v[68:71], a[0:15]
  ds_read_b128 v[100:103], v18 offset:24576
  ds_read_b64_tr_b16 v[104:105], v33 offset:45056
  ds_read_b64_tr_b16 v[106:107], v33 offset:45568
  v_mfma_f32_32x32x16_bf16 a[16:31], v[76:79], v[68:71], a[16:31]
  ds_read_b64_tr_b16 v[108:109], v33 offset:53248
  ds_read_b64_tr_b16 v[110:111], v33 offset:53760
  ds_read_b64_tr_b16 v[112:113], v32 offset:12288
  v_mfma_f32_32x32x16_bf16 a[32:47], v[68:71], v[80:83], a[32:47]
  ds_read_b64_tr_b16 v[114:115], v32 offset:12800
  s_waitcnt lgkmcnt(7)
  v_mfma_f32_32x32x16_bf16 a[0:15], v[88:91], v[84:87], a[0:15]
  ds_read_b128 v[116:119], v21 offset:24576
  ds_read_b64_tr_b16 v[120:121], v33 offset:47104
  ds_read_b64_tr_b16 v[122:123], v33 offset:47616
  v_mfma_f32_32x32x16_bf16 a[16:31], v[92:95], v[84:87], a[16:31]
  ds_read_b64_tr_b16 v[124:125], v33 offset:55296
  ds_read_b64_tr_b16 v[126:127], v33 offset:55808
  ds_read_b64_tr_b16 v[128:129], v32 offset:14336
  v_mfma_f32_32x32x16_bf16 a[32:47], v[84:87], v[96:99], a[32:47]
  ds_read_b64_tr_b16 v[130:131], v32 offset:14848
  s_barrier
  s_waitcnt lgkmcnt(7)
  v_mfma_f32_32x32x16_bf16 a[0:15], v[104:107], v[100:103], a[0:15]
  ds_read_b128 v[68:71], v12 offset:49152
  ds_read_b64_tr_b16 v[72:73], v34 offset:0
  ds_read_b64_tr_b16 v[74:75], v34 offset:512
  v_mfma_f32_32x32x16_bf16 a[16:31], v[108:111], v[100:103], a[16:31]
  ds_read_b64_tr_b16 v[76:77], v32 offset:16384
  ds_read_b64_tr_b16 v[78:79], v32 offset:16896
  ds_read_b64_tr_b16 v[80:81], v34 offset:16384
  v_mfma_f32_32x32x16_bf16 a[32:47], v[100:103], v[112:115], a[32:47]
  ds_read_b64_tr_b16 v[82:83], v34 offset:16896
  s_waitcnt lgkmcnt(7)
  v_mfma_f32_32x32x16_bf16 a[0:15], v[120:123], v[116:119], a[0:15]
  ds_read_b128 v[84:87], v15 offset:49152
  ds_read_b64_tr_b16 v[88:89], v34 offset:2048
  ds_read_b64_tr_b16 v[90:91], v34 offset:2560
  v_mfma_f32_32x32x16_bf16 a[16:31], v[124:127], v[116:119], a[16:31]
  ds_read_b64_tr_b16 v[92:93], v32 offset:18432
  ds_read_b64_tr_b16 v[94:95], v32 offset:18944
  ds_read_b64_tr_b16 v[96:97], v34 offset:18432
  v_mfma_f32_32x32x16_bf16 a[32:47], v[116:119], v[128:131], a[32:47]
  ds_read_b64_tr_b16 v[98:99], v34 offset:18944
  s_waitcnt lgkmcnt(7)
  v_mfma_f32_32x32x16_bf16 a[0:15], v[72:75], v[68:71], a[0:15]
  ds_read_b128 v[100:103], v18 offset:49152
  ds_read_b64_tr_b16 v[104:105], v34 offset:4096
  ds_read_b64_tr_b16 v[106:107], v34 offset:4608
  v_mfma_f32_32x32x16_bf16 a[16:31], v[76:79], v[68:71], a[16:31]
  ds_read_b64_tr_b16 v[108:109], v32 offset:20480
  ds_read_b64_tr_b16 v[110:111], v32 offset:20992
  ds_read_b64_tr_b16 v[112:113], v34 offset:20480
  v_mfma_f32_32x32x16_bf16 a[32:47], v[68:71], v[80:83], a[32:47]
  ds_read_b64_tr_b16 v[114:115], v34 offset:20992
  s_waitcnt lgkmcnt(7)
  v_mfma_f32_32x32x16_bf16 a[0:15], v[88:91], v[84:87], a[0:15]
  ds_read_b128 v[116:119], v21 offset:49152
  ds_read_b64_tr_b16 v[120:121], v34 offset:6144
  ds_read_b64_tr_b16 v[122:123], v34 offset:6656
  v_mfma_f32_32x32x16_bf16 a[16:31], v[92:95], v[84:87], a[16:31]
  ds_read_b64_tr_b16 v[124:125], v32 offset:22528
  ds_read_b64_tr_b16 v[126:127], v32 offset:23040
  ds_read_b64_tr_b16 v[128:129], v34 offset:22528
  v_mfma_f32_32x32x16_bf16 a[32:47], v[84:87], v[96:99], a[32:47]
  ds_read_b64_tr_b16 v[130:131], v34 offset:23040
  s_barrier
  s_waitcnt lgkmcnt(7)
  v_mfma_f32_32x32x16_bf16 a[0:15], v[104:107], v[100:103], a[0:15]
  ds_read_b128 v[68:71], v13 offset:8192
  ds_read_b64_tr_b16 v[72:73], v32 offset:32768
  ds_read_b64_tr_b16 v[74:75], v32 offset:33280
  v_mfma_f32_32x32x16_bf16 a[16:31], v[108:111], v[100:103], a[16:31]
  ds_read_b64_tr_b16 v[76:77], v32 offset:40960
  ds_read_b64_tr_b16 v[78:79], v32 offset:41472
  ds_read_b64_tr_b16 v[80:81], v33 offset:0
  v_mfma_f32_32x32x16_bf16 a[32:47], v[100:103], v[112:115], a[32:47]
  ds_read_b64_tr_b16 v[82:83], v33 offset:512
  s_waitcnt lgkmcnt(7)
  v_mfma_f32_32x32x16_bf16 a[0:15], v[120:123], v[116:119], a[0:15]
  ds_read_b128 v[84:87], v16 offset:8192
  ds_read_b64_tr_b16 v[88:89], v32 offset:34816
  ds_read_b64_tr_b16 v[90:91], v32 offset:35328
  v_mfma_f32_32x32x16_bf16 a[16:31], v[124:127], v[116:119], a[16:31]
  ds_read_b64_tr_b16 v[92:93], v32 offset:43008
  ds_read_b64_tr_b16 v[94:95], v32 offset:43520
  ds_read_b64_tr_b16 v[96:97], v33 offset:2048
  v_mfma_f32_32x32x16_bf16 a[32:47], v[116:119], v[128:131], a[32:47]
  ds_read_b64_tr_b16 v[98:99], v33 offset:2560
  s_waitcnt lgkmcnt(7)
  v_mfma_f32_32x32x16_bf16 a[0:15], v[72:75], v[68:71], a[0:15]
  ds_read_b128 v[100:103], v19 offset:8192
  ds_read_b64_tr_b16 v[104:105], v32 offset:36864
  ds_read_b64_tr_b16 v[106:107], v32 offset:37376
  v_mfma_f32_32x32x16_bf16 a[16:31], v[76:79], v[68:71], a[16:31]
  ds_read_b64_tr_b16 v[108:109], v32 offset:45056
  ds_read_b64_tr_b16 v[110:111], v32 offset:45568
  ds_read_b64_tr_b16 v[112:113], v33 offset:4096
  v_mfma_f32_32x32x16_bf16 a[32:47], v[68:71], v[80:83], a[32:47]
  ds_read_b64_tr_b16 v[114:115], v33 offset:4608
  v_mul_u32_u24 v1, 7168, v6
  v_lshl_add_u32 v35, v5, 4, v1
  s_mul_i32 s14, s8, 14336
  s_lshl_b32 s15, s52, 9
  s_add_u32 s14, s14, s15
  s_add_u32 s14, s14, 524288
  s_add_u32 s15, s14, 4096
  buffer_load_dwordx4 v[152:155], v35, s[56:59], s14 offen offset:0 sc1
  buffer_load_dwordx4 v[156:159], v35, s[56:59], s14 offen offset:1024 sc1
  buffer_load_dwordx4 v[160:163], v35, s[56:59], s14 offen offset:2048 sc1
  buffer_load_dwordx4 v[164:167], v35, s[56:59], s14 offen offset:3072 sc1
  buffer_load_dwordx4 v[168:171], v35, s[56:59], s15 offen offset:0 sc1
  buffer_load_dwordx4 v[172:175], v35, s[56:59], s15 offen offset:1024 sc1
  buffer_load_dwordx4 v[176:179], v35, s[56:59], s15 offen offset:2048 sc1
  s_waitcnt lgkmcnt(7)
  v_mfma_f32_32x32x16_bf16 a[0:15], v[88:91], v[84:87], a[0:15]
  ds_read_b128 v[116:119], v22 offset:8192
  ds_read_b64_tr_b16 v[120:121], v32 offset:38912
  ds_read_b64_tr_b16 v[122:123], v32 offset:39424
  v_mfma_f32_32x32x16_bf16 a[16:31], v[92:95], v[84:87], a[16:31]
  ds_read_b64_tr_b16 v[124:125], v32 offset:47104
  ds_read_b64_tr_b16 v[126:127], v32 offset:47616
  ds_read_b64_tr_b16 v[128:129], v33 offset:6144
  v_mfma_f32_32x32x16_bf16 a[32:47], v[84:87], v[96:99], a[32:47]
  ds_read_b64_tr_b16 v[130:131], v33 offset:6656
  s_barrier
  s_waitcnt lgkmcnt(7)
  v_mfma_f32_32x32x16_bf16 a[0:15], v[104:107], v[100:103], a[0:15]
  ds_read_b128 v[68:71], v13 offset:32768
  ds_read_b64_tr_b16 v[72:73], v33 offset:16384
  ds_read_b64_tr_b16 v[74:75], v33 offset:16896
  v_mfma_f32_32x32x16_bf16 a[16:31], v[108:111], v[100:103], a[16:31]
  ds_read_b64_tr_b16 v[76:77], v33 offset:24576
  ds_read_b64_tr_b16 v[78:79], v33 offset:25088
  ds_read_b64_tr_b16 v[80:81], v32 offset:8192
  v_mfma_f32_32x32x16_bf16 a[32:47], v[100:103], v[112:115], a[32:47]
  ds_read_b64_tr_b16 v[82:83], v32 offset:8704
  s_waitcnt lgkmcnt(7)
  v_mfma_f32_32x32x16_bf16 a[0:15], v[120:123], v[116:119], a[0:15]
  ds_read_b128 v[84:87], v16 offset:32768
  ds_read_b64_tr_b16 v[88:89], v33 offset:18432
  ds_read_b64_tr_b16 v[90:91], v33 offset:18944
  v_mfma_f32_32x32x16_bf16 a[16:31], v[124:127], v[116:119], a[16:31]
  ds_read_b64_tr_b16 v[92:93], v33 offset:26624
  ds_read_b64_tr_b16 v[94:95], v33 offset:27136
  ds_read_b64_tr_b16 v[96:97], v32 offset:10240
  v_mfma_f32_32x32x16_bf16 a[32:47], v[116:119], v[128:131], a[32:47]
  ds_read_b64_tr_b16 v[98:99], v32 offset:10752
  s_waitcnt lgkmcnt(7)
  v_mfma_f32_32x32x16_bf16 a[0:15], v[72:75], v[68:71], a[0:15]
  ds_read_b128 v[100:103], v19 offset:32768
  ds_read_b64_tr_b16 v[104:105], v33 offset:20480
  ds_read_b64_tr_b16 v[106:107], v33 offset:20992
  v_mfma_f32_32x32x16_bf16 a[16:31], v[76:79], v[68:71], a[16:31]
  ds_read_b64_tr_b16 v[108:109], v33 offset:28672
  ds_read_b64_tr_b16 v[110:111], v33 offset:29184
  ds_read_b64_tr_b16 v[112:113], v32 offset:12288
  v_mfma_f32_32x32x16_bf16 a[32:47], v[68:71], v[80:83], a[32:47]
  ds_read_b64_tr_b16 v[114:115], v32 offset:12800
  s_waitcnt lgkmcnt(7)
  v_mfma_f32_32x32x16_bf16 a[0:15], v[88:91], v[84:87], a[0:15]
  ds_read_b128 v[116:119], v22 offset:32768
  ds_read_b64_tr_b16 v[120:121], v33 offset:22528
  ds_read_b64_tr_b16 v[122:123], v33 offset:23040
  v_mfma_f32_32x32x16_bf16 a[16:31], v[92:95], v[84:87], a[16:31]
  ds_read_b64_tr_b16 v[124:125], v33 offset:30720
  ds_read_b64_tr_b16 v[126:127], v33 offset:31232
  ds_read_b64_tr_b16 v[128:129], v32 offset:14336
  v_mfma_f32_32x32x16_bf16 a[32:47], v[84:87], v[96:99], a[32:47]
  ds_read_b64_tr_b16 v[130:131], v32 offset:14848
  s_barrier
  s_waitcnt lgkmcnt(7)
  v_mfma_f32_32x32x16_bf16 a[0:15], v[104:107], v[100:103], a[0:15]
  ds_read_b128 v[68:71], v13 offset:57344
  ds_read_b64_tr_b16 v[72:73], v33 offset:40960
  ds_read_b64_tr_b16 v[74:75], v33 offset:41472
  v_mfma_f32_32x32x16_bf16 a[16:31], v[108:111], v[100:103], a[16:31]
  ds_read_b64_tr_b16 v[76:77], v33 offset:49152
  ds_read_b64_tr_b16 v[78:79], v33 offset:49664
  ds_read_b64_tr_b16 v[80:81], v32 offset:16384
  v_mfma_f32_32x32x16_bf16 a[32:47], v[100:103], v[112:115], a[32:47]
  ds_read_b64_tr_b16 v[82:83], v32 offset:16896
  s_waitcnt lgkmcnt(7)
  v_mfma_f32_32x32x16_bf16 a[0:15], v[120:123], v[116:119], a[0:15]
  ds_read_b128 v[84:87], v16 offset:57344
  ds_read_b64_tr_b16 v[88:89], v33 offset:43008
  ds_read_b64_tr_b16 v[90:91], v33 offset:43520
  v_mfma_f32_32x32x16_bf16 a[16:31], v[124:127], v[116:119], a[16:31]
  ds_read_b64_tr_b16 v[92:93], v33 offset:51200
  ds_read_b64_tr_b16 v[94:95], v33 offset:51712
  ds_read_b64_tr_b16 v[96:97], v32 offset:18432
  v_mfma_f32_32x32x16_bf16 a[32:47], v[116:119], v[128:131], a[32:47]
  ds_read_b64_tr_b16 v[98:99], v32 offset:18944
  s_waitcnt lgkmcnt(7)
  v_mfma_f32_32x32x16_bf16 a[0:15], v[72:75], v[68:71], a[0:15]
  ds_read_b128 v[100:103], v19 offset:57344
  ds_read_b64_tr_b16 v[104:105], v33 offset:45056
  ds_read_b64_tr_b16 v[106:107], v33 offset:45568
  v_mfma_f32_32x32x16_bf16 a[16:31], v[76:79], v[68:71], a[16:31]
  ds_read_b64_tr_b16 v[108:109], v33 offset:53248
  ds_read_b64_tr_b16 v[110:111], v33 offset:53760
  ds_read_b64_tr_b16 v[112:113], v32 offset:20480
  v_mfma_f32_32x32x16_bf16 a[32:47], v[68:71], v[80:83], a[32:47]
  ds_read_b64_tr_b16 v[114:115], v32 offset:20992
  s_waitcnt lgkmcnt(7)
  v_mfma_f32_32x32x16_bf16 a[0:15], v[88:91], v[84:87], a[0:15]
  ds_read_b128 v[116:119], v22 offset:57344
  ds_read_b64_tr_b16 v[120:121], v33 offset:47104
  ds_read_b64_tr_b16 v[122:123], v33 offset:47616
  v_mfma_f32_32x32x16_bf16 a[16:31], v[92:95], v[84:87], a[16:31]
  ds_read_b64_tr_b16 v[124:125], v33 offset:55296
  ds_read_b64_tr_b16 v[126:127], v33 offset:55808
  ds_read_b64_tr_b16 v[128:129], v32 offset:22528
  v_mfma_f32_32x32x16_bf16 a[32:47], v[84:87], v[96:99], a[32:47]
  ds_read_b64_tr_b16 v[130:131], v32 offset:23040
  s_barrier
  s_waitcnt lgkmcnt(7)
  v_mfma_f32_32x32x16_bf16 a[0:15], v[104:107], v[100:103], a[0:15]
  ds_read_b128 v[68:71], v14 offset:8192
  ds_read_b64_tr_b16 v[72:73], v34 offset:0
  ds_read_b64_tr_b16 v[74:75], v34 offset:512
  v_mfma_f32_32x32x16_bf16 a[16:31], v[108:111], v[100:103], a[16:31]
  ds_read_b64_tr_b16 v[76:77], v34 offset:16384
  ds_read_b64_tr_b16 v[78:79], v34 offset:16896
  ds_read_b64_tr_b16 v[80:81], v32 offset:32768
  v_mfma_f32_32x32x16_bf16 a[32:47], v[100:103], v[112:115], a[32:47]
  ds_read_b64_tr_b16 v[82:83], v32 offset:33280
  s_waitcnt lgkmcnt(7)
  v_mfma_f32_32x32x16_bf16 a[0:15], v[120:123], v[116:119], a[0:15]
  ds_read_b128 v[84:87], v17 offset:8192
  ds_read_b64_tr_b16 v[88:89], v34 offset:2048
  ds_read_b64_tr_b16 v[90:91], v34 offset:2560
  v_mfma_f32_32x32x16_bf16 a[16:31], v[124:127], v[116:119], a[16:31]
  ds_read_b64_tr_b16 v[92:93], v34 offset:18432
  ds_read_b64_tr_b16 v[94:95], v34 offset:18944
  ds_read_b64_tr_b16 v[96:97], v32 offset:34816
  v_mfma_f32_32x32x16_bf16 a[32:47], v[116:119], v[128:131], a[32:47]
  ds_read_b64_tr_b16 v[98:99], v32 offset:35328
  s_waitcnt vmcnt(0)
  v_xor_b32 v1, s12, v154
  v_xor_b32 v2, s12, v158
  v_or_b32 v1, v1, v2
  v_xor_b32 v2, s12, v162
  v_or_b32 v1, v1, v2
  v_xor_b32 v2, s12, v166
  v_or_b32 v1, v1, v2
  v_xor_b32 v2, s12, v170
  v_or_b32 v1, v1, v2
  v_xor_b32 v2, s12, v174
  v_or_b32 v1, v1, v2
  v_xor_b32 v2, s12, v178
  v_or_b32 v1, v1, v2
  v_cmp_ne_u32 vcc, 0, v1
  s_nop 0
  s_cmp_eq_u64 vcc, 0
  s_cbranch_scc0 L_ss_59
L_sb_60:
  v_add_f32 v1, v152, v156
  v_add_f32 v2, v153, v157
  v_add_f32 v1, v1, v160
  v_add_f32 v2, v2, v161
  v_add_f32 v1, v1, v164
  v_add_f32 v2, v2, v165
  v_add_f32 v1, v1, v168
  v_add_f32 v2, v2, v169
  v_add_f32 v1, v1, v172
  v_add_f32 v2, v2, v173
  v_add_f32 v1, v1, v176
  v_add_f32 v2, v2, v177
  v_mov_b32 v3, v1
  s_nop 1
  v_permlane32_swap_b32 v3, v1
  v_add_f32 v1, v1, v3
  v_mov_b32 v4, v2
  s_nop 1
  v_permlane32_swap_b32 v4, v2
  v_add_f32 v2, v2, v4
  v_mul_f32 v1, 0x3a924925, v1
  v_mul_f32 v2, 0x3a924925, v2
  v_fma_f32 v2, -v1, v1, v2
  v_max_f32 v2, 0, v2
  v_add_f32 v2, 0x3727c5ac, v2
  v_rsq_f32 v2, v2
  s_nop 0
  v_mul_f32 v1, v1, v2
  v_lshlrev_b32 v3, 5, v5
  v_lshl_add_u32 v3, v6, 4, v3
  v_xor_b32 v4, 128, v3
  s_lshl_b32 s16, s9, 5
  s_add_u32 s16, s16, s8
  s_lshl_b32 s16, s16, 14
  s_lshl_b32 s17, s53, 13
  s_add_u32 s16, s16, s17
  s_lshl_b32 s17, s52, 10
  s_add_u32 s16, s16, s17
  s_add_u32 s16, s16, 7340032
  s_add_u32 s17, s16, 4096
  v_fma_f32 v36, v36, v2, -v1
  v_fma_f32 v37, v37, v2, -v1
  v_fma_f32 v38, v38, v2, -v1
  v_fma_f32 v39, v39, v2, -v1
  v_fma_f32 v40, v40, v2, -v1
  v_fma_f32 v41, v41, v2, -v1
  v_fma_f32 v42, v42, v2, -v1
  v_fma_f32 v43, v43, v2, -v1
  v_cvt_pk_bf16_f32 v152, v36, v37
  v_cvt_pk_bf16_f32 v153, v38, v39
  v_cvt_pk_bf16_f32 v154, v40, v41
  v_cvt_pk_bf16_f32 v155, v42, v43
  s_nop 0
  v_permlane32_swap_b32 v152, v154
  v_permlane32_swap_b32 v153, v155
  buffer_store_dwordx4 v[152:155], v3, s[80:83], s16 offen offset:0 sc1
  v_fma_f32 v44, v44, v2, -v1
  v_fma_f32 v45, v45, v2, -v1
  v_fma_f32 v46, v46, v2, -v1
  v_fma_f32 v47, v47, v2, -v1
  v_fma_f32 v48, v48, v2, -v1
  v_fma_f32 v49, v49, v2, -v1
  v_fma_f32 v50, v50, v2, -v1
  v_fma_f32 v51, v51, v2, -v1
  v_cvt_pk_bf16_f32 v156, v44, v45
  v_cvt_pk_bf16_f32 v157, v46, v47
  v_cvt_pk_bf16_f32 v158, v48, v49
  v_cvt_pk_bf16_f32 v159, v50, v51
  s_nop 0
  v_permlane32_swap_b32 v156, v158
  v_permlane32_swap_b32 v157, v159
  buffer_store_dwordx4 v[156:159], v4, s[80:83], s16 offen offset:2048 sc1
  v_fma_f32 v52, v52, v2, -v1
  v_fma_f32 v53, v53, v2, -v1
  v_fma_f32 v54, v54, v2, -v1
  v_fma_f32 v55, v55, v2, -v1
  v_fma_f32 v56, v56, v2, -v1
  v_fma_f32 v57, v57, v2, -v1
  v_fma_f32 v58, v58, v2, -v1
  v_fma_f32 v59, v59, v2, -v1
  v_cvt_pk_bf16_f32 v160, v52, v53
  v_cvt_pk_bf16_f32 v161, v54, v55
  v_cvt_pk_bf16_f32 v162, v56, v57
  v_cvt_pk_bf16_f32 v163, v58, v59
  s_nop 0
  v_permlane32_swap_b32 v160, v162
  v_permlane32_swap_b32 v161, v163
  buffer_store_dwordx4 v[160:163], v3, s[80:83], s17 offen offset:0 sc1
  v_fma_f32 v60, v60, v2, -v1
  v_fma_f32 v61, v61, v2, -v1
  v_fma_f32 v62, v62, v2, -v1
  v_fma_f32 v63, v63, v2, -v1
  v_fma_f32 v64, v64, v2, -v1
  v_fma_f32 v65, v65, v2, -v1
  v_fma_f32 v66, v66, v2, -v1
  v_fma_f32 v67, v67, v2, -v1
  v_cvt_pk_bf16_f32 v164, v60, v61
  v_cvt_pk_bf16_f32 v165, v62, v63
  v_cvt_pk_bf16_f32 v166, v64, v65
  v_cvt_pk_bf16_f32 v167, v66, v67
  s_nop 0
  v_permlane32_swap_b32 v164, v166
  v_permlane32_swap_b32 v165, v167
  buffer_store_dwordx4 v[164:167], v4, s[80:83], s17 offen offset:2048 sc1
  s_waitcnt lgkmcnt(7)
  v_mfma_f32_32x32x16_bf16 a[0:15], v[72:75], v[68:71], a[0:15]
  ds_read_b128 v[100:103], v20 offset:8192
  ds_read_b64_tr_b16 v[104:105], v34 offset:4096
  ds_read_b64_tr_b16 v[106:107], v34 offset:4608
  v_mfma_f32_32x32x16_bf16 a[16:31], v[76:79], v[68:71], a[16:31]
  ds_read_b64_tr_b16 v[108:109], v34 offset:20480
  ds_read_b64_tr_b16 v[110:111], v34 offset:20992
  ds_read_b64_tr_b16 v[112:113], v32 offset:36864
  v_mfma_f32_32x32x16_bf16 a[32:47], v[68:71], v[80:83], a[32:47]
  ds_read_b64_tr_b16 v[114:115], v32 offset:37376
  s_waitcnt lgkmcnt(7)
  v_mfma_f32_32x32x16_bf16 a[0:15], v[88:91], v[84:87], a[0:15]
  ds_read_b128 v[116:119], v23 offset:8192
  ds_read_b64_tr_b16 v[120:121], v34 offset:6144
  ds_read_b64_tr_b16 v[122:123], v34 offset:6656
  v_mfma_f32_32x32x16_bf16 a[16:31], v[92:95], v[84:87], a[16:31]
  ds_read_b64_tr_b16 v[124:125], v34 offset:22528
  ds_read_b64_tr_b16 v[126:127], v34 offset:23040
  ds_read_b64_tr_b16 v[128:129], v32 offset:38912
  v_mfma_f32_32x32x16_bf16 a[32:47], v[84:87], v[96:99], a[32:47]
  ds_read_b64_tr_b16 v[130:131], v32 offset:39424
  s_barrier
  s_waitcnt lgkmcnt(7)
  v_mfma_f32_32x32x16_bf16 a[0:15], v[104:107], v[100:103], a[0:15]
  ds_read_b128 v[68:71], v12 offset:57344
  ds_read_b64_tr_b16 v[72:73], v32 offset:40960
  ds_read_b64_tr_b16 v[74:75], v32 offset:41472
  v_mfma_f32_32x32x16_bf16 a[16:31], v[108:111], v[100:103], a[16:31]
  ds_read_b64_tr_b16 v[76:77], v33 offset:0
  ds_read_b64_tr_b16 v[78:79], v33 offset:512
  ds_read_b64_tr_b16 v[80:81], v32 offset:8192
  v_mfma_f32_32x32x16_bf16 a[32:47], v[100:103], v[112:115], a[32:47]
  ds_read_b64_tr_b16 v[82:83], v32 offset:8704
  s_waitcnt lgkmcnt(7)
  v_mfma_f32_32x32x16_bf16 a[0:15], v[120:123], v[116:119], a[0:15]
  ds_read_b128 v[84:87], v15 offset:57344
  ds_read_b64_tr_b16 v[88:89], v32 offset:43008
  ds_read_b64_tr_b16 v[90:91], v32 offset:43520
  v_mfma_f32_32x32x16_bf16 a[16:31], v[124:127], v[116:119], a[16:31]
  ds_read_b64_tr_b16 v[92:93], v33 offset:2048
  ds_read_b64_tr_b16 v[94:95], v33 offset:2560
  ds_read_b64_tr_b16 v[96:97], v32 offset:10240
  v_mfma_f32_32x32x16_bf16 a[32:47], v[116:119], v[128:131], a[32:47]
  ds_read_b64_tr_b16 v[98:99], v32 offset:10752
  s_waitcnt lgkmcnt(7)
  v_mfma_f32_32x32x16_bf16 a[0:15], v[72:75], v[68:71], a[0:15]
  ds_read_b128 v[100:103], v18 offset:57344
  ds_read_b64_tr_b16 v[104:105], v32 offset:45056
  ds_read_b64_tr_b16 v[106:107], v32 offset:45568
  v_mfma_f32_32x32x16_bf16 a[16:31], v[76:79], v[68:71], a[16:31]
  ds_read_b64_tr_b16 v[108:109], v33 offset:4096
  ds_read_b64_tr_b16 v[110:111], v33 offset:4608
  ds_read_b64_tr_b16 v[112:113], v32 offset:12288
  v_mfma_f32_32x32x16_bf16 a[32:47], v[68:71], v[80:83], a[32:47]
  ds_read_b64_tr_b16 v[114:115], v32 offset:12800
  s_waitcnt lgkmcnt(7)
  v_mfma_f32_32x32x16_bf16 a[0:15], v[88:91], v[84:87], a[0:15]
  ds_read_b128 v[116:119], v21 offset:57344
  ds_read_b64_tr_b16 v[120:121], v32 offset:47104
  ds_read_b64_tr_b16 v[122:123], v32 offset:47616
  v_mfma_f32_32x32x16_bf16 a[16:31], v[92:95], v[84:87], a[16:31]
  ds_read_b64_tr_b16 v[124:125], v33 offset:6144
  ds_read_b64_tr_b16 v[126:127], v33 offset:6656
  ds_read_b64_tr_b16 v[128:129], v32 offset:14336
  v_mfma_f32_32x32x16_bf16 a[32:47], v[84:87], v[96:99], a[32:47]
  ds_read_b64_tr_b16 v[130:131], v32 offset:14848
  s_waitcnt vmcnt(0)
  s_barrier
  s_mul_i32 s54, s8, 8
  s_add_u32 s54, s54, s9
  s_lshl_b32 s54, s54, 7
  s_add_u32 s54, s54, 4096
  s_cmp_eq_u32 s3, 0
  s_cselect_b32 exec_lo, 1, 0
  s_mov_b32 exec_hi, 0
  buffer_store_dword v7, v8, s[56:59], s54 offen sc1
  s_mov_b64 exec, -1
  s_waitcnt lgkmcnt(7)
  v_mfma_f32_32x32x16_bf16 a[0:15], v[104:107], v[100:103], a[0:15]
  ds_read_b128 v[68:71], v12 offset:0
  ds_read_b64_tr_b16 v[72:73], v27 offset:16384
  v_mfma_f32_32x32x16_bf16 a[16:31], v[108:111], v[100:103], a[16:31]
  ds_read_b64_tr_b16 v[74:75], v27 offset:17408
  ds_read_b64_tr_b16 v[76:77], v30 offset:16384
  v_mfma_f32_32x32x16_bf16 a[32:47], v[100:103], v[112:115], a[32:47]
  ds_read_b64_tr_b16 v[78:79], v30 offset:17408
  s_waitcnt lgkmcnt(5)
  v_mfma_f32_32x32x16_bf16 a[0:15], v[120:123], v[116:119], a[0:15]
  ds_read_b128 v[84:87], v15 offset:0
  ds_read_b64_tr_b16 v[88:89], v27 offset:20480
  v_mfma_f32_32x32x16_bf16 a[16:31], v[124:127], v[116:119], a[16:31]
  ds_read_b64_tr_b16 v[90:91], v27 offset:21504
  ds_read_b64_tr_b16 v[92:93], v30 offset:20480
  v_mfma_f32_32x32x16_bf16 a[32:47], v[116:119], v[128:131], a[32:47]
  ds_read_b64_tr_b16 v[94:95], v30 offset:21504
  s_lshl_b32 s14, s9, 1
  s_add_u32 s14, s14, s53
  s_lshl_b32 s14, s14, 17
  s_lshl_b32 s15, s8, 11
  s_add_u32 s14, s14, s15
  s_lshl_b32 s15, s52, 10
  s_add_u32 s14, s14, s15
  v_lshlrev_b32 v1, 5, v5
  v_lshl_add_u32 v1, v6, 4, v1
  v_lshrrev_b32 v2, 3, v5
  v_and_b32 v2, 1, v2
  v_lshlrev_b32 v2, 4, v2
  v_xor_b32 v2, v2, v1
  v_and_b32 v3, 15, v5
  v_lshrrev_b32 v4, 3, v3
  v_xor_b32 v4, v4, v6
  v_lshlrev_b32 v4, 4, v4
  v_lshl_add_u32 v4, v3, 5, v4
  v_lshrrev_b32 v3, 4, v5
  v_lshl_add_u32 v3, v3, 16, v4
  v_accvgpr_read_b32 v164, a16
  v_accvgpr_read_b32 v165, a17
  v_accvgpr_read_b32 v166, a18
  v_accvgpr_read_b32 v167, a19
  v_accvgpr_read_b32 v168, a20
  v_accvgpr_read_b32 v169, a21
  v_accvgpr_read_b32 v170, a22
  v_accvgpr_read_b32 v171, a23
  v_cvt_pk_bf16_f32 v152, v164, v165
  v_cvt_pk_bf16_f32 v153, v166, v167
  v_cvt_pk_bf16_f32 v154, v168, v169
  v_cvt_pk_bf16_f32 v155, v170, v171
  s_nop 0
  v_permlane32_swap_b32 v152, v154
  v_permlane32_swap_b32 v153, v155
  s_add_u32 s15, s14, 3145728
  buffer_store_dwordx4 v[152:155], v2, s[56:59], s15 offen sc1
  v_accvgpr_read_b32 v172, a24
  v_accvgpr_read_b32 v173, a25
  v_accvgpr_read_b32 v174, a26
  v_accvgpr_read_b32 v175, a27
  v_accvgpr_read_b32 v176, a28
  v_accvgpr_read_b32 v177, a29
  v_accvgpr_read_b32 v178, a30
  v_accvgpr_read_b32 v179, a31
  v_cvt_pk_bf16_f32 v156, v172, v173
  v_cvt_pk_bf16_f32 v157, v174, v175
  v_cvt_pk_bf16_f32 v158, v176, v177
  v_cvt_pk_bf16_f32 v159, v178, v179
  s_nop 0
  v_permlane32_swap_b32 v156, v158
  v_permlane32_swap_b32 v157, v159
  s_add_u32 s15, s14, 3211264
  buffer_store_dwordx4 v[156:159], v2, s[56:59], s15 offen sc1
  s_add_u32 s16, s14, 5242880
  v_accvgpr_read_b32 v164, a32
  v_accvgpr_read_b32 v165, a33
  v_accvgpr_read_b32 v166, a34
  v_accvgpr_read_b32 v167, a35
  v_accvgpr_read_b32 v168, a36
  v_accvgpr_read_b32 v169, a37
  v_accvgpr_read_b32 v170, a38
  v_accvgpr_read_b32 v171, a39
  v_cvt_pk_bf16_f32 v160, v164, v165
  v_cvt_pk_bf16_f32 v161, v166, v167
  v_cvt_pk_bf16_f32 v162, v168, v169
  v_cvt_pk_bf16_f32 v163, v170, v171
  buffer_store_dwordx4 v[160:163], v3, s[56:59], s16 offen offset:0 sc1
  v_accvgpr_read_b32 v172, a40
  v_accvgpr_read_b32 v173, a41
  v_accvgpr_read_b32 v174, a42
  v_accvgpr_read_b32 v175, a43
  v_accvgpr_read_b32 v176, a44
  v_accvgpr_read_b32 v177, a45
  v_accvgpr_read_b32 v178, a46
  v_accvgpr_read_b32 v179, a47
  v_cvt_pk_bf16_f32 v152, v172, v173
  v_cvt_pk_bf16_f32 v153, v174, v175
  v_cvt_pk_bf16_f32 v154, v176, v177
  v_cvt_pk_bf16_f32 v155, v178, v179
  buffer_store_dwordx4 v[152:155], v3, s[56:59], s16 offen offset:512 sc1
  v_accvgpr_read_b32 v164, a0
  v_accvgpr_read_b32 v165, a1
  v_accvgpr_read_b32 v166, a2
  v_accvgpr_read_b32 v167, a3
  v_accvgpr_read_b32 v168, a4
  v_accvgpr_read_b32 v169, a5
  v_accvgpr_read_b32 v170, a6
  v_accvgpr_read_b32 v171, a7
  v_mul_f32 v164, 0x3eb8aa3b, v164
  v_mul_f32 v165, 0x3eb8aa3b, v165
  v_mul_f32 v166, 0x3eb8aa3b, v166
  v_mul_f32 v167, 0x3eb8aa3b, v167
  v_mul_f32 v168, 0x3eb8aa3b, v168
  v_mul_f32 v169, 0x3eb8aa3b, v169
  v_mul_f32 v170, 0x3eb8aa3b, v170
  v_mul_f32 v171, 0x3eb8aa3b, v171
  v_cvt_pk_bf16_f32 v156, v164, v165
  v_cvt_pk_bf16_f32 v157, v166, v167
  v_cvt_pk_bf16_f32 v158, v168, v169
  v_cvt_pk_bf16_f32 v159, v170, v171
  s_nop 0
  v_permlane32_swap_b32 v156, v158
  v_permlane32_swap_b32 v157, v159
  s_add_u32 s15, s14, 1048576
  buffer_store_dwordx4 v[156:159], v1, s[56:59], s15 offen sc1
  v_accvgpr_read_b32 v172, a8
  v_accvgpr_read_b32 v173, a9
  v_accvgpr_read_b32 v174, a10
  v_accvgpr_read_b32 v175, a11
  v_accvgpr_read_b32 v176, a12
  v_accvgpr_read_b32 v177, a13
  v_accvgpr_read_b32 v178, a14
  v_accvgpr_read_b32 v179, a15
  v_mul_f32 v172, 0x3eb8aa3b, v172
  v_mul_f32 v173, 0x3eb8aa3b, v173
  v_mul_f32 v174, 0x3eb8aa3b, v174
  v_mul_f32 v175, 0x3eb8aa3b, v175
  v_mul_f32 v176, 0x3eb8aa3b, v176
  v_mul_f32 v177, 0x3eb8aa3b, v177
  v_mul_f32 v178, 0x3eb8aa3b, v178
  v_mul_f32 v179, 0x3eb8aa3b, v179
  v_cvt_pk_bf16_f32 v160, v172, v173
  v_cvt_pk_bf16_f32 v161, v174, v175
  v_cvt_pk_bf16_f32 v162, v176, v177
  v_cvt_pk_bf16_f32 v163, v178, v179
  s_nop 0
  v_permlane32_swap_b32 v160, v162
  v_permlane32_swap_b32 v161, v163
  s_add_u32 s15, s14, 1114112
  buffer_store_dwordx4 v[160:163], v1, s[56:59], s15 offen sc1
  s_waitcnt lgkmcnt(5)
  v_mfma_f32_32x32x16_bf16 a[0:15], v[72:75], v[68:71], 0
  ds_read_b128 v[100:103], v18 offset:0
  ds_read_b64_tr_b16 v[104:105], v27 offset:24576
  ds_read_b64_tr_b16 v[106:107], v27 offset:25600
  v_mfma_f32_32x32x16_bf16 a[16:31], v[76:79], v[68:71], 0
  ds_read_b64_tr_b16 v[108:109], v30 offset:24576
  ds_read_b64_tr_b16 v[110:111], v30 offset:25600
  s_waitcnt lgkmcnt(5)
  v_mfma_f32_32x32x16_bf16 a[0:15], v[88:91], v[84:87], a[0:15]
  ds_read_b128 v[116:119], v21 offset:0
  ds_read_b64_tr_b16 v[120:121], v27 offset:28672
  ds_read_b64_tr_b16 v[122:123], v27 offset:29696
  v_mfma_f32_32x32x16_bf16 a[16:31], v[92:95], v[84:87], a[16:31]
  ds_read_b64_tr_b16 v[124:125], v30 offset:28672
  ds_read_b64_tr_b16 v[126:127], v30 offset:29696
  s_barrier
  s_waitcnt lgkmcnt(5)
  v_mfma_f32_32x32x16_bf16 a[0:15], v[104:107], v[100:103], a[0:15]
  ds_read_b128 v[68:71], v12 offset:24576
  ds_read_b64_tr_b16 v[72:73], v26 offset:16384
  ds_read_b64_tr_b16 v[74:75], v26 offset:17408
  v_mfma_f32_32x32x16_bf16 a[16:31], v[108:111], v[100:103], a[16:31]
  ds_read_b64_tr_b16 v[76:77], v29 offset:16384
  ds_read_b64_tr_b16 v[78:79], v29 offset:17408
  s_waitcnt lgkmcnt(5)
  v_mfma_f32_32x32x16_bf16 a[0:15], v[120:123], v[116:119], a[0:15]
  ds_read_b128 v[84:87], v15 offset:24576
  ds_read_b64_tr_b16 v[88:89], v26 offset:20480
  ds_read_b64_tr_b16 v[90:91], v26 offset:21504
  v_mfma_f32_32x32x16_bf16 a[16:31], v[124:127], v[116:119], a[16:31]
  ds_read_b64_tr_b16 v[92:93], v29 offset:20480
  ds_read_b64_tr_b16 v[94:95], v29 offset:21504
  s_waitcnt lgkmcnt(5)
  v_mfma_f32_32x32x16_bf16 a[0:15], v[72:75], v[68:71], a[0:15]
  ds_read_b128 v[100:103], v18 offset:24576
  ds_read_b64_tr_b16 v[104:105], v27 offset:40960
  ds_read_b64_tr_b16 v[106:107], v27 offset:41984
  v_mfma_f32_32x32x16_bf16 a[16:31], v[76:79], v[68:71], a[16:31]
  ds_read_b64_tr_b16 v[108:109], v30 offset:40960
  ds_read_b64_tr_b16 v[110:111], v30 offset:41984
  s_waitcnt lgkmcnt(5)
  v_mfma_f32_32x32x16_bf16 a[0:15], v[88:91], v[84:87], a[0:15]
  ds_read_b128 v[116:119], v21 offset:24576
  ds_read_b64_tr_b16 v[120:121], v27 offset:45056
  ds_read_b64_tr_b16 v[122:123], v27 offset:46080
  v_mfma_f32_32x32x16_bf16 a[16:31], v[92:95], v[84:87], a[16:31]
  ds_read_b64_tr_b16 v[124:125], v30 offset:45056
  ds_read_b64_tr_b16 v[126:127], v30 offset:46080
  v_lshrrev_b32 v1, 4, v0
  v_and_b32 v1, 1, v1
  v_and_b32 v2, 3, v0
  v_lshlrev_b32 v2, 3, v2
  v_lshl_add_u32 v2, v1, 11, v2
  s_lshl_b32 s54, s53, 13
  v_add_u32 v2, s54, v2
  v_xor_b32 v3, 0, v1
  v_lshlrev_b32 v3, 2, v3
  v_add_u32 v3, v3, v24
  v_lshl_add_u32 v35, v3, 5, v2
  v_add_u32 v138, 0x10000, v35
  v_add_u32 v139, 0x20000, v35
  v_xor_b32 v3, 1, v1
  v_lshlrev_b32 v3, 2, v3
  v_add_u32 v3, v3, v24
  v_lshl_add_u32 v140, v3, 5, v2
  v_add_u32 v141, 0x10000, v140
  v_add_u32 v142, 0x20000, v140
  v_lshrrev_b32 v1, 3, v5
  v_and_b32 v1, 1, v1
  v_xor_b32 v1, v1, v6
  v_lshlrev_b32 v1, 4, v1
  v_lshl_add_u32 v1, v5, 5, v1
  s_lshl_b32 s54, s52, 10
  v_add_u32 v144, s54, v1
  v_add_u32 v145, 0x10000, v144
  v_add_u32 v146, 0x20000, v144
  s_waitcnt vmcnt(0)
  s_barrier
  s_mul_i32 s54, s8, 8
  s_add_u32 s54, s54, s9
  s_lshl_b32 s54, s54, 7
  s_add_u32 s54, s54, 36864
  s_cmp_eq_u32 s3, 0
  s_cselect_b32 exec_lo, 1, 0
  s_mov_b32 exec_hi, 0
  buffer_store_dword v7, v8, s[56:59], s54 offen sc1
  s_mov_b64 exec, -1
  s_waitcnt lgkmcnt(5)
  v_mfma_f32_32x32x16_bf16 a[0:15], v[104:107], v[100:103], a[0:15]
  ds_read_b128 v[68:71], v12 offset:49152
  ds_read_b64_tr_b16 v[72:73], v27 offset:49152
  ds_read_b64_tr_b16 v[74:75], v27 offset:50176
  v_mfma_f32_32x32x16_bf16 a[16:31], v[108:111], v[100:103], a[16:31]
  ds_read_b64_tr_b16 v[76:77], v30 offset:49152
  ds_read_b64_tr_b16 v[78:79], v30 offset:50176
  s_waitcnt lgkmcnt(5)
  v_mfma_f32_32x32x16_bf16 a[0:15], v[120:123], v[116:119], a[0:15]
  ds_read_b128 v[84:87], v15 offset:49152
  ds_read_b64_tr_b16 v[88:89], v27 offset:53248
  ds_read_b64_tr_b16 v[90:91], v27 offset:54272
  v_mfma_f32_32x32x16_bf16 a[16:31], v[124:127], v[116:119], a[16:31]
  ds_read_b64_tr_b16 v[92:93], v30 offset:53248
  ds_read_b64_tr_b16 v[94:95], v30 offset:54272
  s_waitcnt lgkmcnt(5)
  v_mfma_f32_32x32x16_bf16 a[0:15], v[72:75], v[68:71], a[0:15]
  ds_read_b128 v[100:103], v18 offset:49152
  ds_read_b64_tr_b16 v[104:105], v26 offset:32768
  ds_read_b64_tr_b16 v[106:107], v26 offset:33792
  v_mfma_f32_32x32x16_bf16 a[16:31], v[76:79], v[68:71], a[16:31]
  ds_read_b64_tr_b16 v[108:109], v29 offset:32768
  ds_read_b64_tr_b16 v[110:111], v29 offset:33792
  s_waitcnt lgkmcnt(5)
  v_mfma_f32_32x32x16_bf16 a[0:15], v[88:91], v[84:87], a[0:15]
  ds_read_b128 v[116:119], v21 offset:49152
  ds_read_b64_tr_b16 v[120:121], v26 offset:36864
  ds_read_b64_tr_b16 v[122:123], v26 offset:37888
  v_mfma_f32_32x32x16_bf16 a[16:31], v[92:95], v[84:87], a[16:31]
  ds_read_b64_tr_b16 v[124:125], v29 offset:36864
  ds_read_b64_tr_b16 v[126:127], v29 offset:37888
  s_barrier
  s_waitcnt lgkmcnt(5)
  v_mfma_f32_32x32x16_bf16 a[0:15], v[104:107], v[100:103], a[0:15]
  ds_read_b128 v[68:71], v13 offset:8192
  ds_read_b64_tr_b16 v[72:73], v28 offset:0
  ds_read_b64_tr_b16 v[74:75], v28 offset:1024
  v_mfma_f32_32x32x16_bf16 a[16:31], v[108:111], v[100:103], a[16:31]
  ds_read_b64_tr_b16 v[76:77], v31 offset:0
  ds_read_b64_tr_b16 v[78:79], v31 offset:1024
  s_waitcnt lgkmcnt(5)
  v_mfma_f32_32x32x16_bf16 a[0:15], v[120:123], v[116:119], a[0:15]
  ds_read_b128 v[84:87], v16 offset:8192
  ds_read_b64_tr_b16 v[88:89], v28 offset:4096
  ds_read_b64_tr_b16 v[90:91], v28 offset:5120
  v_mfma_f32_32x32x16_bf16 a[16:31], v[124:127], v[116:119], a[16:31]
  ds_read_b64_tr_b16 v[92:93], v31 offset:4096
  ds_read_b64_tr_b16 v[94:95], v31 offset:5120
  s_waitcnt lgkmcnt(5)
  v_mfma_f32_32x32x16_bf16 a[0:15], v[72:75], v[68:71], a[0:15]
  ds_read_b128 v[100:103], v19 offset:8192
  ds_read_b64_tr_b16 v[104:105], v28 offset:16384
  ds_read_b64_tr_b16 v[106:107], v28 offset:17408
  v_mfma_f32_32x32x16_bf16 a[16:31], v[76:79], v[68:71], a[16:31]
  ds_read_b64_tr_b16 v[108:109], v31 offset:16384
  ds_read_b64_tr_b16 v[110:111], v31 offset:17408
  v_and_b32 v9, 31, v0
  v_lshlrev_b32 v9, 3, v9
  v_add_u32 v9, s9, v9
  v_lshlrev_b32 v9, 7, v9
  v_add_u32 v9, 4096, v9
  v_mov_b32 v10, v7
  s_cmp_eq_u32 s3, 0
  s_cselect_b32 exec_lo, -1, 0
  s_cselect_b32 exec_hi, -1, 0
  buffer_load_dword v10, v9, s[56:59], 0 offen sc1
  s_mov_b64 exec, -1
  s_waitcnt lgkmcnt(5)
  v_mfma_f32_32x32x16_bf16 a[0:15], v[88:91], v[84:87], a[0:15]
  ds_read_b128 v[116:119], v22 offset:8192
  ds_read_b64_tr_b16 v[120:121], v28 offset:20480
  ds_read_b64_tr_b16 v[122:123], v28 offset:21504
  v_mfma_f32_32x32x16_bf16 a[16:31], v[92:95], v[84:87], a[16:31]
  ds_read_b64_tr_b16 v[124:125], v31 offset:20480
  ds_read_b64_tr_b16 v[126:127], v31 offset:21504
  s_barrier
  s_waitcnt lgkmcnt(5)
  v_mfma_f32_32x32x16_bf16 a[0:15], v[104:107], v[100:103], a[0:15]
  ds_read_b128 v[68:71], v13 offset:32768
  ds_read_b64_tr_b16 v[72:73], v26 offset:8192
  ds_read_b64_tr_b16 v[74:75], v26 offset:9216
  v_mfma_f32_32x32x16_bf16 a[16:31], v[108:111], v[100:103], a[16:31]
  ds_read_b64_tr_b16 v[76:77], v29 offset:8192
  ds_read_b64_tr_b16 v[78:79], v29 offset:9216
  s_waitcnt lgkmcnt(5)
  v_mfma_f32_32x32x16_bf16 a[0:15], v[120:123], v[116:119], a[0:15]
  ds_read_b128 v[84:87], v16 offset:32768
  ds_read_b64_tr_b16 v[88:89], v26 offset:12288
  ds_read_b64_tr_b16 v[90:91], v26 offset:13312
  v_mfma_f32_32x32x16_bf16 a[16:31], v[124:127], v[116:119], a[16:31]
  ds_read_b64_tr_b16 v[92:93], v29 offset:12288
  ds_read_b64_tr_b16 v[94:95], v29 offset:13312
  s_waitcnt lgkmcnt(5)
  v_mfma_f32_32x32x16_bf16 a[0:15], v[72:75], v[68:71], a[0:15]
  ds_read_b128 v[100:103], v19 offset:32768
  ds_read_b64_tr_b16 v[104:105], v26 offset:40960
  ds_read_b64_tr_b16 v[106:107], v26 offset:41984
  v_mfma_f32_32x32x16_bf16 a[16:31], v[76:79], v[68:71], a[16:31]
  ds_read_b64_tr_b16 v[108:109], v29 offset:40960
  ds_read_b64_tr_b16 v[110:111], v29 offset:41984
  s_waitcnt lgkmcnt(5)
  v_mfma_f32_32x32x16_bf16 a[0:15], v[88:91], v[84:87], a[0:15]
  ds_read_b128 v[116:119], v22 offset:32768
  ds_read_b64_tr_b16 v[120:121], v26 offset:45056
  ds_read_b64_tr_b16 v[122:123], v26 offset:46080
  v_mfma_f32_32x32x16_bf16 a[16:31], v[92:95], v[84:87], a[16:31]
  ds_read_b64_tr_b16 v[124:125], v29 offset:45056
  ds_read_b64_tr_b16 v[126:127], v29 offset:46080
  s_barrier
  s_waitcnt lgkmcnt(5)
  v_mfma_f32_32x32x16_bf16 a[0:15], v[104:107], v[100:103], a[0:15]
  ds_read_b128 v[68:71], v13 offset:57344
  ds_read_b64_tr_b16 v[72:73], v27 offset:0
  ds_read_b64_tr_b16 v[74:75], v27 offset:1024
  v_mfma_f32_32x32x16_bf16 a[16:31], v[108:111], v[100:103], a[16:31]
  ds_read_b64_tr_b16 v[76:77], v30 offset:0
  ds_read_b64_tr_b16 v[78:79], v30 offset:1024
  s_waitcnt lgkmcnt(5)
  v_mfma_f32_32x32x16_bf16 a[0:15], v[120:123], v[116:119], a[0:15]
  ds_read_b128 v[84:87], v16 offset:57344
  ds_read_b64_tr_b16 v[88:89], v27 offset:4096
  ds_read_b64_tr_b16 v[90:91], v27 offset:5120
  v_mfma_f32_32x32x16_bf16 a[16:31], v[124:127], v[116:119], a[16:31]
  ds_read_b64_tr_b16 v[92:93], v30 offset:4096
  ds_read_b64_tr_b16 v[94:95], v30 offset:5120
  s_waitcnt lgkmcnt(5)
  v_mfma_f32_32x32x16_bf16 a[0:15], v[72:75], v[68:71], a[0:15]
  ds_read_b128 v[100:103], v19 offset:57344
  ds_read_b64_tr_b16 v[104:105], v26 offset:0
  ds_read_b64_tr_b16 v[106:107], v26 offset:1024
  v_mfma_f32_32x32x16_bf16 a[16:31], v[76:79], v[68:71], a[16:31]
  ds_read_b64_tr_b16 v[108:109], v29 offset:0
  ds_read_b64_tr_b16 v[110:111], v29 offset:1024
  s_waitcnt lgkmcnt(5)
  v_mfma_f32_32x32x16_bf16 a[0:15], v[88:91], v[84:87], a[0:15]
  ds_read_b128 v[116:119], v22 offset:57344
  ds_read_b64_tr_b16 v[120:121], v26 offset:4096
  ds_read_b64_tr_b16 v[122:123], v26 offset:5120
  v_mfma_f32_32x32x16_bf16 a[16:31], v[92:95], v[84:87], a[16:31]
  ds_read_b64_tr_b16 v[124:125], v29 offset:4096
  ds_read_b64_tr_b16 v[126:127], v29 offset:5120
  s_barrier
  s_waitcnt lgkmcnt(5)
  v_mfma_f32_32x32x16_bf16 a[0:15], v[104:107], v[100:103], a[0:15]
  ds_read_b128 v[68:71], v14 offset:8192
  ds_read_b64_tr_b16 v[72:73], v27 offset:16384
  ds_read_b64_tr_b16 v[74:75], v27 offset:17408
  v_mfma_f32_32x32x16_bf16 a[16:31], v[108:111], v[100:103], a[16:31]
  ds_read_b64_tr_b16 v[76:77], v30 offset:16384
  ds_read_b64_tr_b16 v[78:79], v30 offset:17408
  s_waitcnt lgkmcnt(5)
  v_mfma_f32_32x32x16_bf16 a[0:15], v[120:123], v[116:119], a[0:15]
  ds_read_b128 v[84:87], v17 offset:8192
  ds_read_b64_tr_b16 v[88:89], v27 offset:20480
  ds_read_b64_tr_b16 v[90:91], v27 offset:21504
  v_mfma_f32_32x32x16_bf16 a[16:31], v[124:127], v[116:119], a[16:31]
  ds_read_b64_tr_b16 v[92:93], v30 offset:20480
  ds_read_b64_tr_b16 v[94:95], v30 offset:21504
  s_waitcnt lgkmcnt(5)
  v_mfma_f32_32x32x16_bf16 a[0:15], v[72:75], v[68:71], a[0:15]
  ds_read_b128 v[100:103], v20 offset:8192
  ds_read_b64_tr_b16 v[104:105], v27 offset:24576
  ds_read_b64_tr_b16 v[106:107], v27 offset:25600
  v_mfma_f32_32x32x16_bf16 a[16:31], v[76:79], v[68:71], a[16:31]
  ds_read_b64_tr_b16 v[108:109], v30 offset:24576
  ds_read_b64_tr_b16 v[110:111], v30 offset:25600
  s_waitcnt lgkmcnt(5)
  v_mfma_f32_32x32x16_bf16 a[0:15], v[88:91], v[84:87], a[0:15]
  ds_read_b128 v[116:119], v23 offset:8192
  ds_read_b64_tr_b16 v[120:121], v27 offset:28672
  ds_read_b64_tr_b16 v[122:123], v27 offset:29696
  v_mfma_f32_32x32x16_bf16 a[16:31], v[92:95], v[84:87], a[16:31]
  ds_read_b64_tr_b16 v[124:125], v30 offset:28672
  ds_read_b64_tr_b16 v[126:127], v30 offset:29696
  s_waitcnt vmcnt(0)
  v_cmp_ne_u32 vcc, s12, v10
  s_nop 0
  s_cmp_eq_u64 vcc, 0
  s_cbranch_scc0 L_ps_62
L_pb_63:
  s_barrier
  s_waitcnt lgkmcnt(5)
  v_mfma_f32_32x32x16_bf16 a[0:15], v[104:107], v[100:103], a[0:15]
  ds_read_b128 v[68:71], v12 offset:57344
  ds_read_b64_tr_b16 v[72:73], v27 offset:40960
  ds_read_b64_tr_b16 v[74:75], v27 offset:41984
  v_mfma_f32_32x32x16_bf16 a[16:31], v[108:111], v[100:103], a[16:31]
  ds_read_b64_tr_b16 v[76:77], v30 offset:40960
  ds_read_b64_tr_b16 v[78:79], v30 offset:41984
  s_waitcnt lgkmcnt(5)
  v_mfma_f32_32x32x16_bf16 a[0:15], v[120:123], v[116:119], a[0:15]
  ds_read_b128 v[84:87], v15 offset:57344
  ds_read_b64_tr_b16 v[88:89], v27 offset:45056
  ds_read_b64_tr_b16 v[90:91], v27 offset:46080
  v_mfma_f32_32x32x16_bf16 a[16:31], v[124:127], v[116:119], a[16:31]
  ds_read_b64_tr_b16 v[92:93], v30 offset:45056
  ds_read_b64_tr_b16 v[94:95], v30 offset:46080
  s_waitcnt lgkmcnt(5)
  v_mfma_f32_32x32x16_bf16 a[0:15], v[72:75], v[68:71], a[0:15]
  ds_read_b128 v[100:103], v18 offset:57344
  ds_read_b64_tr_b16 v[104:105], v26 offset:49152
  ds_read_b64_tr_b16 v[106:107], v26 offset:50176
  v_mfma_f32_32x32x16_bf16 a[16:31], v[76:79], v[68:71], a[16:31]
  ds_read_b64_tr_b16 v[108:109], v29 offset:49152
  ds_read_b64_tr_b16 v[110:111], v29 offset:50176
  s_waitcnt lgkmcnt(5)
  v_mfma_f32_32x32x16_bf16 a[0:15], v[88:91], v[84:87], a[0:15]
  ds_read_b128 v[116:119], v21 offset:57344
  ds_read_b64_tr_b16 v[120:121], v26 offset:53248
  ds_read_b64_tr_b16 v[122:123], v26 offset:54272
  v_mfma_f32_32x32x16_bf16 a[16:31], v[92:95], v[84:87], a[16:31]
  ds_read_b64_tr_b16 v[124:125], v29 offset:53248
  ds_read_b64_tr_b16 v[126:127], v29 offset:54272
  s_barrier
  s_waitcnt lgkmcnt(5)
  v_mfma_f32_32x32x16_bf16 a[0:15], v[104:107], v[100:103], a[0:15]
  ds_read_b128 v[68:71], v12 offset:16384
  ds_read_b64_tr_b16 v[72:73], v35 offset:0
  ds_read_b64_tr_b16 v[74:75], v140 offset:0
  v_mfma_f32_32x32x16_bf16 a[16:31], v[108:111], v[100:103], a[16:31]
  ds_read_b64_tr_b16 v[76:77], v35 offset:4096
  ds_read_b64_tr_b16 v[78:79], v140 offset:4096
  s_mov_b32 s20, s84
  s_mov_b32 s21, s85
  s_and_b32 s22, s13, 8388608
  s_mov_b32 s23, 0x20000
  s_lshl_b32 s14, s3, 11
  v_lshrrev_b32 v1, 3, v0
  s_lshl_b32 s54, s3, 4
  v_add_u32 v1, s54, v1
  v_lshlrev_b32 v1, 12, v1
  v_lshrrev_b32 v2, 4, v0
  v_and_b32 v3, 7, v0
  v_xor_b32 v2, v2, v3
  v_lshl_add_u32 v26, v2, 4, v1
  v_xor_b32 v2, 4, v2
  v_lshl_add_u32 v27, v2, 4, v1
  v_add_u32 v27, 31744, v27
  v_lshlrev_b32 v28, 4, v0
  s_lshl_b32 s16, s8, 18
  s_lshl_b32 s17, s9, 19
  s_add_u32 s17, s17, s14
  s_add_u32 s17, s17, 7340032
  s_and_b32 s18, s8, 7
  s_mul_i32 s18, s18, 0
  s_and_b32 s54, s9, 3
  s_mul_i32 s54, s54, 0
  s_add_u32 s18, s18, s54
  s_add_u32 s18, s18, 2
  s_and_b32 s18, s18, 31
  s_and_b32 s19, s8, 7
  s_mul_i32 s19, s19, 0
  s_and_b32 s54, s9, 3
  s_mul_i32 s54, s54, 0
  s_add_u32 s19, s19, s54
  s_add_u32 s19, s19, 1
  s_and_b32 s19, s19, 31
  s_waitcnt lgkmcnt(5)
  v_mfma_f32_32x32x16_bf16 a[0:15], v[120:123], v[116:119], a[0:15]
  ds_read_b128 v[84:87], v15 offset:16384
  ds_read_b64_tr_b16 v[88:89], v35 offset:512
  ds_read_b64_tr_b16 v[90:91], v140 offset:512
  v_mfma_f32_32x32x16_bf16 a[16:31], v[124:127], v[116:119], a[16:31]
  ds_read_b64_tr_b16 v[92:93], v35 offset:4608
  ds_read_b64_tr_b16 v[94:95], v140 offset:4608
L_C_gentry:
  s_waitcnt lgkmcnt(5)
  v_mfma_f32_32x32x16_bf16 a[32:47], v[72:75], v[68:71], 0
  ds_read_b128 v[100:103], v18 offset:16384
  ds_read_b64_tr_b16 v[104:105], v35 offset:1024
  ds_read_b64_tr_b16 v[106:107], v140 offset:1024
  v_mfma_f32_32x32x16_bf16 a[48:63], v[76:79], v[68:71], 0
  ds_read_b64_tr_b16 v[108:109], v35 offset:5120
  ds_read_b64_tr_b16 v[110:111], v140 offset:5120
  v_accvgpr_read_b32 v36, a0
  v_mul_f32 v143, v36, v36
  v_fma_f32 v143, v143, v134, v132
  v_mul_f32 v143, v143, v36
  v_exp_f32 v143, v143
  s_waitcnt lgkmcnt(5)
  v_mfma_f32_32x32x16_bf16 a[32:47], v[88:91], v[84:87], a[32:47]
  ds_read_b128 v[116:119], v21 offset:16384
  ds_read_b64_tr_b16 v[120:121], v35 offset:1536
  ds_read_b64_tr_b16 v[122:123], v140 offset:1536
  v_mfma_f32_32x32x16_bf16 a[48:63], v[92:95], v[84:87], a[48:63]
  ds_read_b64_tr_b16 v[124:125], v35 offset:5632
  ds_read_b64_tr_b16 v[126:127], v140 offset:5632
  v_add_f32 v143, 1.0, v143
  v_rcp_f32 v143, v143
  s_nop 0
  v_mul_f32 v36, v36, v143
  s_cmp_eq_u32 s9, 7
  s_cbranch_scc1 L_pf_65
L_pfb_66:
  s_barrier
  s_waitcnt lgkmcnt(5)
  v_mfma_f32_32x32x16_bf16 a[32:47], v[104:107], v[100:103], a[32:47]
  ds_read_b128 v[68:71], v12 offset:40960
  ds_read_b64_tr_b16 v[72:73], v35 offset:24576
  ds_read_b64_tr_b16 v[74:75], v140 offset:24576
  v_mfma_f32_32x32x16_bf16 a[48:63], v[108:111], v[100:103], a[48:63]
  ds_read_b64_tr_b16 v[76:77], v35 offset:28672
  ds_read_b64_tr_b16 v[78:79], v140 offset:28672
  v_accvgpr_read_b32 v37, a1
  v_mul_f32 v143, v37, v37
  v_fma_f32 v143, v143, v134, v132
  v_mul_f32 v143, v143, v37
  v_exp_f32 v143, v143
  s_add_u32 s19, s19, 1
  s_and_b32 s19, s19, 31
  s_add_u32 m0, s14, 49152
  s_lshl_b32 s15, s19, 14
  s_add_u32 s15, s15, s17
  buffer_load_dwordx4 v28, s[80:83], s15 offen sc1 lds
  buffer_load_dwordx4 v28, s[80:83], s15 offen offset:1024 sc1 lds
  s_add_u32 m0, s14, 57344
  s_lshl_b32 s15, s19, 14
  s_add_u32 s15, s15, s17
  s_add_u32 s15, s15, 8192
  buffer_load_dwordx4 v28, s[80:83], s15 offen sc1 lds
  s_waitcnt lgkmcnt(5)
  v_mfma_f32_32x32x16_bf16 a[32:47], v[120:123], v[116:119], a[32:47]
  ds_read_b128 v[84:87], v15 offset:40960
  ds_read_b64_tr_b16 v[88:89], v35 offset:25088
  ds_read_b64_tr_b16 v[90:91], v140 offset:25088
  v_mfma_f32_32x32x16_bf16 a[48:63], v[124:127], v[116:119], a[48:63]
  ds_read_b64_tr_b16 v[92:93], v35 offset:29184
  ds_read_b64_tr_b16 v[94:95], v140 offset:29184
  v_add_f32 v143, 1.0, v143
  v_rcp_f32 v143, v143
  s_nop 0
  v_mul_f32 v37, v37, v143
  buffer_load_dwordx4 v28, s[80:83], s15 offen offset:1024 sc1 lds
  s_add_u32 s18, s18, 1
  s_and_b32 s18, s18, 31
  s_add_u32 m0, s14, 90112
  s_lshl_b32 s15, s18, 7
  s_add_u32 s15, s15, s16
  buffer_load_dwordx4 v26, s[20:23], s15 offen lds
  buffer_load_dwordx4 v27, s[20:23], s15 offen offset:1024 lds
  s_waitcnt lgkmcnt(5)
  v_mfma_f32_32x32x16_bf16 a[32:47], v[72:75], v[68:71], a[32:47]
  ds_read_b128 v[100:103], v18 offset:40960
  ds_read_b64_tr_b16 v[104:105], v35 offset:25600
  ds_read_b64_tr_b16 v[106:107], v140 offset:25600
  v_mfma_f32_32x32x16_bf16 a[48:63], v[76:79], v[68:71], a[48:63]
  ds_read_b64_tr_b16 v[108:109], v35 offset:29696
  ds_read_b64_tr_b16 v[110:111], v140 offset:29696
  v_accvgpr_read_b32 v38, a2
  v_mul_f32 v143, v38, v38
  v_fma_f32 v143, v143, v134, v132
  v_mul_f32 v143, v143, v38
  v_exp_f32 v143, v143
  s_add_u32 s19, s19, 1
  s_and_b32 s19, s19, 31
  s_add_u32 m0, s14, 73728
  s_lshl_b32 s15, s19, 14
  s_add_u32 s15, s15, s17
  buffer_load_dwordx4 v28, s[80:83], s15 offen sc1 lds
  buffer_load_dwordx4 v28, s[80:83], s15 offen offset:1024 sc1 lds
  s_add_u32 m0, s14, 81920
  s_lshl_b32 s15, s19, 14
  s_add_u32 s15, s15, s17
  s_add_u32 s15, s15, 8192
  buffer_load_dwordx4 v28, s[80:83], s15 offen sc1 lds
  s_waitcnt lgkmcnt(5)
  v_mfma_f32_32x32x16_bf16 a[32:47], v[88:91], v[84:87], a[32:47]
  ds_read_b128 v[116:119], v21 offset:40960
  ds_read_b64_tr_b16 v[120:121], v35 offset:26112
  ds_read_b64_tr_b16 v[122:123], v140 offset:26112
  v_mfma_f32_32x32x16_bf16 a[48:63], v[92:95], v[84:87], a[48:63]
  ds_read_b64_tr_b16 v[124:125], v35 offset:30208
  ds_read_b64_tr_b16 v[126:127], v140 offset:30208
  v_add_f32 v143, 1.0, v143
  v_rcp_f32 v143, v143
  s_nop 0
  v_mul_f32 v38, v38, v143
  buffer_load_dwordx4 v28, s[80:83], s15 offen offset:1024 sc1 lds
  s_cmp_eq_u32 s9, 7
  s_cbranch_scc1 L_pf_69
L_pfb_70:
  s_waitcnt vmcnt(6)
  s_barrier
  s_waitcnt lgkmcnt(5)
  v_mfma_f32_32x32x16_bf16 a[32:47], v[104:107], v[100:103], a[32:47]
  ds_read_b128 v[68:71], v13 offset:0
  ds_read_b64_tr_b16 v[72:73], v35 offset:49152
  ds_read_b64_tr_b16 v[74:75], v140 offset:49152
  v_mfma_f32_32x32x16_bf16 a[48:63], v[108:111], v[100:103], a[48:63]
  ds_read_b64_tr_b16 v[76:77], v35 offset:53248
  ds_read_b64_tr_b16 v[78:79], v140 offset:53248
  v_accvgpr_read_b32 v39, a3
  v_mul_f32 v143, v39, v39
  v_fma_f32 v143, v143, v134, v132
  v_mul_f32 v143, v143, v39
  v_exp_f32 v143, v143
  s_add_u32 s18, s18, 1
  s_and_b32 s18, s18, 31
  s_add_u32 m0, s14, 114688
  s_lshl_b32 s15, s18, 7
  s_add_u32 s15, s15, s16
  buffer_load_dwordx4 v26, s[20:23], s15 offen lds
  buffer_load_dwordx4 v27, s[20:23], s15 offen offset:1024 lds
  s_add_u32 s19, s19, 1
  s_and_b32 s19, s19, 31
  s_add_u32 m0, s14, 98304
  s_lshl_b32 s15, s19, 14
  s_add_u32 s15, s15, s17
  buffer_load_dwordx4 v28, s[80:83], s15 offen sc1 lds
  s_waitcnt lgkmcnt(5)
  v_mfma_f32_32x32x16_bf16 a[32:47], v[120:123], v[116:119], a[32:47]
  ds_read_b128 v[84:87], v16 offset:0
  ds_read_b64_tr_b16 v[88:89], v35 offset:49664
  ds_read_b64_tr_b16 v[90:91], v140 offset:49664
  v_mfma_f32_32x32x16_bf16 a[48:63], v[124:127], v[116:119], a[48:63]
  ds_read_b64_tr_b16 v[92:93], v35 offset:53760
  ds_read_b64_tr_b16 v[94:95], v140 offset:53760
  v_add_f32 v143, 1.0, v143
  v_rcp_f32 v143, v143
  s_nop 0
  v_mul_f32 v39, v39, v143
  buffer_load_dwordx4 v28, s[80:83], s15 offen offset:1024 sc1 lds
  s_add_u32 m0, s14, 106496
  s_lshl_b32 s15, s19, 14
  s_add_u32 s15, s15, s17
  s_add_u32 s15, s15, 8192
  buffer_load_dwordx4 v28, s[80:83], s15 offen sc1 lds
  buffer_load_dwordx4 v28, s[80:83], s15 offen offset:1024 sc1 lds
  s_waitcnt lgkmcnt(5)
  v_mfma_f32_32x32x16_bf16 a[32:47], v[72:75], v[68:71], a[32:47]
  ds_read_b128 v[100:103], v19 offset:0
  ds_read_b64_tr_b16 v[104:105], v35 offset:50176
  ds_read_b64_tr_b16 v[106:107], v140 offset:50176
  v_mfma_f32_32x32x16_bf16 a[48:63], v[76:79], v[68:71], a[48:63]
  ds_read_b64_tr_b16 v[108:109], v35 offset:54272
  ds_read_b64_tr_b16 v[110:111], v140 offset:54272
  v_accvgpr_read_b32 v40, a4
  v_mul_f32 v143, v40, v40
  v_fma_f32 v143, v143, v134, v132
  v_mul_f32 v143, v143, v40
  v_exp_f32 v143, v143
  s_add_u32 s18, s18, 1
  s_and_b32 s18, s18, 31
  s_add_u32 m0, s14, 16384
  s_lshl_b32 s15, s18, 7
  s_add_u32 s15, s15, s16
  buffer_load_dwordx4 v26, s[20:23], s15 offen lds
  buffer_load_dwordx4 v27, s[20:23], s15 offen offset:1024 lds
  s_add_u32 s19, s19, 1
  s_and_b32 s19, s19, 31
  s_add_u32 m0, s14, 0
  s_lshl_b32 s15, s19, 14
  s_add_u32 s15, s15, s17
  buffer_load_dwordx4 v28, s[80:83], s15 offen sc1 lds
  s_lshl_b32 s54, s11, 2
  v_and_b32 v9, 7, v0
  v_add_u32 v9, s54, v9
  v_subrev_u32 v9, 4, v9
  v_max_i32 v9, 0, v9
  v_lshlrev_b32 v9, 3, v9
  s_lshr_b32 s54, s10, 2
  v_add_u32 v9, s54, v9
  v_lshlrev_b32 v9, 7, v9
  v_add_u32 v9, 36864, v9
  v_mov_b32 v10, v7
  s_cmp_eq_u32 s3, 0
  s_cselect_b32 exec_lo, -1, 0
  s_cselect_b32 exec_hi, -1, 0
  buffer_load_dword v10, v9, s[56:59], 0 offen sc1
  s_mov_b64 exec, -1
  s_waitcnt lgkmcnt(5)
  v_mfma_f32_32x32x16_bf16 a[32:47], v[88:91], v[84:87], a[32:47]
  ds_read_b128 v[116:119], v22 offset:0
  ds_read_b64_tr_b16 v[120:121], v35 offset:50688
  ds_read_b64_tr_b16 v[122:123], v140 offset:50688
  v_mfma_f32_32x32x16_bf16 a[48:63], v[92:95], v[84:87], a[48:63]
  ds_read_b64_tr_b16 v[124:125], v35 offset:54784
  ds_read_b64_tr_b16 v[126:127], v140 offset:54784
  v_add_f32 v143, 1.0, v143
  v_rcp_f32 v143, v143
  s_nop 0
  v_mul_f32 v40, v40, v143
  buffer_load_dwordx4 v28, s[80:83], s15 offen offset:1024 sc1 lds
  s_cmp_eq_u32 s9, 7
  s_cbranch_scc1 L_pf_73
L_pfb_74:
  s_waitcnt vmcnt(11)
  s_barrier
  s_waitcnt lgkmcnt(5)
  v_mfma_f32_32x32x16_bf16 a[32:47], v[104:107], v[100:103], a[32:47]
  ds_read_b128 v[68:71], v13 offset:24576
  ds_read_b64_tr_b16 v[72:73], v138 offset:8192
  ds_read_b64_tr_b16 v[74:75], v141 offset:8192
  v_mfma_f32_32x32x16_bf16 a[48:63], v[108:111], v[100:103], a[48:63]
  ds_read_b64_tr_b16 v[76:77], v138 offset:12288
  ds_read_b64_tr_b16 v[78:79], v141 offset:12288
  v_accvgpr_read_b32 v41, a5
  v_mul_f32 v143, v41, v41
  v_fma_f32 v143, v143, v134, v132
  v_mul_f32 v143, v143, v41
  v_exp_f32 v143, v143
  s_add_u32 m0, s14, 8192
  s_lshl_b32 s15, s19, 14
  s_add_u32 s15, s15, s17
  s_add_u32 s15, s15, 8192
  buffer_load_dwordx4 v28, s[80:83], s15 offen sc1 lds
  buffer_load_dwordx4 v28, s[80:83], s15 offen offset:1024 sc1 lds
  s_waitcnt lgkmcnt(5)
  v_mfma_f32_32x32x16_bf16 a[32:47], v[120:123], v[116:119], a[32:47]
  ds_read_b128 v[84:87], v16 offset:24576
  ds_read_b64_tr_b16 v[88:89], v138 offset:8704
  ds_read_b64_tr_b16 v[90:91], v141 offset:8704
  v_mfma_f32_32x32x16_bf16 a[48:63], v[124:127], v[116:119], a[48:63]
  ds_read_b64_tr_b16 v[92:93], v138 offset:12800
  ds_read_b64_tr_b16 v[94:95], v141 offset:12800
  v_add_f32 v143, 1.0, v143
  v_rcp_f32 v143, v143
  s_nop 0
  v_mul_f32 v41, v41, v143
  s_add_u32 s18, s18, 1
  s_and_b32 s18, s18, 31
  s_add_u32 m0, s14, 40960
  s_lshl_b32 s15, s18, 7
  s_add_u32 s15, s15, s16
  buffer_load_dwordx4 v26, s[20:23], s15 offen lds
  buffer_load_dwordx4 v27, s[20:23], s15 offen offset:1024 lds
  s_waitcnt lgkmcnt(5)
  v_mfma_f32_32x32x16_bf16 a[32:47], v[72:75], v[68:71], a[32:47]
  ds_read_b128 v[100:103], v19 offset:24576
  ds_read_b64_tr_b16 v[104:105], v138 offset:9216
  ds_read_b64_tr_b16 v[106:107], v141 offset:9216
  v_mfma_f32_32x32x16_bf16 a[48:63], v[76:79], v[68:71], a[48:63]
  ds_read_b64_tr_b16 v[108:109], v138 offset:13312
  ds_read_b64_tr_b16 v[110:111], v141 offset:13312
  v_accvgpr_read_b32 v42, a6
  v_mul_f32 v143, v42, v42
  v_fma_f32 v143, v143, v134, v132
  v_mul_f32 v143, v143, v42
  v_exp_f32 v143, v143
  s_add_u32 s19, s19, 1
  s_and_b32 s19, s19, 31
  s_add_u32 m0, s14, 24576
  s_lshl_b32 s15, s19, 14
  s_add_u32 s15, s15, s17
  buffer_load_dwordx4 v28, s[80:83], s15 offen sc1 lds
  buffer_load_dwordx4 v28, s[80:83], s15 offen offset:1024 sc1 lds
  s_waitcnt lgkmcnt(5)
  v_mfma_f32_32x32x16_bf16 a[32:47], v[88:91], v[84:87], a[32:47]
  ds_read_b128 v[116:119], v22 offset:24576
  ds_read_b64_tr_b16 v[120:121], v138 offset:9728
  ds_read_b64_tr_b16 v[122:123], v141 offset:9728
  v_mfma_f32_32x32x16_bf16 a[48:63], v[92:95], v[84:87], a[48:63]
  ds_read_b64_tr_b16 v[124:125], v138 offset:13824
  ds_read_b64_tr_b16 v[126:127], v141 offset:13824
  v_add_f32 v143, 1.0, v143
  v_rcp_f32 v143, v143
  s_nop 0
  v_mul_f32 v42, v42, v143
  s_add_u32 m0, s14, 32768
  s_lshl_b32 s15, s19, 14
  s_add_u32 s15, s15, s17
  s_add_u32 s15, s15, 8192
  buffer_load_dwordx4 v28, s[80:83], s15 offen sc1 lds
  buffer_load_dwordx4 v28, s[80:83], s15 offen offset:1024 sc1 lds
  s_cmp_eq_u32 s9, 7
  s_cbranch_scc1 L_pf_77
L_pfb_78:
  s_waitcnt vmcnt(13)
  s_barrier
  s_waitcnt lgkmcnt(5)
  v_mfma_f32_32x32x16_bf16 a[32:47], v[104:107], v[100:103], a[32:47]
  ds_read_b128 v[68:71], v13 offset:49152
  ds_read_b64_tr_b16 v[72:73], v138 offset:32768
  ds_read_b64_tr_b16 v[74:75], v141 offset:32768
  v_mfma_f32_32x32x16_bf16 a[48:63], v[108:111], v[100:103], a[48:63]
  ds_read_b64_tr_b16 v[76:77], v138 offset:36864
  ds_read_b64_tr_b16 v[78:79], v141 offset:36864
  v_accvgpr_read_b32 v43, a7
  v_mul_f32 v143, v43, v43
  v_fma_f32 v143, v143, v134, v132
  v_mul_f32 v143, v143, v43
  v_exp_f32 v143, v143
  s_add_u32 s18, s18, 1
  s_and_b32 s18, s18, 31
  s_add_u32 m0, s14, 65536
  s_lshl_b32 s15, s18, 7
  s_add_u32 s15, s15, s16
  buffer_load_dwordx4 v26, s[20:23], s15 offen lds
  buffer_load_dwordx4 v27, s[20:23], s15 offen offset:1024 lds
  s_waitcnt lgkmcnt(5)
  v_mfma_f32_32x32x16_bf16 a[32:47], v[120:123], v[116:119], a[32:47]
  ds_read_b128 v[84:87], v16 offset:49152
  ds_read_b64_tr_b16 v[88:89], v138 offset:33280
  ds_read_b64_tr_b16 v[90:91], v141 offset:33280
  v_mfma_f32_32x32x16_bf16 a[48:63], v[124:127], v[116:119], a[48:63]
  ds_read_b64_tr_b16 v[92:93], v138 offset:37376
  ds_read_b64_tr_b16 v[94:95], v141 offset:37376
  v_add_f32 v143, 1.0, v143
  v_rcp_f32 v143, v143
  s_nop 0
  v_mul_f32 v43, v43, v143
  s_add_u32 s19, s19, 1
  s_and_b32 s19, s19, 31
  s_add_u32 m0, s14, 49152
  s_lshl_b32 s15, s19, 14
  s_add_u32 s15, s15, s17
  buffer_load_dwordx4 v28, s[80:83], s15 offen sc1 lds
  buffer_load_dwordx4 v28, s[80:83], s15 offen offset:1024 sc1 lds
  s_waitcnt lgkmcnt(5)
  v_mfma_f32_32x32x16_bf16 a[32:47], v[72:75], v[68:71], a[32:47]
  ds_read_b128 v[100:103], v19 offset:49152
  ds_read_b64_tr_b16 v[104:105], v138 offset:33792
  ds_read_b64_tr_b16 v[106:107], v141 offset:33792
  v_mfma_f32_32x32x16_bf16 a[48:63], v[76:79], v[68:71], a[48:63]
  ds_read_b64_tr_b16 v[108:109], v138 offset:37888
  ds_read_b64_tr_b16 v[110:111], v141 offset:37888
  v_accvgpr_read_b32 v44, a8
  v_mul_f32 v143, v44, v44
  v_fma_f32 v143, v143, v134, v132
  v_mul_f32 v143, v143, v44
  v_exp_f32 v143, v143
  s_add_u32 m0, s14, 57344
  s_lshl_b32 s15, s19, 14
  s_add_u32 s15, s15, s17
  s_add_u32 s15, s15, 8192
  buffer_load_dwordx4 v28, s[80:83], s15 offen sc1 lds
  buffer_load_dwordx4 v28, s[80:83], s15 offen offset:1024 sc1 lds
  s_waitcnt lgkmcnt(5)
  v_mfma_f32_32x32x16_bf16 a[32:47], v[88:91], v[84:87], a[32:47]
  ds_read_b128 v[116:119], v22 offset:49152
  ds_read_b64_tr_b16 v[120:121], v138 offset:34304
  ds_read_b64_tr_b16 v[122:123], v141 offset:34304
  v_mfma_f32_32x32x16_bf16 a[48:63], v[92:95], v[84:87], a[48:63]
  ds_read_b64_tr_b16 v[124:125], v138 offset:38400
  ds_read_b64_tr_b16 v[126:127], v141 offset:38400
  v_add_f32 v143, 1.0, v143
  v_rcp_f32 v143, v143
  s_nop 0
  v_mul_f32 v44, v44, v143
  s_cmp_eq_u32 s9, 7
  s_cbranch_scc1 L_pf_81
L_pfb_82:
  s_waitcnt vmcnt(12)
  s_waitcnt vmcnt(15)
  v_cmp_ne_u32 vcc, s12, v10
  s_nop 0
  s_cmp_eq_u64 vcc, 0
  s_cbranch_scc0 L_ps_85
L_pb_86:
  s_barrier
  s_waitcnt lgkmcnt(5)
  v_mfma_f32_32x32x16_bf16 a[32:47], v[104:107], v[100:103], a[32:47]
  ds_read_b128 v[68:71], v12 offset:16384
  ds_read_b64_tr_b16 v[72:73], v35 offset:0
  ds_read_b64_tr_b16 v[74:75], v140 offset:0
  v_mfma_f32_32x32x16_bf16 a[48:63], v[108:111], v[100:103], a[48:63]
  ds_read_b64_tr_b16 v[76:77], v35 offset:4096
  ds_read_b64_tr_b16 v[78:79], v140 offset:4096
  v_accvgpr_read_b32 v45, a9
  v_mul_f32 v143, v45, v45
  v_fma_f32 v143, v143, v134, v132
  v_mul_f32 v143, v143, v45
  v_exp_f32 v143, v143
  s_add_u32 s18, s18, 1
  s_and_b32 s18, s18, 31
  s_add_u32 m0, s14, 90112
  s_lshl_b32 s15, s18, 7
  s_add_u32 s15, s15, s16
  buffer_load_dwordx4 v26, s[20:23], s15 offen lds
  buffer_load_dwordx4 v27, s[20:23], s15 offen offset:1024 lds
  s_waitcnt lgkmcnt(5)
  v_mfma_f32_32x32x16_bf16 a[32:47], v[120:123], v[116:119], a[32:47]
  ds_read_b128 v[84:87], v15 offset:16384
  ds_read_b64_tr_b16 v[88:89], v35 offset:512
  ds_read_b64_tr_b16 v[90:91], v140 offset:512
  v_mfma_f32_32x32x16_bf16 a[48:63], v[124:127], v[116:119], a[48:63]
  ds_read_b64_tr_b16 v[92:93], v35 offset:4608
  ds_read_b64_tr_b16 v[94:95], v140 offset:4608
  v_add_f32 v143, 1.0, v143
  v_rcp_f32 v143, v143
  s_nop 0
  v_mul_f32 v45, v45, v143
  s_add_u32 s19, s19, 1
  s_and_b32 s19, s19, 31
  s_add_u32 m0, s14, 73728
  s_lshl_b32 s15, s19, 14
  s_add_u32 s15, s15, s17
  buffer_load_dwordx4 v28, s[80:83], s15 offen sc1 lds
  buffer_load_dwordx4 v28, s[80:83], s15 offen offset:1024 sc1 lds
  s_waitcnt lgkmcnt(5)
  v_mfma_f32_32x32x16_bf16 a[32:47], v[72:75], v[68:71], a[32:47]
  ds_read_b128 v[100:103], v18 offset:16384
  ds_read_b64_tr_b16 v[104:105], v35 offset:1024
  ds_read_b64_tr_b16 v[106:107], v140 offset:1024
  v_mfma_f32_32x32x16_bf16 a[48:63], v[76:79], v[68:71], a[48:63]
  ds_read_b64_tr_b16 v[108:109], v35 offset:5120
  ds_read_b64_tr_b16 v[110:111], v140 offset:5120
  v_accvgpr_read_b32 v46, a10
  v_mul_f32 v143, v46, v46
  v_fma_f32 v143, v143, v134, v132
  v_mul_f32 v143, v143, v46
  v_exp_f32 v143, v143
  s_add_u32 m0, s14, 81920
  s_lshl_b32 s15, s19, 14
  s_add_u32 s15, s15, s17
  s_add_u32 s15, s15, 8192
  buffer_load_dwordx4 v28, s[80:83], s15 offen sc1 lds
  buffer_load_dwordx4 v28, s[80:83], s15 offen offset:1024 sc1 lds
  s_waitcnt lgkmcnt(5)
  v_mfma_f32_32x32x16_bf16 a[32:47], v[88:91], v[84:87], a[32:47]
  ds_read_b128 v[116:119], v21 offset:16384
  ds_read_b64_tr_b16 v[120:121], v35 offset:1536
  ds_read_b64_tr_b16 v[122:123], v140 offset:1536
  v_mfma_f32_32x32x16_bf16 a[48:63], v[92:95], v[84:87], a[48:63]
  ds_read_b64_tr_b16 v[124:125], v35 offset:5632
  ds_read_b64_tr_b16 v[126:127], v140 offset:5632
  v_add_f32 v143, 1.0, v143
  v_rcp_f32 v143, v143
  s_nop 0
  v_mul_f32 v46, v46, v143
  s_cmp_eq_u32 s9, 7
  s_cbranch_scc1 L_pf_88
L_pfb_89:
  s_waitcnt vmcnt(12)
  s_barrier
  s_waitcnt lgkmcnt(5)
  v_mfma_f32_32x32x16_bf16 a[32:47], v[104:107], v[100:103], a[32:47]
  ds_read_b128 v[68:71], v12 offset:40960
  ds_read_b64_tr_b16 v[72:73], v35 offset:24576
  ds_read_b64_tr_b16 v[74:75], v140 offset:24576
  v_mfma_f32_32x32x16_bf16 a[48:63], v[108:111], v[100:103], a[48:63]
  ds_read_b64_tr_b16 v[76:77], v35 offset:28672
  ds_read_b64_tr_b16 v[78:79], v140 offset:28672
  v_accvgpr_read_b32 v47, a11
  v_mul_f32 v143, v47, v47
  v_fma_f32 v143, v143, v134, v132
  v_mul_f32 v143, v143, v47
  v_exp_f32 v143, v143
  s_add_u32 s18, s18, 1
  s_and_b32 s18, s18, 31
  s_add_u32 m0, s14, 114688
  s_lshl_b32 s15, s18, 7
  s_add_u32 s15, s15, s16
  buffer_load_dwordx4 v26, s[20:23], s15 offen lds
  buffer_load_dwordx4 v27, s[20:23], s15 offen offset:1024 lds
  s_waitcnt lgkmcnt(5)
  v_mfma_f32_32x32x16_bf16 a[32:47], v[120:123], v[116:119], a[32:47]
  ds_read_b128 v[84:87], v15 offset:40960
  ds_read_b64_tr_b16 v[88:89], v35 offset:25088
  ds_read_b64_tr_b16 v[90:91], v140 offset:25088
  v_mfma_f32_32x32x16_bf16 a[48:63], v[124:127], v[116:119], a[48:63]
  ds_read_b64_tr_b16 v[92:93], v35 offset:29184
  ds_read_b64_tr_b16 v[94:95], v140 offset:29184
  v_add_f32 v143, 1.0, v143
  v_rcp_f32 v143, v143
  s_nop 0
  v_mul_f32 v47, v47, v143
  s_add_u32 s19, s19, 1
  s_and_b32 s19, s19, 31
  s_add_u32 m0, s14, 98304
  s_lshl_b32 s15, s19, 14
  s_add_u32 s15, s15, s17
  buffer_load_dwordx4 v28, s[80:83], s15 offen sc1 lds
  buffer_load_dwordx4 v28, s[80:83], s15 offen offset:1024 sc1 lds
  s_waitcnt lgkmcnt(5)
  v_mfma_f32_32x32x16_bf16 a[32:47], v[72:75], v[68:71], a[32:47]
  ds_read_b128 v[100:103], v18 offset:40960
  ds_read_b64_tr_b16 v[104:105], v35 offset:25600
  ds_read_b64_tr_b16 v[106:107], v140 offset:25600
  v_mfma_f32_32x32x16_bf16 a[48:63], v[76:79], v[68:71], a[48:63]
  ds_read_b64_tr_b16 v[108:109], v35 offset:29696
  ds_read_b64_tr_b16 v[110:111], v140 offset:29696
  v_accvgpr_read_b32 v48, a12
  v_mul_f32 v143, v48, v48
  v_fma_f32 v143, v143, v134, v132
  v_mul_f32 v143, v143, v48
  v_exp_f32 v143, v143
  s_add_u32 m0, s14, 106496
  s_lshl_b32 s15, s19, 14
  s_add_u32 s15, s15, s17
  s_add_u32 s15, s15, 8192
  buffer_load_dwordx4 v28, s[80:83], s15 offen sc1 lds
  buffer_load_dwordx4 v28, s[80:83], s15 offen offset:1024 sc1 lds
  s_waitcnt lgkmcnt(5)
  v_mfma_f32_32x32x16_bf16 a[32:47], v[88:91], v[84:87], a[32:47]
  ds_read_b128 v[116:119], v21 offset:40960
  ds_read_b64_tr_b16 v[120:121], v35 offset:26112
  ds_read_b64_tr_b16 v[122:123], v140 offset:26112
  v_mfma_f32_32x32x16_bf16 a[48:63], v[92:95], v[84:87], a[48:63]
  ds_read_b64_tr_b16 v[124:125], v35 offset:30208
  ds_read_b64_tr_b16 v[126:127], v140 offset:30208
  v_add_f32 v143, 1.0, v143
  v_rcp_f32 v143, v143
  s_nop 0
  v_mul_f32 v48, v48, v143
  s_cmp_eq_u32 s9, 7
  s_cbranch_scc1 L_pf_92
L_pfb_93:
  s_waitcnt vmcnt(12)
  s_barrier
  s_waitcnt lgkmcnt(5)
  v_mfma_f32_32x32x16_bf16 a[32:47], v[104:107], v[100:103], a[32:47]
  ds_read_b128 v[68:71], v13 offset:0
  ds_read_b64_tr_b16 v[72:73], v35 offset:49152
  ds_read_b64_tr_b16 v[74:75], v140 offset:49152
  v_mfma_f32_32x32x16_bf16 a[48:63], v[108:111], v[100:103], a[48:63]
  ds_read_b64_tr_b16 v[76:77], v35 offset:53248
  ds_read_b64_tr_b16 v[78:79], v140 offset:53248
  v_accvgpr_read_b32 v49, a13
  v_mul_f32 v143, v49, v49
  v_fma_f32 v143, v143, v134, v132
  v_mul_f32 v143, v143, v49
  v_exp_f32 v143, v143
  s_add_u32 s18, s18, 1
  s_and_b32 s18, s18, 31
  s_add_u32 m0, s14, 16384
  s_lshl_b32 s15, s18, 7
  s_add_u32 s15, s15, s16
  buffer_load_dwordx4 v26, s[20:23], s15 offen lds
  buffer_load_dwordx4 v27, s[20:23], s15 offen offset:1024 lds
  s_waitcnt lgkmcnt(5)
  v_mfma_f32_32x32x16_bf16 a[32:47], v[120:123], v[116:119], a[32:47]
  ds_read_b128 v[84:87], v16 offset:0
  ds_read_b64_tr_b16 v[88:89], v35 offset:49664
  ds_read_b64_tr_b16 v[90:91], v140 offset:49664
  v_mfma_f32_32x32x16_bf16 a[48:63], v[124:127], v[116:119], a[48:63]
  ds_read_b64_tr_b16 v[92:93], v35 offset:53760
  ds_read_b64_tr_b16 v[94:95], v140 offset:53760
  v_add_f32 v143, 1.0, v143
  v_rcp_f32 v143, v143
  s_nop 0
  v_mul_f32 v49, v49, v143
  s_add_u32 s19, s19, 1
  s_and_b32 s19, s19, 31
  s_add_u32 m0, s14, 0
  s_lshl_b32 s15, s19, 14
  s_add_u32 s15, s15, s17
  buffer_load_dwordx4 v28, s[80:83], s15 offen sc1 lds
  buffer_load_dwordx4 v28, s[80:83], s15 offen offset:1024 sc1 lds
  s_waitcnt lgkmcnt(5)
  v_mfma_f32_32x32x16_bf16 a[32:47], v[72:75], v[68:71], a[32:47]
  ds_read_b128 v[100:103], v19 offset:0
  ds_read_b64_tr_b16 v[104:105], v35 offset:50176
  ds_read_b64_tr_b16 v[106:107], v140 offset:50176
  v_mfma_f32_32x32x16_bf16 a[48:63], v[76:79], v[68:71], a[48:63]
  ds_read_b64_tr_b16 v[108:109], v35 offset:54272
  ds_read_b64_tr_b16 v[110:111], v140 offset:54272
  s_add_u32 m0, s14, 8192
  s_lshl_b32 s15, s19, 14
  s_add_u32 s15, s15, s17
  s_add_u32 s15, s15, 8192
  buffer_load_dwordx4 v28, s[80:83], s15 offen sc1 lds
  buffer_load_dwordx4 v28, s[80:83], s15 offen offset:1024 sc1 lds
  s_waitcnt lgkmcnt(5)
  v_mfma_f32_32x32x16_bf16 a[32:47], v[88:91], v[84:87], a[32:47]
  ds_read_b128 v[116:119], v22 offset:0
  ds_read_b64_tr_b16 v[120:121], v35 offset:50688
  ds_read_b64_tr_b16 v[122:123], v140 offset:50688
  v_mfma_f32_32x32x16_bf16 a[48:63], v[92:95], v[84:87], a[48:63]
  ds_read_b64_tr_b16 v[124:125], v35 offset:54784
  ds_read_b64_tr_b16 v[126:127], v140 offset:54784
  s_cmp_eq_u32 s9, 7
  s_cbranch_scc1 L_pf_96
L_pfb_97:
  s_waitcnt vmcnt(12)
  s_barrier
  s_waitcnt lgkmcnt(5)
  v_mfma_f32_32x32x16_bf16 a[32:47], v[104:107], v[100:103], a[32:47]
  ds_read_b128 v[68:71], v13 offset:24576
  ds_read_b64_tr_b16 v[72:73], v138 offset:8192
  ds_read_b64_tr_b16 v[74:75], v141 offset:8192
  v_mfma_f32_32x32x16_bf16 a[48:63], v[108:111], v[100:103], a[48:63]
  ds_read_b64_tr_b16 v[76:77], v138 offset:12288
  ds_read_b64_tr_b16 v[78:79], v141 offset:12288
  s_add_u32 s18, s18, 1
  s_and_b32 s18, s18, 31
  s_add_u32 m0, s14, 40960
  s_lshl_b32 s15, s18, 7
  s_add_u32 s15, s15, s16
  buffer_load_dwordx4 v26, s[20:23], s15 offen lds
  buffer_load_dwordx4 v27, s[20:23], s15 offen offset:1024 lds
  s_waitcnt lgkmcnt(5)
  v_mfma_f32_32x32x16_bf16 a[32:47], v[120:123], v[116:119], a[32:47]
  ds_read_b128 v[84:87], v16 offset:24576
  ds_read_b64_tr_b16 v[88:89], v138 offset:8704
  ds_read_b64_tr_b16 v[90:91], v141 offset:8704
  v_mfma_f32_32x32x16_bf16 a[48:63], v[124:127], v[116:119], a[48:63]
  ds_read_b64_tr_b16 v[92:93], v138 offset:12800
  ds_read_b64_tr_b16 v[94:95], v141 offset:12800
  s_add_u32 s19, s19, 1
  s_and_b32 s19, s19, 31
  s_add_u32 m0, s14, 24576
  s_lshl_b32 s15, s19, 14
  s_add_u32 s15, s15, s17
  buffer_load_dwordx4 v28, s[80:83], s15 offen sc1 lds
  buffer_load_dwordx4 v28, s[80:83], s15 offen offset:1024 sc1 lds
  s_waitcnt lgkmcnt(5)
  v_mfma_f32_32x32x16_bf16 a[32:47], v[72:75], v[68:71], a[32:47]
  ds_read_b128 v[100:103], v19 offset:24576
  ds_read_b64_tr_b16 v[104:105], v138 offset:9216
  ds_read_b64_tr_b16 v[106:107], v141 offset:9216
  v_mfma_f32_32x32x16_bf16 a[48:63], v[76:79], v[68:71], a[48:63]
  ds_read_b64_tr_b16 v[108:109], v138 offset:13312
  ds_read_b64_tr_b16 v[110:111], v141 offset:13312
  s_add_u32 m0, s14, 32768
  s_lshl_b32 s15, s19, 14
  s_add_u32 s15, s15, s17
  s_add_u32 s15, s15, 8192
  buffer_load_dwordx4 v28, s[80:83], s15 offen sc1 lds
  buffer_load_dwordx4 v28, s[80:83], s15 offen offset:1024 sc1 lds
  s_waitcnt lgkmcnt(5)
  v_mfma_f32_32x32x16_bf16 a[32:47], v[88:91], v[84:87], a[32:47]
  ds_read_b128 v[116:119], v22 offset:24576
  ds_read_b64_tr_b16 v[120:121], v138 offset:9728
  ds_read_b64_tr_b16 v[122:123], v141 offset:9728
  v_mfma_f32_32x32x16_bf16 a[48:63], v[92:95], v[84:87], a[48:63]
  ds_read_b64_tr_b16 v[124:125], v138 offset:13824
  ds_read_b64_tr_b16 v[126:127], v141 offset:13824
  s_cmp_eq_u32 s9, 7
  s_cbranch_scc1 L_pf_99
L_pfb_100:
  s_waitcnt vmcnt(12)
  s_barrier
  s_waitcnt lgkmcnt(5)
  v_mfma_f32_32x32x16_bf16 a[32:47], v[104:107], v[100:103], a[32:47]
  ds_read_b128 v[68:71], v13 offset:49152
  ds_read_b64_tr_b16 v[72:73], v138 offset:32768
  ds_read_b64_tr_b16 v[74:75], v141 offset:32768
  v_mfma_f32_32x32x16_bf16 a[48:63], v[108:111], v[100:103], a[48:63]
  ds_read_b64_tr_b16 v[76:77], v138 offset:36864
  ds_read_b64_tr_b16 v[78:79], v141 offset:36864
  s_add_u32 s18, s18, 1
  s_and_b32 s18, s18, 31
  s_add_u32 m0, s14, 65536
  s_lshl_b32 s15, s18, 7
  s_add_u32 s15, s15, s16
  buffer_load_dwordx4 v26, s[20:23], s15 offen lds
  buffer_load_dwordx4 v27, s[20:23], s15 offen offset:1024 lds
  s_waitcnt lgkmcnt(5)
  v_mfma_f32_32x32x16_bf16 a[32:47], v[120:123], v[116:119], a[32:47]
  ds_read_b128 v[84:87], v16 offset:49152
  ds_read_b64_tr_b16 v[88:89], v138 offset:33280
  ds_read_b64_tr_b16 v[90:91], v141 offset:33280
  v_mfma_f32_32x32x16_bf16 a[48:63], v[124:127], v[116:119], a[48:63]
  ds_read_b64_tr_b16 v[92:93], v138 offset:37376
  ds_read_b64_tr_b16 v[94:95], v141 offset:37376
  s_add_u32 s19, s19, 1
  s_and_b32 s19, s19, 31
  s_add_u32 m0, s14, 49152
  s_lshl_b32 s15, s19, 14
  s_add_u32 s15, s15, s17
  buffer_load_dwordx4 v28, s[80:83], s15 offen sc1 lds
  buffer_load_dwordx4 v28, s[80:83], s15 offen offset:1024 sc1 lds
  s_waitcnt lgkmcnt(5)
  v_mfma_f32_32x32x16_bf16 a[32:47], v[72:75], v[68:71], a[32:47]
  ds_read_b128 v[100:103], v19 offset:49152
  ds_read_b64_tr_b16 v[104:105], v138 offset:33792
  ds_read_b64_tr_b16 v[106:107], v141 offset:33792
  v_mfma_f32_32x32x16_bf16 a[48:63], v[76:79], v[68:71], a[48:63]
  ds_read_b64_tr_b16 v[108:109], v138 offset:37888
  ds_read_b64_tr_b16 v[110:111], v141 offset:37888
  s_add_u32 m0, s14, 57344
  s_lshl_b32 s15, s19, 14
  s_add_u32 s15, s15, s17
  s_add_u32 s15, s15, 8192
  buffer_load_dwordx4 v28, s[80:83], s15 offen sc1 lds
  buffer_load_dwordx4 v28, s[80:83], s15 offen offset:1024 sc1 lds
  s_waitcnt lgkmcnt(5)
  v_mfma_f32_32x32x16_bf16 a[32:47], v[88:91], v[84:87], a[32:47]
  ds_read_b128 v[116:119], v22 offset:49152
  ds_read_b64_tr_b16 v[120:121], v138 offset:34304
  ds_read_b64_tr_b16 v[122:123], v141 offset:34304
  v_mfma_f32_32x32x16_bf16 a[48:63], v[92:95], v[84:87], a[48:63]
  ds_read_b64_tr_b16 v[124:125], v138 offset:38400
  ds_read_b64_tr_b16 v[126:127], v141 offset:38400
  s_cmp_eq_u32 s9, 7
  s_cbranch_scc1 L_pf_102
L_pfb_103:
  s_waitcnt vmcnt(12)
  s_barrier
  s_waitcnt lgkmcnt(5)
  v_mfma_f32_32x32x16_bf16 a[32:47], v[104:107], v[100:103], a[32:47]
  ds_read_b128 v[68:71], v12 offset:16384
  ds_read_b64_tr_b16 v[72:73], v35 offset:0
  ds_read_b64_tr_b16 v[74:75], v140 offset:0
  v_mfma_f32_32x32x16_bf16 a[48:63], v[108:111], v[100:103], a[48:63]
  ds_read_b64_tr_b16 v[76:77], v35 offset:4096
  ds_read_b64_tr_b16 v[78:79], v140 offset:4096
  s_add_u32 s18, s18, 1
  s_and_b32 s18, s18, 31
  s_add_u32 m0, s14, 90112
  s_lshl_b32 s15, s18, 7
  s_add_u32 s15, s15, s16
  buffer_load_dwordx4 v26, s[20:23], s15 offen lds
  buffer_load_dwordx4 v27, s[20:23], s15 offen offset:1024 lds
  s_waitcnt lgkmcnt(5)
  v_mfma_f32_32x32x16_bf16 a[32:47], v[120:123], v[116:119], a[32:47]
  ds_read_b128 v[84:87], v15 offset:16384
  ds_read_b64_tr_b16 v[88:89], v35 offset:512
  ds_read_b64_tr_b16 v[90:91], v140 offset:512
  v_mfma_f32_32x32x16_bf16 a[48:63], v[124:127], v[116:119], a[48:63]
  ds_read_b64_tr_b16 v[92:93], v35 offset:4608
  ds_read_b64_tr_b16 v[94:95], v140 offset:4608
  s_add_u32 s19, s19, 1
  s_and_b32 s19, s19, 31
  s_add_u32 m0, s14, 73728
  s_lshl_b32 s15, s19, 14
  s_add_u32 s15, s15, s17
  buffer_load_dwordx4 v28, s[80:83], s15 offen sc1 lds
  buffer_load_dwordx4 v28, s[80:83], s15 offen offset:1024 sc1 lds
  s_waitcnt lgkmcnt(5)
  v_mfma_f32_32x32x16_bf16 a[32:47], v[72:75], v[68:71], a[32:47]
  ds_read_b128 v[100:103], v18 offset:16384
  ds_read_b64_tr_b16 v[104:105], v35 offset:1024
  ds_read_b64_tr_b16 v[106:107], v140 offset:1024
  v_mfma_f32_32x32x16_bf16 a[48:63], v[76:79], v[68:71], a[48:63]
  ds_read_b64_tr_b16 v[108:109], v35 offset:5120
  ds_read_b64_tr_b16 v[110:111], v140 offset:5120
  s_add_u32 m0, s14, 81920
  s_lshl_b32 s15, s19, 14
  s_add_u32 s15, s15, s17
  s_add_u32 s15, s15, 8192
  buffer_load_dwordx4 v28, s[80:83], s15 offen sc1 lds
  buffer_load_dwordx4 v28, s[80:83], s15 offen offset:1024 sc1 lds
  s_waitcnt lgkmcnt(5)
  v_mfma_f32_32x32x16_bf16 a[32:47], v[88:91], v[84:87], a[32:47]
  ds_read_b128 v[116:119], v21 offset:16384
  ds_read_b64_tr_b16 v[120:121], v35 offset:1536
  ds_read_b64_tr_b16 v[122:123], v140 offset:1536
  v_mfma_f32_32x32x16_bf16 a[48:63], v[92:95], v[84:87], a[48:63]
  ds_read_b64_tr_b16 v[124:125], v35 offset:5632
  ds_read_b64_tr_b16 v[126:127], v140 offset:5632
  s_cmp_eq_u32 s9, 7
  s_cbranch_scc1 L_pf_105
L_pfb_106:
  s_waitcnt vmcnt(12)
  s_barrier
  s_waitcnt lgkmcnt(5)
  v_mfma_f32_32x32x16_bf16 a[32:47], v[104:107], v[100:103], a[32:47]
  ds_read_b128 v[68:71], v12 offset:40960
  ds_read_b64_tr_b16 v[72:73], v35 offset:24576
  ds_read_b64_tr_b16 v[74:75], v140 offset:24576
  v_mfma_f32_32x32x16_bf16 a[48:63], v[108:111], v[100:103], a[48:63]
  ds_read_b64_tr_b16 v[76:77], v35 offset:28672
  ds_read_b64_tr_b16 v[78:79], v140 offset:28672
  s_add_u32 s18, s18, 1
  s_and_b32 s18, s18, 31
  s_add_u32 m0, s14, 114688
  s_lshl_b32 s15, s18, 7
  s_add_u32 s15, s15, s16
  buffer_load_dwordx4 v26, s[20:23], s15 offen lds
  buffer_load_dwordx4 v27, s[20:23], s15 offen offset:1024 lds
  s_waitcnt lgkmcnt(5)
  v_mfma_f32_32x32x16_bf16 a[32:47], v[120:123], v[116:119], a[32:47]
  ds_read_b128 v[84:87], v15 offset:40960
  ds_read_b64_tr_b16 v[88:89], v35 offset:25088
  ds_read_b64_tr_b16 v[90:91], v140 offset:25088
  v_mfma_f32_32x32x16_bf16 a[48:63], v[124:127], v[116:119], a[48:63]
  ds_read_b64_tr_b16 v[92:93], v35 offset:29184
  ds_read_b64_tr_b16 v[94:95], v140 offset:29184
  s_add_u32 s19, s19, 1
  s_and_b32 s19, s19, 31
  s_add_u32 m0, s14, 98304
  s_lshl_b32 s15, s19, 14
  s_add_u32 s15, s15, s17
  buffer_load_dwordx4 v28, s[80:83], s15 offen sc1 lds
  buffer_load_dwordx4 v28, s[80:83], s15 offen offset:1024 sc1 lds
  s_waitcnt lgkmcnt(5)
  v_mfma_f32_32x32x16_bf16 a[32:47], v[72:75], v[68:71], a[32:47]
  ds_read_b128 v[100:103], v18 offset:40960
  ds_read_b64_tr_b16 v[104:105], v35 offset:25600
  ds_read_b64_tr_b16 v[106:107], v140 offset:25600
  v_mfma_f32_32x32x16_bf16 a[48:63], v[76:79], v[68:71], a[48:63]
  ds_read_b64_tr_b16 v[108:109], v35 offset:29696
  ds_read_b64_tr_b16 v[110:111], v140 offset:29696
  s_add_u32 m0, s14, 106496
  s_lshl_b32 s15, s19, 14
  s_add_u32 s15, s15, s17
  s_add_u32 s15, s15, 8192
  buffer_load_dwordx4 v28, s[80:83], s15 offen sc1 lds
  buffer_load_dwordx4 v28, s[80:83], s15 offen offset:1024 sc1 lds
  s_waitcnt lgkmcnt(5)
  v_mfma_f32_32x32x16_bf16 a[32:47], v[88:91], v[84:87], a[32:47]
  ds_read_b128 v[116:119], v21 offset:40960
  ds_read_b64_tr_b16 v[120:121], v35 offset:26112
  ds_read_b64_tr_b16 v[122:123], v140 offset:26112
  v_mfma_f32_32x32x16_bf16 a[48:63], v[92:95], v[84:87], a[48:63]
  ds_read_b64_tr_b16 v[124:125], v35 offset:30208
  ds_read_b64_tr_b16 v[126:127], v140 offset:30208
  s_cmp_eq_u32 s9, 7
  s_cbranch_scc1 L_pf_108
L_pfb_109:
  s_waitcnt vmcnt(12)
  s_barrier
  s_waitcnt lgkmcnt(5)
  v_mfma_f32_32x32x16_bf16 a[32:47], v[104:107], v[100:103], a[32:47]
  ds_read_b128 v[68:71], v13 offset:0
  ds_read_b64_tr_b16 v[72:73], v35 offset:49152
  ds_read_b64_tr_b16 v[74:75], v140 offset:49152
  v_mfma_f32_32x32x16_bf16 a[48:63], v[108:111], v[100:103], a[48:63]
  ds_read_b64_tr_b16 v[76:77], v35 offset:53248
  ds_read_b64_tr_b16 v[78:79], v140 offset:53248
  s_add_u32 s18, s18, 1
  s_and_b32 s18, s18, 31
  s_add_u32 m0, s14, 16384
  s_lshl_b32 s15, s18, 7
  s_add_u32 s15, s15, s16
  buffer_load_dwordx4 v26, s[20:23], s15 offen lds
  buffer_load_dwordx4 v27, s[20:23], s15 offen offset:1024 lds
  s_waitcnt lgkmcnt(5)
  v_mfma_f32_32x32x16_bf16 a[32:47], v[120:123], v[116:119], a[32:47]
  ds_read_b128 v[84:87], v16 offset:0
  ds_read_b64_tr_b16 v[88:89], v35 offset:49664
  ds_read_b64_tr_b16 v[90:91], v140 offset:49664
  v_mfma_f32_32x32x16_bf16 a[48:63], v[124:127], v[116:119], a[48:63]
  ds_read_b64_tr_b16 v[92:93], v35 offset:53760
  ds_read_b64_tr_b16 v[94:95], v140 offset:53760
  s_add_u32 s19, s19, 1
  s_and_b32 s19, s19, 31
  s_add_u32 m0, s14, 0
  s_lshl_b32 s15, s19, 14
  s_add_u32 s15, s15, s17
  buffer_load_dwordx4 v28, s[80:83], s15 offen sc1 lds
  buffer_load_dwordx4 v28, s[80:83], s15 offen offset:1024 sc1 lds
  s_waitcnt lgkmcnt(5)
  v_mfma_f32_32x32x16_bf16 a[32:47], v[72:75], v[68:71], a[32:47]
  ds_read_b128 v[100:103], v19 offset:0
  ds_read_b64_tr_b16 v[104:105], v35 offset:50176
  ds_read_b64_tr_b16 v[106:107], v140 offset:50176
  v_mfma_f32_32x32x16_bf16 a[48:63], v[76:79], v[68:71], a[48:63]
  ds_read_b64_tr_b16 v[108:109], v35 offset:54272
  ds_read_b64_tr_b16 v[110:111], v140 offset:54272
  s_add_u32 m0, s14, 8192
  s_lshl_b32 s15, s19, 14
  s_add_u32 s15, s15, s17
  s_add_u32 s15, s15, 8192
  buffer_load_dwordx4 v28, s[80:83], s15 offen sc1 lds
  buffer_load_dwordx4 v28, s[80:83], s15 offen offset:1024 sc1 lds
  s_waitcnt lgkmcnt(5)
  v_mfma_f32_32x32x16_bf16 a[32:47], v[88:91], v[84:87], a[32:47]
  ds_read_b128 v[116:119], v22 offset:0
  ds_read_b64_tr_b16 v[120:121], v35 offset:50688
  ds_read_b64_tr_b16 v[122:123], v140 offset:50688
  v_mfma_f32_32x32x16_bf16 a[48:63], v[92:95], v[84:87], a[48:63]
  ds_read_b64_tr_b16 v[124:125], v35 offset:54784
  ds_read_b64_tr_b16 v[126:127], v140 offset:54784
  s_cmp_eq_u32 s9, 7
  s_cbranch_scc1 L_pf_111
L_pfb_112:
  s_waitcnt vmcnt(12)
  s_barrier
  s_waitcnt lgkmcnt(5)
  v_mfma_f32_32x32x16_bf16 a[32:47], v[104:107], v[100:103], a[32:47]
  ds_read_b128 v[68:71], v13 offset:24576
  ds_read_b64_tr_b16 v[72:73], v138 offset:8192
  ds_read_b64_tr_b16 v[74:75], v141 offset:8192
  v_mfma_f32_32x32x16_bf16 a[48:63], v[108:111], v[100:103], a[48:63]
  ds_read_b64_tr_b16 v[76:77], v138 offset:12288
  ds_read_b64_tr_b16 v[78:79], v141 offset:12288
  s_add_u32 s18, s18, 1
  s_and_b32 s18, s18, 31
  s_add_u32 m0, s14, 40960
  s_lshl_b32 s15, s18, 7
  s_add_u32 s15, s15, s16
  buffer_load_dwordx4 v26, s[20:23], s15 offen lds
  buffer_load_dwordx4 v27, s[20:23], s15 offen offset:1024 lds
  s_waitcnt lgkmcnt(5)
  v_mfma_f32_32x32x16_bf16 a[32:47], v[120:123], v[116:119], a[32:47]
  ds_read_b128 v[84:87], v16 offset:24576
  ds_read_b64_tr_b16 v[88:89], v138 offset:8704
  ds_read_b64_tr_b16 v[90:91], v141 offset:8704
  v_mfma_f32_32x32x16_bf16 a[48:63], v[124:127], v[116:119], a[48:63]
  ds_read_b64_tr_b16 v[92:93], v138 offset:12800
  ds_read_b64_tr_b16 v[94:95], v141 offset:12800
  s_add_u32 s19, s19, 1
  s_and_b32 s19, s19, 31
  s_add_u32 m0, s14, 24576
  s_lshl_b32 s15, s19, 14
  s_add_u32 s15, s15, s17
  buffer_load_dwordx4 v28, s[80:83], s15 offen sc1 lds
  buffer_load_dwordx4 v28, s[80:83], s15 offen offset:1024 sc1 lds
  s_waitcnt lgkmcnt(5)
  v_mfma_f32_32x32x16_bf16 a[32:47], v[72:75], v[68:71], a[32:47]
  ds_read_b128 v[100:103], v19 offset:24576
  ds_read_b64_tr_b16 v[104:105], v138 offset:9216
  ds_read_b64_tr_b16 v[106:107], v141 offset:9216
  v_mfma_f32_32x32x16_bf16 a[48:63], v[76:79], v[68:71], a[48:63]
  ds_read_b64_tr_b16 v[108:109], v138 offset:13312
  ds_read_b64_tr_b16 v[110:111], v141 offset:13312
  s_add_u32 m0, s14, 32768
  s_lshl_b32 s15, s19, 14
  s_add_u32 s15, s15, s17
  s_add_u32 s15, s15, 8192
  buffer_load_dwordx4 v28, s[80:83], s15 offen sc1 lds
  buffer_load_dwordx4 v28, s[80:83], s15 offen offset:1024 sc1 lds
  s_waitcnt lgkmcnt(5)
  v_mfma_f32_32x32x16_bf16 a[32:47], v[88:91], v[84:87], a[32:47]
  ds_read_b128 v[116:119], v22 offset:24576
  ds_read_b64_tr_b16 v[120:121], v138 offset:9728
  ds_read_b64_tr_b16 v[122:123], v141 offset:9728
  v_mfma_f32_32x32x16_bf16 a[48:63], v[92:95], v[84:87], a[48:63]
  ds_read_b64_tr_b16 v[124:125], v138 offset:13824
  ds_read_b64_tr_b16 v[126:127], v141 offset:13824
  s_cmp_eq_u32 s9, 7
  s_cbranch_scc1 L_pf_114
L_pfb_115:
  s_waitcnt vmcnt(12)
  s_barrier
  s_waitcnt lgkmcnt(5)
  v_mfma_f32_32x32x16_bf16 a[32:47], v[104:107], v[100:103], a[32:47]
  ds_read_b128 v[68:71], v13 offset:49152
  ds_read_b64_tr_b16 v[72:73], v138 offset:32768
  ds_read_b64_tr_b16 v[74:75], v141 offset:32768
  v_mfma_f32_32x32x16_bf16 a[48:63], v[108:111], v[100:103], a[48:63]
  ds_read_b64_tr_b16 v[76:77], v138 offset:36864
  ds_read_b64_tr_b16 v[78:79], v141 offset:36864
  s_add_u32 s18, s18, 1
  s_and_b32 s18, s18, 31
  s_add_u32 m0, s14, 65536
  s_lshl_b32 s15, s18, 7
  s_add_u32 s15, s15, s16
  buffer_load_dwordx4 v26, s[20:23], s15 offen lds
  buffer_load_dwordx4 v27, s[20:23], s15 offen offset:1024 lds
  s_waitcnt lgkmcnt(5)
  v_mfma_f32_32x32x16_bf16 a[32:47], v[120:123], v[116:119], a[32:47]
  ds_read_b128 v[84:87], v16 offset:49152
  ds_read_b64_tr_b16 v[88:89], v138 offset:33280
  ds_read_b64_tr_b16 v[90:91], v141 offset:33280
  v_mfma_f32_32x32x16_bf16 a[48:63], v[124:127], v[116:119], a[48:63]
  ds_read_b64_tr_b16 v[92:93], v138 offset:37376
  ds_read_b64_tr_b16 v[94:95], v141 offset:37376
  s_add_u32 s19, s19, 1
  s_and_b32 s19, s19, 31
  s_add_u32 m0, s14, 49152
  s_lshl_b32 s15, s19, 14
  s_add_u32 s15, s15, s17
  buffer_load_dwordx4 v28, s[80:83], s15 offen sc1 lds
  buffer_load_dwordx4 v28, s[80:83], s15 offen offset:1024 sc1 lds
  s_waitcnt lgkmcnt(5)
  v_mfma_f32_32x32x16_bf16 a[32:47], v[72:75], v[68:71], a[32:47]
  ds_read_b128 v[100:103], v19 offset:49152
  ds_read_b64_tr_b16 v[104:105], v138 offset:33792
  ds_read_b64_tr_b16 v[106:107], v141 offset:33792
  v_mfma_f32_32x32x16_bf16 a[48:63], v[76:79], v[68:71], a[48:63]
  ds_read_b64_tr_b16 v[108:109], v138 offset:37888
  ds_read_b64_tr_b16 v[110:111], v141 offset:37888
  s_add_u32 m0, s14, 57344
  s_lshl_b32 s15, s19, 14
  s_add_u32 s15, s15, s17
  s_add_u32 s15, s15, 8192
  buffer_load_dwordx4 v28, s[80:83], s15 offen sc1 lds
  buffer_load_dwordx4 v28, s[80:83], s15 offen offset:1024 sc1 lds
  s_waitcnt lgkmcnt(5)
  v_mfma_f32_32x32x16_bf16 a[32:47], v[88:91], v[84:87], a[32:47]
  ds_read_b128 v[116:119], v22 offset:49152
  ds_read_b64_tr_b16 v[120:121], v138 offset:34304
  ds_read_b64_tr_b16 v[122:123], v141 offset:34304
  v_mfma_f32_32x32x16_bf16 a[48:63], v[92:95], v[84:87], a[48:63]
  ds_read_b64_tr_b16 v[124:125], v138 offset:38400
  ds_read_b64_tr_b16 v[126:127], v141 offset:38400
  s_cmp_eq_u32 s9, 7
  s_cbranch_scc1 L_pf_117
L_pfb_118:
  s_waitcnt vmcnt(12)
  s_barrier
  s_waitcnt lgkmcnt(5)
  v_mfma_f32_32x32x16_bf16 a[32:47], v[104:107], v[100:103], a[32:47]
  ds_read_b128 v[68:71], v12 offset:16384
  ds_read_b64_tr_b16 v[72:73], v35 offset:0
  ds_read_b64_tr_b16 v[74:75], v140 offset:0
  v_mfma_f32_32x32x16_bf16 a[48:63], v[108:111], v[100:103], a[48:63]
  ds_read_b64_tr_b16 v[76:77], v35 offset:4096
  ds_read_b64_tr_b16 v[78:79], v140 offset:4096
  s_add_u32 s18, s18, 1
  s_and_b32 s18, s18, 31
  s_add_u32 m0, s14, 90112
  s_lshl_b32 s15, s18, 7
  s_add_u32 s15, s15, s16
  buffer_load_dwordx4 v26, s[20:23], s15 offen lds
  buffer_load_dwordx4 v27, s[20:23], s15 offen offset:1024 lds
  s_waitcnt lgkmcnt(5)
  v_mfma_f32_32x32x16_bf16 a[32:47], v[120:123], v[116:119], a[32:47]
  ds_read_b128 v[84:87], v15 offset:16384
  ds_read_b64_tr_b16 v[88:89], v35 offset:512
  ds_read_b64_tr_b16 v[90:91], v140 offset:512
  v_mfma_f32_32x32x16_bf16 a[48:63], v[124:127], v[116:119], a[48:63]
  ds_read_b64_tr_b16 v[92:93], v35 offset:4608
  ds_read_b64_tr_b16 v[94:95], v140 offset:4608
  s_add_u32 s19, s19, 1
  s_and_b32 s19, s19, 31
  s_add_u32 m0, s14, 73728
  s_lshl_b32 s15, s19, 14
  s_add_u32 s15, s15, s17
  buffer_load_dwordx4 v28, s[80:83], s15 offen sc1 lds
  buffer_load_dwordx4 v28, s[80:83], s15 offen offset:1024 sc1 lds
  s_waitcnt lgkmcnt(5)
  v_mfma_f32_32x32x16_bf16 a[32:47], v[72:75], v[68:71], a[32:47]
  ds_read_b128 v[100:103], v18 offset:16384
  ds_read_b64_tr_b16 v[104:105], v35 offset:1024
  ds_read_b64_tr_b16 v[106:107], v140 offset:1024
  v_mfma_f32_32x32x16_bf16 a[48:63], v[76:79], v[68:71], a[48:63]
  ds_read_b64_tr_b16 v[108:109], v35 offset:5120
  ds_read_b64_tr_b16 v[110:111], v140 offset:5120
  s_add_u32 m0, s14, 81920
  s_lshl_b32 s15, s19, 14
  s_add_u32 s15, s15, s17
  s_add_u32 s15, s15, 8192
  buffer_load_dwordx4 v28, s[80:83], s15 offen sc1 lds
  buffer_load_dwordx4 v28, s[80:83], s15 offen offset:1024 sc1 lds
  s_waitcnt lgkmcnt(5)
  v_mfma_f32_32x32x16_bf16 a[32:47], v[88:91], v[84:87], a[32:47]
  ds_read_b128 v[116:119], v21 offset:16384
  ds_read_b64_tr_b16 v[120:121], v35 offset:1536
  ds_read_b64_tr_b16 v[122:123], v140 offset:1536
  v_mfma_f32_32x32x16_bf16 a[48:63], v[92:95], v[84:87], a[48:63]
  ds_read_b64_tr_b16 v[124:125], v35 offset:5632
  ds_read_b64_tr_b16 v[126:127], v140 offset:5632
  s_cmp_eq_u32 s9, 7
  s_cbranch_scc1 L_pf_120
L_pfb_121:
  s_waitcnt vmcnt(12)
  s_barrier
  s_waitcnt lgkmcnt(5)
  v_mfma_f32_32x32x16_bf16 a[32:47], v[104:107], v[100:103], a[32:47]
  ds_read_b128 v[68:71], v12 offset:40960
  ds_read_b64_tr_b16 v[72:73], v35 offset:24576
  ds_read_b64_tr_b16 v[74:75], v140 offset:24576
  v_mfma_f32_32x32x16_bf16 a[48:63], v[108:111], v[100:103], a[48:63]
  ds_read_b64_tr_b16 v[76:77], v35 offset:28672
  ds_read_b64_tr_b16 v[78:79], v140 offset:28672
  s_add_u32 s18, s18, 1
  s_and_b32 s18, s18, 31
  s_add_u32 m0, s14, 114688
  s_lshl_b32 s15, s18, 7
  s_add_u32 s15, s15, s16
  buffer_load_dwordx4 v26, s[20:23], s15 offen lds
  buffer_load_dwordx4 v27, s[20:23], s15 offen offset:1024 lds
  s_waitcnt lgkmcnt(5)
  v_mfma_f32_32x32x16_bf16 a[32:47], v[120:123], v[116:119], a[32:47]
  ds_read_b128 v[84:87], v15 offset:40960
  ds_read_b64_tr_b16 v[88:89], v35 offset:25088
  ds_read_b64_tr_b16 v[90:91], v140 offset:25088
  v_mfma_f32_32x32x16_bf16 a[48:63], v[124:127], v[116:119], a[48:63]
  ds_read_b64_tr_b16 v[92:93], v35 offset:29184
  ds_read_b64_tr_b16 v[94:95], v140 offset:29184
  s_add_u32 s19, s19, 1
  s_and_b32 s19, s19, 31
  s_add_u32 m0, s14, 98304
  s_lshl_b32 s15, s19, 14
  s_add_u32 s15, s15, s17
  buffer_load_dwordx4 v28, s[80:83], s15 offen sc1 lds
  buffer_load_dwordx4 v28, s[80:83], s15 offen offset:1024 sc1 lds
  s_waitcnt lgkmcnt(5)
  v_mfma_f32_32x32x16_bf16 a[32:47], v[72:75], v[68:71], a[32:47]
  ds_read_b128 v[100:103], v18 offset:40960
  ds_read_b64_tr_b16 v[104:105], v35 offset:25600
  ds_read_b64_tr_b16 v[106:107], v140 offset:25600
  v_mfma_f32_32x32x16_bf16 a[48:63], v[76:79], v[68:71], a[48:63]
  ds_read_b64_tr_b16 v[108:109], v35 offset:29696
  ds_read_b64_tr_b16 v[110:111], v140 offset:29696
  s_add_u32 m0, s14, 106496
  s_lshl_b32 s15, s19, 14
  s_add_u32 s15, s15, s17
  s_add_u32 s15, s15, 8192
  buffer_load_dwordx4 v28, s[80:83], s15 offen sc1 lds
  buffer_load_dwordx4 v28, s[80:83], s15 offen offset:1024 sc1 lds
  s_waitcnt lgkmcnt(5)
  v_mfma_f32_32x32x16_bf16 a[32:47], v[88:91], v[84:87], a[32:47]
  ds_read_b128 v[116:119], v21 offset:40960
  ds_read_b64_tr_b16 v[120:121], v35 offset:26112
  ds_read_b64_tr_b16 v[122:123], v140 offset:26112
  v_mfma_f32_32x32x16_bf16 a[48:63], v[92:95], v[84:87], a[48:63]
  ds_read_b64_tr_b16 v[124:125], v35 offset:30208
  ds_read_b64_tr_b16 v[126:127], v140 offset:30208
  s_cmp_eq_u32 s9, 7
  s_cbranch_scc1 L_pf_123
L_pfb_124:
  s_waitcnt vmcnt(12)
  s_barrier
  s_waitcnt lgkmcnt(5)
  v_mfma_f32_32x32x16_bf16 a[32:47], v[104:107], v[100:103], a[32:47]
  ds_read_b128 v[68:71], v13 offset:0
  ds_read_b64_tr_b16 v[72:73], v35 offset:49152
  ds_read_b64_tr_b16 v[74:75], v140 offset:49152
  v_mfma_f32_32x32x16_bf16 a[48:63], v[108:111], v[100:103], a[48:63]
  ds_read_b64_tr_b16 v[76:77], v35 offset:53248
  ds_read_b64_tr_b16 v[78:79], v140 offset:53248
  s_add_u32 s18, s18, 1
  s_and_b32 s18, s18, 31
  s_add_u32 m0, s14, 16384
  s_lshl_b32 s15, s18, 7
  s_add_u32 s15, s15, s16
  buffer_load_dwordx4 v26, s[20:23], s15 offen lds
  buffer_load_dwordx4 v27, s[20:23], s15 offen offset:1024 lds
  s_waitcnt lgkmcnt(5)
  v_mfma_f32_32x32x16_bf16 a[32:47], v[120:123], v[116:119], a[32:47]
  ds_read_b128 v[84:87], v16 offset:0
  ds_read_b64_tr_b16 v[88:89], v35 offset:49664
  ds_read_b64_tr_b16 v[90:91], v140 offset:49664
  v_mfma_f32_32x32x16_bf16 a[48:63], v[124:127], v[116:119], a[48:63]
  ds_read_b64_tr_b16 v[92:93], v35 offset:53760
  ds_read_b64_tr_b16 v[94:95], v140 offset:53760
  s_add_u32 s19, s19, 1
  s_and_b32 s19, s19, 31
  s_add_u32 m0, s14, 0
  s_lshl_b32 s15, s19, 14
  s_add_u32 s15, s15, s17
  buffer_load_dwordx4 v28, s[80:83], s15 offen sc1 lds
  buffer_load_dwordx4 v28, s[80:83], s15 offen offset:1024 sc1 lds
  s_waitcnt lgkmcnt(5)
  v_mfma_f32_32x32x16_bf16 a[32:47], v[72:75], v[68:71], a[32:47]
  ds_read_b128 v[100:103], v19 offset:0
  ds_read_b64_tr_b16 v[104:105], v35 offset:50176
  ds_read_b64_tr_b16 v[106:107], v140 offset:50176
  v_mfma_f32_32x32x16_bf16 a[48:63], v[76:79], v[68:71], a[48:63]
  ds_read_b64_tr_b16 v[108:109], v35 offset:54272
  ds_read_b64_tr_b16 v[110:111], v140 offset:54272
  s_add_u32 m0, s14, 8192
  s_lshl_b32 s15, s19, 14
  s_add_u32 s15, s15, s17
  s_add_u32 s15, s15, 8192
  buffer_load_dwordx4 v28, s[80:83], s15 offen sc1 lds
  buffer_load_dwordx4 v28, s[80:83], s15 offen offset:1024 sc1 lds
  s_waitcnt lgkmcnt(5)
  v_mfma_f32_32x32x16_bf16 a[32:47], v[88:91], v[84:87], a[32:47]
  ds_read_b128 v[116:119], v22 offset:0
  ds_read_b64_tr_b16 v[120:121], v35 offset:50688
  ds_read_b64_tr_b16 v[122:123], v140 offset:50688
  v_mfma_f32_32x32x16_bf16 a[48:63], v[92:95], v[84:87], a[48:63]
  ds_read_b64_tr_b16 v[124:125], v35 offset:54784
  ds_read_b64_tr_b16 v[126:127], v140 offset:54784
  s_cmp_eq_u32 s9, 7
  s_cbranch_scc1 L_pf_126
L_pfb_127:
  s_waitcnt vmcnt(12)
  s_barrier
  s_waitcnt lgkmcnt(5)
  v_mfma_f32_32x32x16_bf16 a[32:47], v[104:107], v[100:103], a[32:47]
  ds_read_b128 v[68:71], v13 offset:24576
  ds_read_b64_tr_b16 v[72:73], v138 offset:8192
  ds_read_b64_tr_b16 v[74:75], v141 offset:8192
  v_mfma_f32_32x32x16_bf16 a[48:63], v[108:111], v[100:103], a[48:63]
  ds_read_b64_tr_b16 v[76:77], v138 offset:12288
  ds_read_b64_tr_b16 v[78:79], v141 offset:12288
  s_add_u32 s18, s18, 1
  s_and_b32 s18, s18, 31
  s_add_u32 m0, s14, 40960
  s_lshl_b32 s15, s18, 7
  s_add_u32 s15, s15, s16
  buffer_load_dwordx4 v26, s[20:23], s15 offen lds
  buffer_load_dwordx4 v27, s[20:23], s15 offen offset:1024 lds
  s_waitcnt lgkmcnt(5)
  v_mfma_f32_32x32x16_bf16 a[32:47], v[120:123], v[116:119], a[32:47]
  ds_read_b128 v[84:87], v16 offset:24576
  ds_read_b64_tr_b16 v[88:89], v138 offset:8704
  ds_read_b64_tr_b16 v[90:91], v141 offset:8704
  v_mfma_f32_32x32x16_bf16 a[48:63], v[124:127], v[116:119], a[48:63]
  ds_read_b64_tr_b16 v[92:93], v138 offset:12800
  ds_read_b64_tr_b16 v[94:95], v141 offset:12800
  s_add_u32 s19, s19, 1
  s_and_b32 s19, s19, 31
  s_add_u32 m0, s14, 24576
  s_lshl_b32 s15, s19, 14
  s_add_u32 s15, s15, s17
  buffer_load_dwordx4 v28, s[80:83], s15 offen sc1 lds
  buffer_load_dwordx4 v28, s[80:83], s15 offen offset:1024 sc1 lds
  s_waitcnt lgkmcnt(5)
  v_mfma_f32_32x32x16_bf16 a[32:47], v[72:75], v[68:71], a[32:47]
  ds_read_b128 v[100:103], v19 offset:24576
  ds_read_b64_tr_b16 v[104:105], v138 offset:9216
  ds_read_b64_tr_b16 v[106:107], v141 offset:9216
  v_mfma_f32_32x32x16_bf16 a[48:63], v[76:79], v[68:71], a[48:63]
  ds_read_b64_tr_b16 v[108:109], v138 offset:13312
  ds_read_b64_tr_b16 v[110:111], v141 offset:13312
  s_add_u32 m0, s14, 32768
  s_lshl_b32 s15, s19, 14
  s_add_u32 s15, s15, s17
  s_add_u32 s15, s15, 8192
  buffer_load_dwordx4 v28, s[80:83], s15 offen sc1 lds
  buffer_load_dwordx4 v28, s[80:83], s15 offen offset:1024 sc1 lds
  s_waitcnt lgkmcnt(5)
  v_mfma_f32_32x32x16_bf16 a[32:47], v[88:91], v[84:87], a[32:47]
  ds_read_b128 v[116:119], v22 offset:24576
  ds_read_b64_tr_b16 v[120:121], v138 offset:9728
  ds_read_b64_tr_b16 v[122:123], v141 offset:9728
  v_mfma_f32_32x32x16_bf16 a[48:63], v[92:95], v[84:87], a[48:63]
  ds_read_b64_tr_b16 v[124:125], v138 offset:13824
  ds_read_b64_tr_b16 v[126:127], v141 offset:13824
  s_cmp_eq_u32 s9, 7
  s_cbranch_scc1 L_pf_129
L_pfb_130:
  s_waitcnt vmcnt(12)
  s_barrier
  s_waitcnt lgkmcnt(5)
  v_mfma_f32_32x32x16_bf16 a[32:47], v[104:107], v[100:103], a[32:47]
  ds_read_b128 v[68:71], v13 offset:49152
  ds_read_b64_tr_b16 v[72:73], v138 offset:32768
  ds_read_b64_tr_b16 v[74:75], v141 offset:32768
  v_mfma_f32_32x32x16_bf16 a[48:63], v[108:111], v[100:103], a[48:63]
  ds_read_b64_tr_b16 v[76:77], v138 offset:36864
  ds_read_b64_tr_b16 v[78:79], v141 offset:36864
  s_add_u32 s18, s18, 1
  s_and_b32 s18, s18, 31
  s_add_u32 m0, s14, 65536
  s_lshl_b32 s15, s18, 7
  s_add_u32 s15, s15, s16
  buffer_load_dwordx4 v26, s[20:23], s15 offen lds
  buffer_load_dwordx4 v27, s[20:23], s15 offen offset:1024 lds
  s_waitcnt lgkmcnt(5)
  v_mfma_f32_32x32x16_bf16 a[32:47], v[120:123], v[116:119], a[32:47]
  ds_read_b128 v[84:87], v16 offset:49152
  ds_read_b64_tr_b16 v[88:89], v138 offset:33280
  ds_read_b64_tr_b16 v[90:91], v141 offset:33280
  v_mfma_f32_32x32x16_bf16 a[48:63], v[124:127], v[116:119], a[48:63]
  ds_read_b64_tr_b16 v[92:93], v138 offset:37376
  ds_read_b64_tr_b16 v[94:95], v141 offset:37376
  s_add_u32 s19, s19, 1
  s_and_b32 s19, s19, 31
  s_add_u32 m0, s14, 49152
  s_lshl_b32 s15, s19, 14
  s_add_u32 s15, s15, s17
  buffer_load_dwordx4 v28, s[80:83], s15 offen sc1 lds
  buffer_load_dwordx4 v28, s[80:83], s15 offen offset:1024 sc1 lds
  s_waitcnt lgkmcnt(5)
  v_mfma_f32_32x32x16_bf16 a[32:47], v[72:75], v[68:71], a[32:47]
  ds_read_b128 v[100:103], v19 offset:49152
  ds_read_b64_tr_b16 v[104:105], v138 offset:33792
  ds_read_b64_tr_b16 v[106:107], v141 offset:33792
  v_mfma_f32_32x32x16_bf16 a[48:63], v[76:79], v[68:71], a[48:63]
  ds_read_b64_tr_b16 v[108:109], v138 offset:37888
  ds_read_b64_tr_b16 v[110:111], v141 offset:37888
  s_add_u32 m0, s14, 57344
  s_lshl_b32 s15, s19, 14
  s_add_u32 s15, s15, s17
  s_add_u32 s15, s15, 8192
  buffer_load_dwordx4 v28, s[80:83], s15 offen sc1 lds
  buffer_load_dwordx4 v28, s[80:83], s15 offen offset:1024 sc1 lds
  s_waitcnt lgkmcnt(5)
  v_mfma_f32_32x32x16_bf16 a[32:47], v[88:91], v[84:87], a[32:47]
  ds_read_b128 v[116:119], v22 offset:49152
  ds_read_b64_tr_b16 v[120:121], v138 offset:34304
  ds_read_b64_tr_b16 v[122:123], v141 offset:34304
  v_mfma_f32_32x32x16_bf16 a[48:63], v[92:95], v[84:87], a[48:63]
  ds_read_b64_tr_b16 v[124:125], v138 offset:38400
  ds_read_b64_tr_b16 v[126:127], v141 offset:38400
  s_waitcnt vmcnt(12)
  s_barrier
  s_waitcnt lgkmcnt(5)
  v_mfma_f32_32x32x16_bf16 a[32:47], v[104:107], v[100:103], a[32:47]
  ds_read_b128 v[68:71], v12 offset:16384
  ds_read_b64_tr_b16 v[72:73], v35 offset:0
  ds_read_b64_tr_b16 v[74:75], v140 offset:0
  v_mfma_f32_32x32x16_bf16 a[48:63], v[108:111], v[100:103], a[48:63]
  ds_read_b64_tr_b16 v[76:77], v35 offset:4096
  ds_read_b64_tr_b16 v[78:79], v140 offset:4096
  s_add_u32 s18, s18, 1
  s_and_b32 s18, s18, 31
  s_add_u32 m0, s14, 90112
  s_lshl_b32 s15, s18, 7
  s_add_u32 s15, s15, s16
  buffer_load_dwordx4 v26, s[20:23], s15 offen lds
  buffer_load_dwordx4 v27, s[20:23], s15 offen offset:1024 lds
  s_waitcnt lgkmcnt(5)
  v_mfma_f32_32x32x16_bf16 a[32:47], v[120:123], v[116:119], a[32:47]
  ds_read_b128 v[84:87], v15 offset:16384
  ds_read_b64_tr_b16 v[88:89], v35 offset:512
  ds_read_b64_tr_b16 v[90:91], v140 offset:512
  v_mfma_f32_32x32x16_bf16 a[48:63], v[124:127], v[116:119], a[48:63]
  ds_read_b64_tr_b16 v[92:93], v35 offset:4608
  ds_read_b64_tr_b16 v[94:95], v140 offset:4608
  s_add_u32 s19, s19, 1
  s_and_b32 s19, s19, 31
  s_add_u32 m0, s14, 73728
  s_lshl_b32 s15, s19, 14
  s_add_u32 s15, s15, s17
  buffer_load_dwordx4 v28, s[80:83], s15 offen sc1 lds
  buffer_load_dwordx4 v28, s[80:83], s15 offen offset:1024 sc1 lds
  s_waitcnt lgkmcnt(5)
  v_mfma_f32_32x32x16_bf16 a[32:47], v[72:75], v[68:71], a[32:47]
  ds_read_b128 v[100:103], v18 offset:16384
  ds_read_b64_tr_b16 v[104:105], v35 offset:1024
  ds_read_b64_tr_b16 v[106:107], v140 offset:1024
  v_mfma_f32_32x32x16_bf16 a[48:63], v[76:79], v[68:71], a[48:63]
  ds_read_b64_tr_b16 v[108:109], v35 offset:5120
  ds_read_b64_tr_b16 v[110:111], v140 offset:5120
  s_add_u32 m0, s14, 81920
  s_lshl_b32 s15, s19, 14
  s_add_u32 s15, s15, s17
  s_add_u32 s15, s15, 8192
  buffer_load_dwordx4 v28, s[80:83], s15 offen sc1 lds
  buffer_load_dwordx4 v28, s[80:83], s15 offen offset:1024 sc1 lds
  s_waitcnt lgkmcnt(5)
  v_mfma_f32_32x32x16_bf16 a[32:47], v[88:91], v[84:87], a[32:47]
  ds_read_b128 v[116:119], v21 offset:16384
  ds_read_b64_tr_b16 v[120:121], v35 offset:1536
  ds_read_b64_tr_b16 v[122:123], v140 offset:1536
  v_mfma_f32_32x32x16_bf16 a[48:63], v[92:95], v[84:87], a[48:63]
  ds_read_b64_tr_b16 v[124:125], v35 offset:5632
  ds_read_b64_tr_b16 v[126:127], v140 offset:5632
  s_waitcnt vmcnt(12)
  s_barrier
  s_waitcnt lgkmcnt(5)
  v_mfma_f32_32x32x16_bf16 a[32:47], v[104:107], v[100:103], a[32:47]
  ds_read_b128 v[68:71], v12 offset:40960
  ds_read_b64_tr_b16 v[72:73], v35 offset:24576
  ds_read_b64_tr_b16 v[74:75], v140 offset:24576
  v_mfma_f32_32x32x16_bf16 a[48:63], v[108:111], v[100:103], a[48:63]
  ds_read_b64_tr_b16 v[76:77], v35 offset:28672
  ds_read_b64_tr_b16 v[78:79], v140 offset:28672
  s_add_u32 s18, s18, 1
  s_and_b32 s18, s18, 31
  s_add_u32 m0, s14, 114688
  s_lshl_b32 s15, s18, 7
  s_add_u32 s15, s15, s16
  buffer_load_dwordx4 v26, s[20:23], s15 offen lds
  buffer_load_dwordx4 v27, s[20:23], s15 offen offset:1024 lds
  s_waitcnt lgkmcnt(5)
  v_mfma_f32_32x32x16_bf16 a[32:47], v[120:123], v[116:119], a[32:47]
  ds_read_b128 v[84:87], v15 offset:40960
  ds_read_b64_tr_b16 v[88:89], v35 offset:25088
  ds_read_b64_tr_b16 v[90:91], v140 offset:25088
  v_mfma_f32_32x32x16_bf16 a[48:63], v[124:127], v[116:119], a[48:63]
  ds_read_b64_tr_b16 v[92:93], v35 offset:29184
  ds_read_b64_tr_b16 v[94:95], v140 offset:29184
  s_add_u32 s19, s19, 1
  s_and_b32 s19, s19, 31
  s_add_u32 m0, s14, 98304
  s_lshl_b32 s15, s19, 14
  s_add_u32 s15, s15, s17
  buffer_load_dwordx4 v28, s[80:83], s15 offen sc1 lds
  buffer_load_dwordx4 v28, s[80:83], s15 offen offset:1024 sc1 lds
  s_waitcnt lgkmcnt(5)
  v_mfma_f32_32x32x16_bf16 a[32:47], v[72:75], v[68:71], a[32:47]
  ds_read_b128 v[100:103], v18 offset:40960
  ds_read_b64_tr_b16 v[104:105], v35 offset:25600
  ds_read_b64_tr_b16 v[106:107], v140 offset:25600
  v_mfma_f32_32x32x16_bf16 a[48:63], v[76:79], v[68:71], a[48:63]
  ds_read_b64_tr_b16 v[108:109], v35 offset:29696
  ds_read_b64_tr_b16 v[110:111], v140 offset:29696
  s_add_u32 m0, s14, 106496
  s_lshl_b32 s15, s19, 14
  s_add_u32 s15, s15, s17
  s_add_u32 s15, s15, 8192
  buffer_load_dwordx4 v28, s[80:83], s15 offen sc1 lds
  buffer_load_dwordx4 v28, s[80:83], s15 offen offset:1024 sc1 lds
  s_waitcnt lgkmcnt(5)
  v_mfma_f32_32x32x16_bf16 a[32:47], v[88:91], v[84:87], a[32:47]
  ds_read_b128 v[116:119], v21 offset:40960
  ds_read_b64_tr_b16 v[120:121], v35 offset:26112
  ds_read_b64_tr_b16 v[122:123], v140 offset:26112
  v_mfma_f32_32x32x16_bf16 a[48:63], v[92:95], v[84:87], a[48:63]
  ds_read_b64_tr_b16 v[124:125], v35 offset:30208
  ds_read_b64_tr_b16 v[126:127], v140 offset:30208
  s_waitcnt vmcnt(12)
  s_barrier
  s_waitcnt lgkmcnt(5)
  v_mfma_f32_32x32x16_bf16 a[32:47], v[104:107], v[100:103], a[32:47]
  ds_read_b128 v[68:71], v13 offset:0
  ds_read_b64_tr_b16 v[72:73], v35 offset:49152
  ds_read_b64_tr_b16 v[74:75], v140 offset:49152
  v_mfma_f32_32x32x16_bf16 a[48:63], v[108:111], v[100:103], a[48:63]
  ds_read_b64_tr_b16 v[76:77], v35 offset:53248
  ds_read_b64_tr_b16 v[78:79], v140 offset:53248
  s_add_u32 s18, s18, 1
  s_and_b32 s18, s18, 31
  s_add_u32 m0, s14, 16384
  s_lshl_b32 s15, s18, 7
  s_add_u32 s15, s15, s16
  buffer_load_dwordx4 v26, s[20:23], s15 offen lds
  buffer_load_dwordx4 v27, s[20:23], s15 offen offset:1024 lds
  s_waitcnt lgkmcnt(5)
  v_mfma_f32_32x32x16_bf16 a[32:47], v[120:123], v[116:119], a[32:47]
  ds_read_b128 v[84:87], v16 offset:0
  ds_read_b64_tr_b16 v[88:89], v35 offset:49664
  ds_read_b64_tr_b16 v[90:91], v140 offset:49664
  v_mfma_f32_32x32x16_bf16 a[48:63], v[124:127], v[116:119], a[48:63]
  ds_read_b64_tr_b16 v[92:93], v35 offset:53760
  ds_read_b64_tr_b16 v[94:95], v140 offset:53760
  s_add_u32 s19, s19, 1
  s_and_b32 s19, s19, 31
  s_add_u32 m0, s14, 0
  s_lshl_b32 s15, s19, 14
  s_add_u32 s15, s15, s17
  buffer_load_dwordx4 v28, s[80:83], s15 offen sc1 lds
  buffer_load_dwordx4 v28, s[80:83], s15 offen offset:1024 sc1 lds
  s_waitcnt lgkmcnt(5)
  v_mfma_f32_32x32x16_bf16 a[32:47], v[72:75], v[68:71], a[32:47]
  ds_read_b128 v[100:103], v19 offset:0
  ds_read_b64_tr_b16 v[104:105], v35 offset:50176
  ds_read_b64_tr_b16 v[106:107], v140 offset:50176
  v_mfma_f32_32x32x16_bf16 a[48:63], v[76:79], v[68:71], a[48:63]
  ds_read_b64_tr_b16 v[108:109], v35 offset:54272
  ds_read_b64_tr_b16 v[110:111], v140 offset:54272
  s_add_u32 m0, s14, 8192
  s_lshl_b32 s15, s19, 14
  s_add_u32 s15, s15, s17
  s_add_u32 s15, s15, 8192
  buffer_load_dwordx4 v28, s[80:83], s15 offen sc1 lds
  buffer_load_dwordx4 v28, s[80:83], s15 offen offset:1024 sc1 lds
  s_waitcnt lgkmcnt(5)
  v_mfma_f32_32x32x16_bf16 a[32:47], v[88:91], v[84:87], a[32:47]
  ds_read_b128 v[116:119], v22 offset:0
  ds_read_b64_tr_b16 v[120:121], v35 offset:50688
  ds_read_b64_tr_b16 v[122:123], v140 offset:50688
  v_mfma_f32_32x32x16_bf16 a[48:63], v[92:95], v[84:87], a[48:63]
  ds_read_b64_tr_b16 v[124:125], v35 offset:54784
  ds_read_b64_tr_b16 v[126:127], v140 offset:54784
  s_waitcnt vmcnt(12)
  s_barrier
  s_waitcnt lgkmcnt(5)
  v_mfma_f32_32x32x16_bf16 a[32:47], v[104:107], v[100:103], a[32:47]
  ds_read_b128 v[68:71], v13 offset:24576
  ds_read_b64_tr_b16 v[72:73], v138 offset:8192
  ds_read_b64_tr_b16 v[74:75], v141 offset:8192
  v_mfma_f32_32x32x16_bf16 a[48:63], v[108:111], v[100:103], a[48:63]
  ds_read_b64_tr_b16 v[76:77], v138 offset:12288
  ds_read_b64_tr_b16 v[78:79], v141 offset:12288
  s_add_u32 s18, s18, 1
  s_and_b32 s18, s18, 31
  s_add_u32 m0, s14, 40960
  s_lshl_b32 s15, s18, 7
  s_add_u32 s15, s15, s16
  buffer_load_dwordx4 v26, s[20:23], s15 offen lds
  buffer_load_dwordx4 v27, s[20:23], s15 offen offset:1024 lds
  s_waitcnt lgkmcnt(5)
  v_mfma_f32_32x32x16_bf16 a[32:47], v[120:123], v[116:119], a[32:47]
  ds_read_b128 v[84:87], v16 offset:24576
  ds_read_b64_tr_b16 v[88:89], v138 offset:8704
  ds_read_b64_tr_b16 v[90:91], v141 offset:8704
  v_mfma_f32_32x32x16_bf16 a[48:63], v[124:127], v[116:119], a[48:63]
  ds_read_b64_tr_b16 v[92:93], v138 offset:12800
  ds_read_b64_tr_b16 v[94:95], v141 offset:12800
  s_add_u32 s19, s19, 1
  s_and_b32 s19, s19, 31
  s_add_u32 m0, s14, 24576
  s_lshl_b32 s15, s19, 14
  s_add_u32 s15, s15, s17
  buffer_load_dwordx4 v28, s[80:83], s15 offen sc1 lds
  buffer_load_dwordx4 v28, s[80:83], s15 offen offset:1024 sc1 lds
  s_waitcnt lgkmcnt(5)
  v_mfma_f32_32x32x16_bf16 a[32:47], v[72:75], v[68:71], a[32:47]
  ds_read_b128 v[100:103], v19 offset:24576
  ds_read_b64_tr_b16 v[104:105], v138 offset:9216
  ds_read_b64_tr_b16 v[106:107], v141 offset:9216
  v_mfma_f32_32x32x16_bf16 a[48:63], v[76:79], v[68:71], a[48:63]
  ds_read_b64_tr_b16 v[108:109], v138 offset:13312
  ds_read_b64_tr_b16 v[110:111], v141 offset:13312
  v_accvgpr_read_b32 v50, a14
  v_mul_f32 v143, v50, v50
  v_fma_f32 v143, v143, v134, v132
  v_mul_f32 v143, v143, v50
  v_exp_f32 v143, v143
  s_add_u32 m0, s14, 32768
  s_lshl_b32 s15, s19, 14
  s_add_u32 s15, s15, s17
  s_add_u32 s15, s15, 8192
  buffer_load_dwordx4 v28, s[80:83], s15 offen sc1 lds
  buffer_load_dwordx4 v28, s[80:83], s15 offen offset:1024 sc1 lds
  s_waitcnt lgkmcnt(5)
  v_mfma_f32_32x32x16_bf16 a[32:47], v[88:91], v[84:87], a[32:47]
  ds_read_b128 v[116:119], v22 offset:24576
  ds_read_b64_tr_b16 v[120:121], v138 offset:9728
  ds_read_b64_tr_b16 v[122:123], v141 offset:9728
  v_mfma_f32_32x32x16_bf16 a[48:63], v[92:95], v[84:87], a[48:63]
  ds_read_b64_tr_b16 v[124:125], v138 offset:13824
  ds_read_b64_tr_b16 v[126:127], v141 offset:13824
  v_add_f32 v143, 1.0, v143
  v_rcp_f32 v143, v143
  s_nop 0
  v_mul_f32 v50, v50, v143
  s_waitcnt vmcnt(12)
  s_barrier
  s_mul_i32 s54, s11, 32
  s_add_u32 s54, s54, s10
  s_lshl_b32 s54, s54, 7
  s_add_u32 s54, s54, 102400
  s_cmp_eq_u32 s3, 0
  s_cselect_b32 exec_lo, 1, 0
  s_mov_b32 exec_hi, 0
  buffer_store_dword v7, v8, s[56:59], s54 offen sc1
  s_mov_b64 exec, -1
  s_waitcnt lgkmcnt(5)
  v_mfma_f32_32x32x16_bf16 a[32:47], v[104:107], v[100:103], a[32:47]
  ds_read_b128 v[68:71], v13 offset:49152
  ds_read_b64_tr_b16 v[72:73], v138 offset:32768
  ds_read_b64_tr_b16 v[74:75], v141 offset:32768
  v_mfma_f32_32x32x16_bf16 a[48:63], v[108:111], v[100:103], a[48:63]
  ds_read_b64_tr_b16 v[76:77], v138 offset:36864
  ds_read_b64_tr_b16 v[78:79], v141 offset:36864
  v_accvgpr_read_b32 v51, a15
  v_mul_f32 v143, v51, v51
  v_fma_f32 v143, v143, v134, v132
  v_mul_f32 v143, v143, v51
  v_exp_f32 v143, v143
  s_add_u32 s18, s18, 1
  s_and_b32 s18, s18, 31
  s_add_u32 m0, s14, 65536
  s_lshl_b32 s15, s18, 7
  s_add_u32 s15, s15, s16
  buffer_load_dwordx4 v26, s[20:23], s15 offen lds
  buffer_load_dwordx4 v27, s[20:23], s15 offen offset:1024 lds
  s_waitcnt lgkmcnt(5)
  v_mfma_f32_32x32x16_bf16 a[32:47], v[120:123], v[116:119], a[32:47]
  ds_read_b128 v[84:87], v16 offset:49152
  ds_read_b64_tr_b16 v[88:89], v138 offset:33280
  ds_read_b64_tr_b16 v[90:91], v141 offset:33280
  v_mfma_f32_32x32x16_bf16 a[48:63], v[124:127], v[116:119], a[48:63]
  ds_read_b64_tr_b16 v[92:93], v138 offset:37376
  ds_read_b64_tr_b16 v[94:95], v141 offset:37376
  v_add_f32 v143, 1.0, v143
  v_rcp_f32 v143, v143
  s_nop 0
  v_mul_f32 v51, v51, v143
  s_add_u32 s19, s19, 1
  s_and_b32 s19, s19, 31
  s_add_u32 m0, s14, 49152
  s_lshl_b32 s15, s19, 14
  s_add_u32 s15, s15, s17
  buffer_load_dwordx4 v28, s[80:83], s15 offen sc1 lds
  buffer_load_dwordx4 v28, s[80:83], s15 offen offset:1024 sc1 lds
  s_waitcnt lgkmcnt(5)
  v_mfma_f32_32x32x16_bf16 a[32:47], v[72:75], v[68:71], a[32:47]
  ds_read_b128 v[100:103], v19 offset:49152
  ds_read_b64_tr_b16 v[104:105], v138 offset:33792
  ds_read_b64_tr_b16 v[106:107], v141 offset:33792
  v_mfma_f32_32x32x16_bf16 a[48:63], v[76:79], v[68:71], a[48:63]
  ds_read_b64_tr_b16 v[108:109], v138 offset:37888
  ds_read_b64_tr_b16 v[110:111], v141 offset:37888
  v_accvgpr_read_b32 v52, a16
  v_mul_f32 v143, v52, v52
  v_fma_f32 v143, v143, v134, v132
  v_mul_f32 v143, v143, v52
  v_exp_f32 v143, v143
  s_add_u32 m0, s14, 57344
  s_lshl_b32 s15, s19, 14
  s_add_u32 s15, s15, s17
  s_add_u32 s15, s15, 8192
  buffer_load_dwordx4 v28, s[80:83], s15 offen sc1 lds
  buffer_load_dwordx4 v28, s[80:83], s15 offen offset:1024 sc1 lds
  s_waitcnt lgkmcnt(5)
  v_mfma_f32_32x32x16_bf16 a[32:47], v[88:91], v[84:87], a[32:47]
  ds_read_b128 v[116:119], v22 offset:49152
  ds_read_b64_tr_b16 v[120:121], v138 offset:34304
  ds_read_b64_tr_b16 v[122:123], v141 offset:34304
  v_mfma_f32_32x32x16_bf16 a[48:63], v[92:95], v[84:87], a[48:63]
  ds_read_b64_tr_b16 v[124:125], v138 offset:38400
  ds_read_b64_tr_b16 v[126:127], v141 offset:38400
  v_add_f32 v143, 1.0, v143
  v_rcp_f32 v143, v143
  s_nop 0
  v_mul_f32 v52, v52, v143
  s_waitcnt vmcnt(13)
  s_barrier
  s_waitcnt lgkmcnt(5)
  v_mfma_f32_32x32x16_bf16 a[32:47], v[104:107], v[100:103], a[32:47]
  ds_read_b128 v[68:71], v12 offset:16384
  ds_read_b64_tr_b16 v[72:73], v35 offset:0
  ds_read_b64_tr_b16 v[74:75], v140 offset:0
  v_mfma_f32_32x32x16_bf16 a[48:63], v[108:111], v[100:103], a[48:63]
  ds_read_b64_tr_b16 v[76:77], v35 offset:4096
  ds_read_b64_tr_b16 v[78:79], v140 offset:4096
  v_accvgpr_read_b32 v53, a17
  v_mul_f32 v143, v53, v53
  v_fma_f32 v143, v143, v134, v132
  v_mul_f32 v143, v143, v53
  v_exp_f32 v143, v143
  s_add_u32 s18, s18, 1
  s_and_b32 s18, s18, 31
  s_add_u32 m0, s14, 90112
  s_lshl_b32 s15, s18, 7
  s_add_u32 s15, s15, s16
  buffer_load_dwordx4 v26, s[20:23], s15 offen lds
  buffer_load_dwordx4 v27, s[20:23], s15 offen offset:1024 lds
  s_waitcnt lgkmcnt(5)
  v_mfma_f32_32x32x16_bf16 a[32:47], v[120:123], v[116:119], a[32:47]
  ds_read_b128 v[84:87], v15 offset:16384
  ds_read_b64_tr_b16 v[88:89], v35 offset:512
  ds_read_b64_tr_b16 v[90:91], v140 offset:512
  v_mfma_f32_32x32x16_bf16 a[48:63], v[124:127], v[116:119], a[48:63]
  ds_read_b64_tr_b16 v[92:93], v35 offset:4608
  ds_read_b64_tr_b16 v[94:95], v140 offset:4608
  v_add_f32 v143, 1.0, v143
  v_rcp_f32 v143, v143
  s_nop 0
  v_mul_f32 v53, v53, v143
  s_add_u32 s19, s19, 1
  s_and_b32 s19, s19, 31
  s_add_u32 m0, s14, 73728
  s_lshl_b32 s15, s19, 14
  s_add_u32 s15, s15, s17
  buffer_load_dwordx4 v28, s[80:83], s15 offen sc1 lds
  buffer_load_dwordx4 v28, s[80:83], s15 offen offset:1024 sc1 lds
  s_waitcnt lgkmcnt(5)
  v_mfma_f32_32x32x16_bf16 a[32:47], v[72:75], v[68:71], a[32:47]
  ds_read_b128 v[100:103], v18 offset:16384
  ds_read_b64_tr_b16 v[104:105], v35 offset:1024
  ds_read_b64_tr_b16 v[106:107], v140 offset:1024
  v_mfma_f32_32x32x16_bf16 a[48:63], v[76:79], v[68:71], a[48:63]
  ds_read_b64_tr_b16 v[108:109], v35 offset:5120
  ds_read_b64_tr_b16 v[110:111], v140 offset:5120
  v_accvgpr_read_b32 v54, a18
  v_mul_f32 v143, v54, v54
  v_fma_f32 v143, v143, v134, v132
  v_mul_f32 v143, v143, v54
  v_exp_f32 v143, v143
  s_add_u32 m0, s14, 81920
  s_lshl_b32 s15, s19, 14
  s_add_u32 s15, s15, s17
  s_add_u32 s15, s15, 8192
  buffer_load_dwordx4 v28, s[80:83], s15 offen sc1 lds
  buffer_load_dwordx4 v28, s[80:83], s15 offen offset:1024 sc1 lds
  s_waitcnt lgkmcnt(5)
  v_mfma_f32_32x32x16_bf16 a[32:47], v[88:91], v[84:87], a[32:47]
  ds_read_b128 v[116:119], v21 offset:16384
  ds_read_b64_tr_b16 v[120:121], v35 offset:1536
  ds_read_b64_tr_b16 v[122:123], v140 offset:1536
  v_mfma_f32_32x32x16_bf16 a[48:63], v[92:95], v[84:87], a[48:63]
  ds_read_b64_tr_b16 v[124:125], v35 offset:5632
  ds_read_b64_tr_b16 v[126:127], v140 offset:5632
  v_add_f32 v143, 1.0, v143
  v_rcp_f32 v143, v143
  s_nop 0
  v_mul_f32 v54, v54, v143
  s_waitcnt vmcnt(13)
  s_barrier
  s_waitcnt lgkmcnt(5)
  v_mfma_f32_32x32x16_bf16 a[32:47], v[104:107], v[100:103], a[32:47]
  ds_read_b128 v[68:71], v12 offset:40960
  ds_read_b64_tr_b16 v[72:73], v35 offset:24576
  ds_read_b64_tr_b16 v[74:75], v140 offset:24576
  v_mfma_f32_32x32x16_bf16 a[48:63], v[108:111], v[100:103], a[48:63]
  ds_read_b64_tr_b16 v[76:77], v35 offset:28672
  ds_read_b64_tr_b16 v[78:79], v140 offset:28672
  v_accvgpr_read_b32 v55, a19
  v_mul_f32 v143, v55, v55
  v_fma_f32 v143, v143, v134, v132
  v_mul_f32 v143, v143, v55
  v_exp_f32 v143, v143
  s_add_u32 s18, s18, 1
  s_and_b32 s18, s18, 31
  s_add_u32 m0, s14, 114688
  s_lshl_b32 s15, s18, 7
  s_add_u32 s15, s15, s16
  buffer_load_dwordx4 v26, s[20:23], s15 offen lds
  buffer_load_dwordx4 v27, s[20:23], s15 offen offset:1024 lds
  s_waitcnt lgkmcnt(5)
  v_mfma_f32_32x32x16_bf16 a[32:47], v[120:123], v[116:119], a[32:47]
  ds_read_b128 v[84:87], v15 offset:40960
  ds_read_b64_tr_b16 v[88:89], v35 offset:25088
  ds_read_b64_tr_b16 v[90:91], v140 offset:25088
  v_mfma_f32_32x32x16_bf16 a[48:63], v[124:127], v[116:119], a[48:63]
  ds_read_b64_tr_b16 v[92:93], v35 offset:29184
  ds_read_b64_tr_b16 v[94:95], v140 offset:29184
  v_add_f32 v143, 1.0, v143
  v_rcp_f32 v143, v143
  s_nop 0
  v_mul_f32 v55, v55, v143
  s_add_u32 s19, s19, 1
  s_and_b32 s19, s19, 31
  s_add_u32 m0, s14, 98304
  s_lshl_b32 s15, s19, 14
  s_add_u32 s15, s15, s17
  buffer_load_dwordx4 v28, s[80:83], s15 offen sc1 lds
  buffer_load_dwordx4 v28, s[80:83], s15 offen offset:1024 sc1 lds
  s_waitcnt lgkmcnt(5)
  v_mfma_f32_32x32x16_bf16 a[32:47], v[72:75], v[68:71], a[32:47]
  ds_read_b128 v[100:103], v18 offset:40960
  ds_read_b64_tr_b16 v[104:105], v35 offset:25600
  ds_read_b64_tr_b16 v[106:107], v140 offset:25600
  v_mfma_f32_32x32x16_bf16 a[48:63], v[76:79], v[68:71], a[48:63]
  ds_read_b64_tr_b16 v[108:109], v35 offset:29696
  ds_read_b64_tr_b16 v[110:111], v140 offset:29696
  v_accvgpr_read_b32 v56, a20
  v_mul_f32 v143, v56, v56
  v_fma_f32 v143, v143, v134, v132
  v_mul_f32 v143, v143, v56
  v_exp_f32 v143, v143
  s_add_u32 m0, s14, 106496
  s_lshl_b32 s15, s19, 14
  s_add_u32 s15, s15, s17
  s_add_u32 s15, s15, 8192
  buffer_load_dwordx4 v28, s[80:83], s15 offen sc1 lds
  buffer_load_dwordx4 v28, s[80:83], s15 offen offset:1024 sc1 lds
  s_waitcnt lgkmcnt(5)
  v_mfma_f32_32x32x16_bf16 a[32:47], v[88:91], v[84:87], a[32:47]
  ds_read_b128 v[116:119], v21 offset:40960
  ds_read_b64_tr_b16 v[120:121], v35 offset:26112
  ds_read_b64_tr_b16 v[122:123], v140 offset:26112
  v_mfma_f32_32x32x16_bf16 a[48:63], v[92:95], v[84:87], a[48:63]
  ds_read_b64_tr_b16 v[124:125], v35 offset:30208
  ds_read_b64_tr_b16 v[126:127], v140 offset:30208
  v_add_f32 v143, 1.0, v143
  v_rcp_f32 v143, v143
  s_nop 0
  v_mul_f32 v56, v56, v143
  s_waitcnt vmcnt(12)
  s_barrier
  s_waitcnt lgkmcnt(5)
  v_mfma_f32_32x32x16_bf16 a[32:47], v[104:107], v[100:103], a[32:47]
  ds_read_b128 v[68:71], v13 offset:0
  ds_read_b64_tr_b16 v[72:73], v35 offset:49152
  ds_read_b64_tr_b16 v[74:75], v140 offset:49152
  v_mfma_f32_32x32x16_bf16 a[48:63], v[108:111], v[100:103], a[48:63]
  ds_read_b64_tr_b16 v[76:77], v35 offset:53248
  ds_read_b64_tr_b16 v[78:79], v140 offset:53248
  v_accvgpr_read_b32 v57, a21
  v_mul_f32 v143, v57, v57
  v_fma_f32 v143, v143, v134, v132
  v_mul_f32 v143, v143, v57
  v_exp_f32 v143, v143
  s_add_u32 s18, s18, 1
  s_and_b32 s18, s18, 31
  s_add_u32 m0, s14, 16384
  s_lshl_b32 s15, s18, 7
  s_add_u32 s15, s15, s16
  buffer_load_dwordx4 v26, s[20:23], s15 offen lds
  buffer_load_dwordx4 v27, s[20:23], s15 offen offset:1024 lds
  s_waitcnt lgkmcnt(5)
  v_mfma_f32_32x32x16_bf16 a[32:47], v[120:123], v[116:119], a[32:47]
  ds_read_b128 v[84:87], v16 offset:0
  ds_read_b64_tr_b16 v[88:89], v35 offset:49664
  ds_read_b64_tr_b16 v[90:91], v140 offset:49664
  v_mfma_f32_32x32x16_bf16 a[48:63], v[124:127], v[116:119], a[48:63]
  ds_read_b64_tr_b16 v[92:93], v35 offset:53760
  ds_read_b64_tr_b16 v[94:95], v140 offset:53760
  v_add_f32 v143, 1.0, v143
  v_rcp_f32 v143, v143
  s_nop 0
  v_mul_f32 v57, v57, v143
  s_add_u32 s19, s19, 1
  s_and_b32 s19, s19, 31
  s_add_u32 m0, s14, 0
  s_lshl_b32 s15, s19, 14
  s_add_u32 s15, s15, s17
  buffer_load_dwordx4 v28, s[80:83], s15 offen sc1 lds
  buffer_load_dwordx4 v28, s[80:83], s15 offen offset:1024 sc1 lds
  s_mul_i32 s24, s8, 114688
  s_lshl_b32 s25, s9, 1
  s_add_u32 s25, s25, s53
  s_lshl_b32 s25, s25, 13
  s_add_u32 s24, s24, s25
  s_lshl_b32 s25, s52, 10
  s_add_u32 s24, s24, s25
  s_add_u32 s24, s24, 11534336
  s_add_u32 s25, s24, 4096
  v_lshlrev_b32 v136, 16, v11
  v_lshlrev_b32 v137, 16, v11
  v_bfe_u32 v1, v5, 3, 1
  v_xor_b32 v1, v1, v6
  v_lshlrev_b32 v1, 4, v1
  v_lshl_add_u32 v11, v5, 5, v1
  s_waitcnt lgkmcnt(5)
  v_mfma_f32_32x32x16_bf16 a[32:47], v[72:75], v[68:71], a[32:47]
  ds_read_b128 v[100:103], v19 offset:0
  ds_read_b64_tr_b16 v[104:105], v35 offset:50176
  ds_read_b64_tr_b16 v[106:107], v140 offset:50176
  v_mfma_f32_32x32x16_bf16 a[48:63], v[76:79], v[68:71], a[48:63]
  ds_read_b64_tr_b16 v[108:109], v35 offset:54272
  ds_read_b64_tr_b16 v[110:111], v140 offset:54272
  v_accvgpr_read_b32 v58, a22
  v_mul_f32 v143, v58, v58
  v_fma_f32 v143, v143, v134, v132
  v_mul_f32 v143, v143, v58
  v_exp_f32 v143, v143
  s_add_u32 m0, s14, 8192
  s_lshl_b32 s15, s19, 14
  s_add_u32 s15, s15, s17
  s_add_u32 s15, s15, 8192
  buffer_load_dwordx4 v28, s[80:83], s15 offen sc1 lds
  buffer_load_dwordx4 v28, s[80:83], s15 offen offset:1024 sc1 lds
  s_waitcnt lgkmcnt(5)
  v_mfma_f32_32x32x16_bf16 a[32:47], v[88:91], v[84:87], a[32:47]
  ds_read_b128 v[116:119], v22 offset:0
  ds_read_b64_tr_b16 v[120:121], v35 offset:50688
  ds_read_b64_tr_b16 v[122:123], v140 offset:50688
  v_mfma_f32_32x32x16_bf16 a[48:63], v[92:95], v[84:87], a[48:63]
  ds_read_b64_tr_b16 v[124:125], v35 offset:54784
  ds_read_b64_tr_b16 v[126:127], v140 offset:54784
  v_add_f32 v143, 1.0, v143
  v_rcp_f32 v143, v143
  s_nop 0
  v_mul_f32 v58, v58, v143
  s_waitcnt vmcnt(12)
  s_barrier
  s_waitcnt lgkmcnt(5)
  v_mfma_f32_32x32x16_bf16 a[32:47], v[104:107], v[100:103], a[32:47]
  ds_read_b128 v[68:71], v13 offset:24576
  ds_read_b64_tr_b16 v[72:73], v138 offset:8192
  ds_read_b64_tr_b16 v[74:75], v141 offset:8192
  v_mfma_f32_32x32x16_bf16 a[48:63], v[108:111], v[100:103], a[48:63]
  ds_read_b64_tr_b16 v[76:77], v138 offset:12288
  ds_read_b64_tr_b16 v[78:79], v141 offset:12288
  v_accvgpr_read_b32 v59, a23
  v_mul_f32 v143, v59, v59
  v_fma_f32 v143, v143, v134, v132
  v_mul_f32 v143, v143, v59
  v_exp_f32 v143, v143
  s_add_u32 s18, s18, 1
  s_and_b32 s18, s18, 31
  s_add_u32 m0, s14, 40960
  s_lshl_b32 s15, s18, 7
  s_add_u32 s15, s15, s16
  buffer_load_dwordx4 v26, s[20:23], s15 offen lds
  buffer_load_dwordx4 v27, s[20:23], s15 offen offset:1024 lds
  s_waitcnt lgkmcnt(5)
  v_mfma_f32_32x32x16_bf16 a[32:47], v[120:123], v[116:119], a[32:47]
  ds_read_b128 v[84:87], v16 offset:24576
  ds_read_b64_tr_b16 v[88:89], v138 offset:8704
  ds_read_b64_tr_b16 v[90:91], v141 offset:8704
  v_mfma_f32_32x32x16_bf16 a[48:63], v[124:127], v[116:119], a[48:63]
  ds_read_b64_tr_b16 v[92:93], v138 offset:12800
  ds_read_b64_tr_b16 v[94:95], v141 offset:12800
  v_add_f32 v143, 1.0, v143
  v_rcp_f32 v143, v143
  s_nop 0
  v_mul_f32 v59, v59, v143
  s_add_u32 s19, s19, 1
  s_and_b32 s19, s19, 31
  s_add_u32 m0, s14, 24576
  s_lshl_b32 s15, s19, 14
  s_add_u32 s15, s15, s17
  buffer_load_dwordx4 v28, s[80:83], s15 offen sc1 lds
  buffer_load_dwordx4 v28, s[80:83], s15 offen offset:1024 sc1 lds
  s_waitcnt lgkmcnt(5)
  v_mfma_f32_32x32x16_bf16 a[32:47], v[72:75], v[68:71], a[32:47]
  ds_read_b128 v[100:103], v19 offset:24576
  ds_read_b64_tr_b16 v[104:105], v138 offset:9216
  ds_read_b64_tr_b16 v[106:107], v141 offset:9216
  v_mfma_f32_32x32x16_bf16 a[48:63], v[76:79], v[68:71], a[48:63]
  ds_read_b64_tr_b16 v[108:109], v138 offset:13312
  ds_read_b64_tr_b16 v[110:111], v141 offset:13312
  v_accvgpr_read_b32 v60, a24
  v_mul_f32 v143, v60, v60
  v_fma_f32 v143, v143, v134, v132
  v_mul_f32 v143, v143, v60
  v_exp_f32 v143, v143
  s_add_u32 m0, s14, 32768
  s_lshl_b32 s15, s19, 14
  s_add_u32 s15, s15, s17
  s_add_u32 s15, s15, 8192
  buffer_load_dwordx4 v28, s[80:83], s15 offen sc1 lds
  buffer_load_dwordx4 v28, s[80:83], s15 offen offset:1024 sc1 lds
  s_waitcnt lgkmcnt(5)
  v_mfma_f32_32x32x16_bf16 a[32:47], v[88:91], v[84:87], a[32:47]
  ds_read_b128 v[116:119], v22 offset:24576
  ds_read_b64_tr_b16 v[120:121], v138 offset:9728
  ds_read_b64_tr_b16 v[122:123], v141 offset:9728
  v_mfma_f32_32x32x16_bf16 a[48:63], v[92:95], v[84:87], a[48:63]
  ds_read_b64_tr_b16 v[124:125], v138 offset:13824
  ds_read_b64_tr_b16 v[126:127], v141 offset:13824
  v_add_f32 v143, 1.0, v143
  v_rcp_f32 v143, v143
  s_nop 0
  v_mul_f32 v60, v60, v143
  s_waitcnt vmcnt(12)
  s_barrier
  s_waitcnt lgkmcnt(5)
  v_mfma_f32_32x32x16_bf16 a[32:47], v[104:107], v[100:103], a[32:47]
  ds_read_b128 v[68:71], v13 offset:49152
  ds_read_b64_tr_b16 v[72:73], v138 offset:32768
  ds_read_b64_tr_b16 v[74:75], v141 offset:32768
  v_mfma_f32_32x32x16_bf16 a[48:63], v[108:111], v[100:103], a[48:63]
  ds_read_b64_tr_b16 v[76:77], v138 offset:36864
  ds_read_b64_tr_b16 v[78:79], v141 offset:36864
  v_accvgpr_read_b32 v61, a25
  v_mul_f32 v143, v61, v61
  v_fma_f32 v143, v143, v134, v132
  v_mul_f32 v143, v143, v61
  v_exp_f32 v143, v143
  s_waitcnt lgkmcnt(5)
  v_mfma_f32_32x32x16_bf16 a[32:47], v[120:123], v[116:119], a[32:47]
  ds_read_b128 v[84:87], v16 offset:49152
  ds_read_b64_tr_b16 v[88:89], v138 offset:33280
  ds_read_b64_tr_b16 v[90:91], v141 offset:33280
  v_mfma_f32_32x32x16_bf16 a[48:63], v[124:127], v[116:119], a[48:63]
  ds_read_b64_tr_b16 v[92:93], v138 offset:37376
  ds_read_b64_tr_b16 v[94:95], v141 offset:37376
  v_add_f32 v143, 1.0, v143
  v_rcp_f32 v143, v143
  s_nop 0
  v_mul_f32 v61, v61, v143
  s_waitcnt lgkmcnt(5)
  v_mfma_f32_32x32x16_bf16 a[32:47], v[72:75], v[68:71], a[32:47]
  ds_read_b128 v[100:103], v19 offset:49152
  ds_read_b64_tr_b16 v[104:105], v138 offset:33792
  ds_read_b64_tr_b16 v[106:107], v141 offset:33792
  v_mfma_f32_32x32x16_bf16 a[48:63], v[76:79], v[68:71], a[48:63]
  ds_read_b64_tr_b16 v[108:109], v138 offset:37888
  ds_read_b64_tr_b16 v[110:111], v141 offset:37888
  v_accvgpr_read_b32 v62, a26
  v_mul_f32 v143, v62, v62
  v_fma_f32 v143, v143, v134, v132
  v_mul_f32 v143, v143, v62
  v_exp_f32 v143, v143
  s_lshr_b32 s54, s8, 2
  s_lshl_b32 s54, s54, 5
  v_and_b32 v9, 31, v0
  v_add_u32 v9, s54, v9
  v_lshlrev_b32 v9, 7, v9
  v_add_u32 v9, 102400, v9
  v_mov_b32 v10, v7
  s_cmp_eq_u32 s3, 0
  s_cselect_b32 exec_lo, -1, 0
  s_cselect_b32 exec_hi, -1, 0
  buffer_load_dword v10, v9, s[56:59], 0 offen sc1
  s_mov_b64 exec, -1
  s_waitcnt lgkmcnt(5)
  v_mfma_f32_32x32x16_bf16 a[32:47], v[88:91], v[84:87], a[32:47]
  ds_read_b128 v[116:119], v22 offset:49152
  ds_read_b64_tr_b16 v[120:121], v138 offset:34304
  ds_read_b64_tr_b16 v[122:123], v141 offset:34304
  v_mfma_f32_32x32x16_bf16 a[48:63], v[92:95], v[84:87], a[48:63]
  ds_read_b64_tr_b16 v[124:125], v138 offset:38400
  ds_read_b64_tr_b16 v[126:127], v141 offset:38400
  v_add_f32 v143, 1.0, v143
  v_rcp_f32 v143, v143
  s_nop 0
  v_mul_f32 v62, v62, v143
  s_waitcnt vmcnt(7)
  s_barrier
  s_waitcnt lgkmcnt(5)
  v_mfma_f32_32x32x16_bf16 a[32:47], v[104:107], v[100:103], a[32:47]
  ds_read_b128 v[68:71], v12 offset:16384
  ds_read_b64_tr_b16 v[72:73], v35 offset:0
  ds_read_b64_tr_b16 v[74:75], v140 offset:0
  v_mfma_f32_32x32x16_bf16 a[48:63], v[108:111], v[100:103], a[48:63]
  ds_read_b64_tr_b16 v[76:77], v35 offset:4096
  ds_read_b64_tr_b16 v[78:79], v140 offset:4096
  v_accvgpr_read_b32 v63, a27
  v_mul_f32 v143, v63, v63
  v_fma_f32 v143, v143, v134, v132
  v_mul_f32 v143, v143, v63
  v_exp_f32 v143, v143
  s_waitcnt lgkmcnt(5)
  v_mfma_f32_32x32x16_bf16 a[32:47], v[120:123], v[116:119], a[32:47]
  ds_read_b128 v[84:87], v15 offset:16384
  ds_read_b64_tr_b16 v[88:89], v35 offset:512
  ds_read_b64_tr_b16 v[90:91], v140 offset:512
  v_mfma_f32_32x32x16_bf16 a[48:63], v[124:127], v[116:119], a[48:63]
  ds_read_b64_tr_b16 v[92:93], v35 offset:4608
  ds_read_b64_tr_b16 v[94:95], v140 offset:4608
  v_add_f32 v143, 1.0, v143
  v_rcp_f32 v143, v143
  s_nop 0
  v_mul_f32 v63, v63, v143
  s_waitcnt lgkmcnt(5)
  v_mfma_f32_32x32x16_bf16 a[32:47], v[72:75], v[68:71], a[32:47]
  ds_read_b128 v[100:103], v18 offset:16384
  ds_read_b64_tr_b16 v[104:105], v35 offset:1024
  ds_read_b64_tr_b16 v[106:107], v140 offset:1024
  v_mfma_f32_32x32x16_bf16 a[48:63], v[76:79], v[68:71], a[48:63]
  ds_read_b64_tr_b16 v[108:109], v35 offset:5120
  ds_read_b64_tr_b16 v[110:111], v140 offset:5120
  v_accvgpr_read_b32 v64, a28
  v_mul_f32 v143, v64, v64
  v_fma_f32 v143, v143, v134, v132
  v_mul_f32 v143, v143, v64
  v_exp_f32 v143, v143
  s_waitcnt lgkmcnt(5)
  v_mfma_f32_32x32x16_bf16 a[32:47], v[88:91], v[84:87], a[32:47]
  ds_read_b128 v[116:119], v21 offset:16384
  ds_read_b64_tr_b16 v[120:121], v35 offset:1536
  ds_read_b64_tr_b16 v[122:123], v140 offset:1536
  v_mfma_f32_32x32x16_bf16 a[48:63], v[92:95], v[84:87], a[48:63]
  ds_read_b64_tr_b16 v[124:125], v35 offset:5632
  ds_read_b64_tr_b16 v[126:127], v140 offset:5632
  v_add_f32 v143, 1.0, v143
  v_rcp_f32 v143, v143
  s_nop 0
  v_mul_f32 v64, v64, v143
  s_waitcnt vmcnt(1)
  s_barrier
  s_waitcnt lgkmcnt(5)
  v_mfma_f32_32x32x16_bf16 a[32:47], v[104:107], v[100:103], a[32:47]
  ds_read_b128 v[68:71], v12 offset:40960
  ds_read_b64_tr_b16 v[72:73], v35 offset:24576
  ds_read_b64_tr_b16 v[74:75], v140 offset:24576
  v_mfma_f32_32x32x16_bf16 a[48:63], v[108:111], v[100:103], a[48:63]
  ds_read_b64_tr_b16 v[76:77], v35 offset:28672
  ds_read_b64_tr_b16 v[78:79], v140 offset:28672
  v_accvgpr_read_b32 v65, a29
  v_mul_f32 v143, v65, v65
  v_fma_f32 v143, v143, v134, v132
  v_mul_f32 v143, v143, v65
  v_exp_f32 v143, v143
  s_waitcnt lgkmcnt(5)
  v_mfma_f32_32x32x16_bf16 a[32:47], v[120:123], v[116:119], a[32:47]
  ds_read_b128 v[84:87], v15 offset:40960
  ds_read_b64_tr_b16 v[88:89], v35 offset:25088
  ds_read_b64_tr_b16 v[90:91], v140 offset:25088
  v_mfma_f32_32x32x16_bf16 a[48:63], v[124:127], v[116:119], a[48:63]
  ds_read_b64_tr_b16 v[92:93], v35 offset:29184
  ds_read_b64_tr_b16 v[94:95], v140 offset:29184
  v_add_f32 v143, 1.0, v143
  v_rcp_f32 v143, v143
  s_nop 0
  v_mul_f32 v65, v65, v143
  s_waitcnt lgkmcnt(5)
  v_mfma_f32_32x32x16_bf16 a[32:47], v[72:75], v[68:71], a[32:47]
  ds_read_b128 v[100:103], v18 offset:40960
  ds_read_b64_tr_b16 v[104:105], v35 offset:25600
  ds_read_b64_tr_b16 v[106:107], v140 offset:25600
  v_mfma_f32_32x32x16_bf16 a[48:63], v[76:79], v[68:71], a[48:63]
  ds_read_b64_tr_b16 v[108:109], v35 offset:29696
  ds_read_b64_tr_b16 v[110:111], v140 offset:29696
  v_accvgpr_read_b32 v66, a30
  v_mul_f32 v143, v66, v66
  v_fma_f32 v143, v143, v134, v132
  v_mul_f32 v143, v143, v66
  v_exp_f32 v143, v143
  s_waitcnt lgkmcnt(5)
  v_mfma_f32_32x32x16_bf16 a[32:47], v[88:91], v[84:87], a[32:47]
  ds_read_b128 v[116:119], v21 offset:40960
  ds_read_b64_tr_b16 v[120:121], v35 offset:26112
  ds_read_b64_tr_b16 v[122:123], v140 offset:26112
  v_mfma_f32_32x32x16_bf16 a[48:63], v[92:95], v[84:87], a[48:63]
  ds_read_b64_tr_b16 v[124:125], v35 offset:30208
  ds_read_b64_tr_b16 v[126:127], v140 offset:30208
  v_add_f32 v143, 1.0, v143
  v_rcp_f32 v143, v143
  s_nop 0
  v_mul_f32 v66, v66, v143
  s_barrier
  s_waitcnt lgkmcnt(5)
  v_mfma_f32_32x32x16_bf16 a[32:47], v[104:107], v[100:103], a[32:47]
  v_mfma_f32_32x32x16_bf16 a[48:63], v[108:111], v[100:103], a[48:63]
  v_accvgpr_read_b32 v67, a31
  v_mul_f32 v143, v67, v67
  v_fma_f32 v143, v143, v134, v132
  v_mul_f32 v143, v143, v67
  v_exp_f32 v143, v143
  s_waitcnt lgkmcnt(0)
  v_mfma_f32_32x32x16_bf16 a[32:47], v[120:123], v[116:119], a[32:47]
  v_mfma_f32_32x32x16_bf16 a[48:63], v[124:127], v[116:119], a[48:63]
  v_add_f32 v143, 1.0, v143
  v_rcp_f32 v143, v143
  s_nop 0
  v_mul_f32 v67, v67, v143
  s_nop 6
  v_accvgpr_read_b32 v156, a32
  v_accvgpr_read_b32 v157, a33
  v_accvgpr_read_b32 v158, a34
  v_accvgpr_read_b32 v159, a35
  v_accvgpr_read_b32 v160, a36
  v_accvgpr_read_b32 v161, a37
  v_accvgpr_read_b32 v162, a38
  v_accvgpr_read_b32 v163, a39
  v_pk_add_f32 v[156:157], v[156:157], v[136:137]
  v_pk_add_f32 v[158:159], v[158:159], v[136:137]
  v_pk_add_f32 v[160:161], v[160:161], v[136:137]
  v_pk_add_f32 v[162:163], v[162:163], v[136:137]
  v_pk_mul_f32 v[156:157], v[156:157], v[36:37]
  v_pk_mul_f32 v[158:159], v[158:159], v[38:39]
  v_pk_mul_f32 v[160:161], v[160:161], v[40:41]
  v_pk_mul_f32 v[162:163], v[162:163], v[42:43]
  v_cvt_pk_bf16_f32 v148, v156, v157
  v_cvt_pk_bf16_f32 v149, v158, v159
  v_cvt_pk_bf16_f32 v150, v160, v161
  v_cvt_pk_bf16_f32 v151, v162, v163
  s_nop 0
  v_permlane32_swap_b32 v148, v150
  v_permlane32_swap_b32 v149, v151
  buffer_store_dwordx4 v[148:151], v11, s[80:83], s24 offen offset:0 sc1
  v_accvgpr_read_b32 v164, a40
  v_accvgpr_read_b32 v165, a41
  v_accvgpr_read_b32 v166, a42
  v_accvgpr_read_b32 v167, a43
  v_accvgpr_read_b32 v168, a44
  v_accvgpr_read_b32 v169, a45
  v_accvgpr_read_b32 v170, a46
  v_accvgpr_read_b32 v171, a47
  v_pk_add_f32 v[164:165], v[164:165], v[136:137]
  v_pk_add_f32 v[166:167], v[166:167], v[136:137]
  v_pk_add_f32 v[168:169], v[168:169], v[136:137]
  v_pk_add_f32 v[170:171], v[170:171], v[136:137]
  v_pk_mul_f32 v[164:165], v[164:165], v[44:45]
  v_pk_mul_f32 v[166:167], v[166:167], v[46:47]
  v_pk_mul_f32 v[168:169], v[168:169], v[48:49]
  v_pk_mul_f32 v[170:171], v[170:171], v[50:51]
  v_cvt_pk_bf16_f32 v152, v164, v165
  v_cvt_pk_bf16_f32 v153, v166, v167
  v_cvt_pk_bf16_f32 v154, v168, v169
  v_cvt_pk_bf16_f32 v155, v170, v171
  s_nop 0
  v_permlane32_swap_b32 v152, v154
  v_permlane32_swap_b32 v153, v155
  buffer_store_dwordx4 v[152:155], v11, s[80:83], s24 offen offset:2048 sc1
  v_accvgpr_read_b32 v156, a48
  v_accvgpr_read_b32 v157, a49
  v_accvgpr_read_b32 v158, a50
  v_accvgpr_read_b32 v159, a51
  v_accvgpr_read_b32 v160, a52
  v_accvgpr_read_b32 v161, a53
  v_accvgpr_read_b32 v162, a54
  v_accvgpr_read_b32 v163, a55
  v_pk_add_f32 v[156:157], v[156:157], v[136:137]
  v_pk_add_f32 v[158:159], v[158:159], v[136:137]
  v_pk_add_f32 v[160:161], v[160:161], v[136:137]
  v_pk_add_f32 v[162:163], v[162:163], v[136:137]
  v_pk_mul_f32 v[156:157], v[156:157], v[52:53]
  v_pk_mul_f32 v[158:159], v[158:159], v[54:55]
  v_pk_mul_f32 v[160:161], v[160:161], v[56:57]
  v_pk_mul_f32 v[162:163], v[162:163], v[58:59]
  v_cvt_pk_bf16_f32 v148, v156, v157
  v_cvt_pk_bf16_f32 v149, v158, v159
  v_cvt_pk_bf16_f32 v150, v160, v161
  v_cvt_pk_bf16_f32 v151, v162, v163
  s_nop 0
  v_permlane32_swap_b32 v148, v150
  v_permlane32_swap_b32 v149, v151
  buffer_store_dwordx4 v[148:151], v11, s[80:83], s25 offen offset:0 sc1
  v_accvgpr_read_b32 v164, a56
  v_accvgpr_read_b32 v165, a57
  v_accvgpr_read_b32 v166, a58
  v_accvgpr_read_b32 v167, a59
  v_accvgpr_read_b32 v168, a60
  v_accvgpr_read_b32 v169, a61
  v_accvgpr_read_b32 v170, a62
  v_accvgpr_read_b32 v171, a63
  v_pk_add_f32 v[164:165], v[164:165], v[136:137]
  v_pk_add_f32 v[166:167], v[166:167], v[136:137]
  v_pk_add_f32 v[168:169], v[168:169], v[136:137]
  v_pk_add_f32 v[170:171], v[170:171], v[136:137]
  v_pk_mul_f32 v[164:165], v[164:165], v[60:61]
  v_pk_mul_f32 v[166:167], v[166:167], v[62:63]
  v_pk_mul_f32 v[168:169], v[168:169], v[64:65]
  v_pk_mul_f32 v[170:171], v[170:171], v[66:67]
  v_cvt_pk_bf16_f32 v152, v164, v165
  v_cvt_pk_bf16_f32 v153, v166, v167
  v_cvt_pk_bf16_f32 v154, v168, v169
  v_cvt_pk_bf16_f32 v155, v170, v171
  s_nop 0
  v_permlane32_swap_b32 v152, v154
  v_permlane32_swap_b32 v153, v155
  buffer_store_dwordx4 v[152:155], v11, s[80:83], s25 offen offset:2048 sc1
  s_waitcnt vmcnt(4)
  v_cmp_ne_u32 vcc, s12, v10
  s_nop 0
  s_cmp_eq_u64 vcc, 0
  s_cbranch_scc0 L_ps_132
L_pb_133:
  s_barrier
  s_waitcnt vmcnt(0)
  s_barrier
  s_mul_i32 s54, s8, 8
  s_add_u32 s54, s54, s9
  s_lshl_b32 s54, s54, 7
  s_add_u32 s54, s54, 69632
  s_cmp_eq_u32 s3, 0
  s_cselect_b32 exec_lo, 1, 0
  s_mov_b32 exec_hi, 0
  buffer_store_dword v7, v8, s[56:59], s54 offen sc1
  s_mov_b64 exec, -1
  s_barrier
  ds_read_b128 v[68:71], v144 offset:0
  ds_read_b64_tr_b16 v[72:73], v33 offset:57344
  ds_read_b64_tr_b16 v[74:75], v33 offset:57856
  ds_read_b128 v[84:87], v144 offset:2048
  ds_read_b64_tr_b16 v[88:89], v33 offset:59392
  ds_read_b64_tr_b16 v[90:91], v33 offset:59904
  ds_read_b128 v[100:103], v144 offset:4096
  ds_read_b64_tr_b16 v[104:105], v33 offset:61440
  ds_read_b64_tr_b16 v[106:107], v33 offset:61952
  ds_read_b128 v[116:119], v144 offset:6144
  ds_read_b64_tr_b16 v[120:121], v33 offset:63488
  ds_read_b64_tr_b16 v[122:123], v33 offset:64000
  s_waitcnt lgkmcnt(9)
  v_mfma_f32_32x32x16_bf16 a[0:15], v[72:75], v[68:71], 0
  s_barrier
  ds_read_b128 v[68:71], v144 offset:16384
  ds_read_b64_tr_b16 v[72:73], v34 offset:0
  ds_read_b64_tr_b16 v[74:75], v34 offset:512
  s_waitcnt lgkmcnt(9)
  v_mfma_f32_32x32x16_bf16 a[0:15], v[88:91], v[84:87], a[0:15]
  ds_read_b128 v[84:87], v144 offset:18432
  ds_read_b64_tr_b16 v[88:89], v34 offset:2048
  ds_read_b64_tr_b16 v[90:91], v34 offset:2560
  s_waitcnt lgkmcnt(9)
  v_mfma_f32_32x32x16_bf16 a[0:15], v[104:107], v[100:103], a[0:15]
  ds_read_b128 v[100:103], v144 offset:20480
  ds_read_b64_tr_b16 v[104:105], v34 offset:4096
  ds_read_b64_tr_b16 v[106:107], v34 offset:4608
  s_waitcnt lgkmcnt(9)
  v_mfma_f32_32x32x16_bf16 a[0:15], v[120:123], v[116:119], a[0:15]
  ds_read_b128 v[116:119], v144 offset:22528
  ds_read_b64_tr_b16 v[120:121], v34 offset:6144
  ds_read_b64_tr_b16 v[122:123], v34 offset:6656
  s_waitcnt lgkmcnt(9)
  v_mfma_f32_32x32x16_bf16 a[0:15], v[72:75], v[68:71], a[0:15]
  s_barrier
  ds_read_b128 v[68:71], v144 offset:32768
  ds_read_b64_tr_b16 v[72:73], v32 offset:49152
  ds_read_b64_tr_b16 v[74:75], v32 offset:49664
  s_waitcnt lgkmcnt(9)
  v_mfma_f32_32x32x16_bf16 a[0:15], v[88:91], v[84:87], a[0:15]
  ds_read_b128 v[84:87], v144 offset:34816
  ds_read_b64_tr_b16 v[88:89], v32 offset:51200
  ds_read_b64_tr_b16 v[90:91], v32 offset:51712
  s_waitcnt lgkmcnt(9)
  v_mfma_f32_32x32x16_bf16 a[0:15], v[104:107], v[100:103], a[0:15]
  ds_read_b128 v[100:103], v144 offset:36864
  ds_read_b64_tr_b16 v[104:105], v32 offset:53248
  ds_read_b64_tr_b16 v[106:107], v32 offset:53760
  s_waitcnt lgkmcnt(9)
  v_mfma_f32_32x32x16_bf16 a[0:15], v[120:123], v[116:119], a[0:15]
  ds_read_b128 v[116:119], v144 offset:38912
  ds_read_b64_tr_b16 v[120:121], v32 offset:55296
  ds_read_b64_tr_b16 v[122:123], v32 offset:55808
  s_waitcnt lgkmcnt(9)
  v_mfma_f32_32x32x16_bf16 a[0:15], v[72:75], v[68:71], a[0:15]
  s_lshl_b32 s54, s8, 3
  v_min_u32 v9, 6, v0
  v_add_u32 v9, s54, v9
  v_lshlrev_b32 v9, 7, v9
  v_add_u32 v9, 69632, v9
  v_mov_b32 v10, v7
  s_cmp_eq_u32 s3, 0
  s_cselect_b32 exec_lo, -1, 0
  s_cselect_b32 exec_hi, -1, 0
  buffer_load_dword v10, v9, s[56:59], 0 offen sc1
  s_mov_b64 exec, -1
  s_barrier
  ds_read_b128 v[68:71], v145 offset:16384
  ds_read_b64_tr_b16 v[72:73], v32 offset:57344
  ds_read_b64_tr_b16 v[74:75], v32 offset:57856
  s_waitcnt lgkmcnt(9)
  v_mfma_f32_32x32x16_bf16 a[0:15], v[88:91], v[84:87], a[0:15]
  ds_read_b128 v[84:87], v145 offset:18432
  ds_read_b64_tr_b16 v[88:89], v32 offset:59392
  ds_read_b64_tr_b16 v[90:91], v32 offset:59904
  s_waitcnt lgkmcnt(9)
  v_mfma_f32_32x32x16_bf16 a[0:15], v[104:107], v[100:103], a[0:15]
  ds_read_b128 v[100:103], v145 offset:20480
  ds_read_b64_tr_b16 v[104:105], v32 offset:61440
  ds_read_b64_tr_b16 v[106:107], v32 offset:61952
  s_waitcnt lgkmcnt(9)
  v_mfma_f32_32x32x16_bf16 a[0:15], v[120:123], v[116:119], a[0:15]
  ds_read_b128 v[116:119], v145 offset:22528
  ds_read_b64_tr_b16 v[120:121], v32 offset:63488
  ds_read_b64_tr_b16 v[122:123], v32 offset:64000
  s_waitcnt lgkmcnt(9)
  v_mfma_f32_32x32x16_bf16 a[0:15], v[72:75], v[68:71], a[0:15]
  s_barrier
  ds_read_b128 v[68:71], v145 offset:32768
  ds_read_b64_tr_b16 v[72:73], v33 offset:0
  ds_read_b64_tr_b16 v[74:75], v33 offset:512
  s_waitcnt lgkmcnt(9)
  v_mfma_f32_32x32x16_bf16 a[0:15], v[88:91], v[84:87], a[0:15]
  ds_read_b128 v[84:87], v145 offset:34816
  ds_read_b64_tr_b16 v[88:89], v33 offset:2048
  ds_read_b64_tr_b16 v[90:91], v33 offset:2560
  s_waitcnt lgkmcnt(9)
  v_mfma_f32_32x32x16_bf16 a[0:15], v[104:107], v[100:103], a[0:15]
  ds_read_b128 v[100:103], v145 offset:36864
  ds_read_b64_tr_b16 v[104:105], v33 offset:4096
  ds_read_b64_tr_b16 v[106:107], v33 offset:4608
  s_waitcnt lgkmcnt(9)
  v_mfma_f32_32x32x16_bf16 a[0:15], v[120:123], v[116:119], a[0:15]
  ds_read_b128 v[116:119], v145 offset:38912
  ds_read_b64_tr_b16 v[120:121], v33 offset:6144
  ds_read_b64_tr_b16 v[122:123], v33 offset:6656
  s_waitcnt lgkmcnt(9)
  v_mfma_f32_32x32x16_bf16 a[0:15], v[72:75], v[68:71], a[0:15]
  s_waitcnt vmcnt(0)
  v_cmp_ne_u32 vcc, s12, v10
  s_nop 0
  s_cmp_eq_u64 vcc, 0
  s_cbranch_scc0 L_ps_135
L_pb_136:
  s_barrier
  ds_read_b128 v[68:71], v145 offset:49152
  ds_read_b64_tr_b16 v[72:73], v34 offset:8192
  ds_read_b64_tr_b16 v[74:75], v34 offset:8704
  s_waitcnt lgkmcnt(9)
  v_mfma_f32_32x32x16_bf16 a[0:15], v[88:91], v[84:87], a[0:15]
  ds_read_b128 v[84:87], v145 offset:51200
  ds_read_b64_tr_b16 v[88:89], v34 offset:10240
  ds_read_b64_tr_b16 v[90:91], v34 offset:10752
  s_waitcnt lgkmcnt(9)
  v_mfma_f32_32x32x16_bf16 a[0:15], v[104:107], v[100:103], a[0:15]
  ds_read_b128 v[100:103], v145 offset:53248
  ds_read_b64_tr_b16 v[104:105], v34 offset:12288
  ds_read_b64_tr_b16 v[106:107], v34 offset:12800
  s_waitcnt lgkmcnt(9)
  v_mfma_f32_32x32x16_bf16 a[0:15], v[120:123], v[116:119], a[0:15]
  ds_read_b128 v[116:119], v145 offset:55296
  ds_read_b64_tr_b16 v[120:121], v34 offset:14336
  ds_read_b64_tr_b16 v[122:123], v34 offset:14848
  s_waitcnt lgkmcnt(9)
  v_mfma_f32_32x32x16_bf16 a[0:15], v[72:75], v[68:71], a[0:15]
  s_lshl_b32 s54, s8, 3
  s_add_u32 s54, s54, s9
  s_lshl_b32 s54, s54, 2
  s_add_u32 s54, s54, s3
  s_cmp_eq_u32 s54, 28
  s_cbranch_scc1 L_nu_138
L_nb_139:
  s_barrier
  ds_read_b128 v[68:71], v145 offset:57344
  ds_read_b64_tr_b16 v[72:73], v34 offset:16384
  ds_read_b64_tr_b16 v[74:75], v34 offset:16896
  s_waitcnt lgkmcnt(9)
  v_mfma_f32_32x32x16_bf16 a[0:15], v[88:91], v[84:87], a[0:15]
  ds_read_b128 v[84:87], v145 offset:59392
  ds_read_b64_tr_b16 v[88:89], v34 offset:18432
  ds_read_b64_tr_b16 v[90:91], v34 offset:18944
  s_waitcnt lgkmcnt(9)
  v_mfma_f32_32x32x16_bf16 a[0:15], v[104:107], v[100:103], a[0:15]
  ds_read_b128 v[100:103], v145 offset:61440
  ds_read_b64_tr_b16 v[104:105], v34 offset:20480
  ds_read_b64_tr_b16 v[106:107], v34 offset:20992
  s_waitcnt lgkmcnt(9)
  v_mfma_f32_32x32x16_bf16 a[0:15], v[120:123], v[116:119], a[0:15]
  ds_read_b128 v[116:119], v145 offset:63488
  ds_read_b64_tr_b16 v[120:121], v34 offset:22528
  ds_read_b64_tr_b16 v[122:123], v34 offset:23040
  s_waitcnt lgkmcnt(9)
  v_mfma_f32_32x32x16_bf16 a[0:15], v[72:75], v[68:71], a[0:15]
  s_barrier
  ds_read_b128 v[68:71], v146 offset:0
  ds_read_b64_tr_b16 v[72:73], v33 offset:8192
  ds_read_b64_tr_b16 v[74:75], v33 offset:8704
  s_waitcnt lgkmcnt(9)
  v_mfma_f32_32x32x16_bf16 a[0:15], v[88:91], v[84:87], a[0:15]
  ds_read_b128 v[84:87], v146 offset:2048
  ds_read_b64_tr_b16 v[88:89], v33 offset:10240
  ds_read_b64_tr_b16 v[90:91], v33 offset:10752
  s_waitcnt lgkmcnt(9)
  v_mfma_f32_32x32x16_bf16 a[0:15], v[104:107], v[100:103], a[0:15]
  ds_read_b128 v[100:103], v146 offset:4096
  ds_read_b64_tr_b16 v[104:105], v33 offset:12288
  ds_read_b64_tr_b16 v[106:107], v33 offset:12800
  s_waitcnt lgkmcnt(9)
  v_mfma_f32_32x32x16_bf16 a[0:15], v[120:123], v[116:119], a[0:15]
  ds_read_b128 v[116:119], v146 offset:6144
  ds_read_b64_tr_b16 v[120:121], v33 offset:14336
  ds_read_b64_tr_b16 v[122:123], v33 offset:14848
  s_waitcnt lgkmcnt(9)
  v_mfma_f32_32x32x16_bf16 a[0:15], v[72:75], v[68:71], a[0:15]
  s_barrier
  ds_read_b128 v[68:71], v144 offset:57344
  ds_read_b64_tr_b16 v[72:73], v32 offset:8192
  ds_read_b64_tr_b16 v[74:75], v32 offset:8704
  s_waitcnt lgkmcnt(9)
  v_mfma_f32_32x32x16_bf16 a[0:15], v[88:91], v[84:87], a[0:15]
  ds_read_b128 v[84:87], v144 offset:59392
  ds_read_b64_tr_b16 v[88:89], v32 offset:10240
  ds_read_b64_tr_b16 v[90:91], v32 offset:10752
  s_waitcnt lgkmcnt(9)
  v_mfma_f32_32x32x16_bf16 a[0:15], v[104:107], v[100:103], a[0:15]
  ds_read_b128 v[100:103], v144 offset:61440
  ds_read_b64_tr_b16 v[104:105], v32 offset:12288
  ds_read_b64_tr_b16 v[106:107], v32 offset:12800
  s_waitcnt lgkmcnt(9)
  v_mfma_f32_32x32x16_bf16 a[0:15], v[120:123], v[116:119], a[0:15]
  ds_read_b128 v[116:119], v144 offset:63488
  ds_read_b64_tr_b16 v[120:121], v32 offset:14336
  ds_read_b64_tr_b16 v[122:123], v32 offset:14848
  s_waitcnt lgkmcnt(9)
  v_mfma_f32_32x32x16_bf16 a[16:31], v[72:75], v[68:71], 0
  s_barrier
  ds_read_b128 v[68:71], v145 offset:0
  ds_read_b64_tr_b16 v[72:73], v32 offset:24576
  ds_read_b64_tr_b16 v[74:75], v32 offset:25088
  s_waitcnt lgkmcnt(9)
  v_mfma_f32_32x32x16_bf16 a[16:31], v[88:91], v[84:87], a[16:31]
  ds_read_b128 v[84:87], v145 offset:2048
  ds_read_b64_tr_b16 v[88:89], v32 offset:26624
  ds_read_b64_tr_b16 v[90:91], v32 offset:27136
  s_waitcnt lgkmcnt(9)
  v_mfma_f32_32x32x16_bf16 a[16:31], v[104:107], v[100:103], a[16:31]
  ds_read_b128 v[100:103], v145 offset:4096
  ds_read_b64_tr_b16 v[104:105], v32 offset:28672
  ds_read_b64_tr_b16 v[106:107], v32 offset:29184
  s_waitcnt lgkmcnt(9)
  v_mfma_f32_32x32x16_bf16 a[16:31], v[120:123], v[116:119], a[16:31]
  ds_read_b128 v[116:119], v145 offset:6144
  ds_read_b64_tr_b16 v[120:121], v32 offset:30720
  ds_read_b64_tr_b16 v[122:123], v32 offset:31232
  s_waitcnt lgkmcnt(9)
  v_mfma_f32_32x32x16_bf16 a[16:31], v[72:75], v[68:71], a[16:31]
  s_barrier
  s_lshl_b32 s54, s52, 7
  s_add_u32 s54, s54, 156672
  v_lshl_add_u32 v2, v5, 2, s54
  ds_read_b32 v147, v2
  ds_read_b128 v[68:71], v145 offset:49152
  ds_read_b64_tr_b16 v[72:73], v32 offset:40960
  ds_read_b64_tr_b16 v[74:75], v32 offset:41472
  s_waitcnt lgkmcnt(10)
  v_mfma_f32_32x32x16_bf16 a[16:31], v[88:91], v[84:87], a[16:31]
  ds_read_b128 v[84:87], v145 offset:51200
  ds_read_b64_tr_b16 v[88:89], v32 offset:43008
  ds_read_b64_tr_b16 v[90:91], v32 offset:43520
  s_waitcnt lgkmcnt(10)
  v_mfma_f32_32x32x16_bf16 a[16:31], v[104:107], v[100:103], a[16:31]
  ds_read_b128 v[100:103], v145 offset:53248
  ds_read_b64_tr_b16 v[104:105], v32 offset:45056
  ds_read_b64_tr_b16 v[106:107], v32 offset:45568
  s_waitcnt lgkmcnt(10)
  v_mfma_f32_32x32x16_bf16 a[16:31], v[120:123], v[116:119], a[16:31]
  ds_read_b128 v[116:119], v145 offset:55296
  ds_read_b64_tr_b16 v[120:121], v32 offset:47104
  ds_read_b64_tr_b16 v[122:123], v32 offset:47616
  s_waitcnt lgkmcnt(9)
  v_mfma_f32_32x32x16_bf16 a[16:31], v[72:75], v[68:71], a[16:31]
  s_barrier
  ds_read_b128 v[68:71], v145 offset:57344
  ds_read_b64_tr_b16 v[72:73], v33 offset:24576
  ds_read_b64_tr_b16 v[74:75], v33 offset:25088
  s_waitcnt lgkmcnt(9)
  v_mfma_f32_32x32x16_bf16 a[16:31], v[88:91], v[84:87], a[16:31]
  ds_read_b128 v[84:87], v145 offset:59392
  ds_read_b64_tr_b16 v[88:89], v33 offset:26624
  ds_read_b64_tr_b16 v[90:91], v33 offset:27136
  s_waitcnt lgkmcnt(9)
  v_mfma_f32_32x32x16_bf16 a[16:31], v[104:107], v[100:103], a[16:31]
  ds_read_b128 v[100:103], v145 offset:61440
  ds_read_b64_tr_b16 v[104:105], v33 offset:28672
  ds_read_b64_tr_b16 v[106:107], v33 offset:29184
  s_waitcnt lgkmcnt(9)
  v_mfma_f32_32x32x16_bf16 a[16:31], v[120:123], v[116:119], a[16:31]
  ds_read_b128 v[116:119], v145 offset:63488
  ds_read_b64_tr_b16 v[120:121], v33 offset:30720
  ds_read_b64_tr_b16 v[122:123], v33 offset:31232
  s_waitcnt lgkmcnt(9)
  v_mfma_f32_32x32x16_bf16 a[16:31], v[72:75], v[68:71], a[16:31]
  s_lshl_b32 s24, s8, 16
  s_lshl_b32 s25, s52, 15
  s_add_u32 s24, s24, s25
  s_lshl_b32 s25, s9, 7
  s_add_u32 s24, s24, s25
  s_lshl_b32 s25, s53, 6
  s_add_u32 s24, s24, s25
  v_lshlrev_b32 v1, 10, v5
  v_lshl_add_u32 v11, v6, 4, v1
  s_barrier
  ds_read_b128 v[68:71], v145 offset:8192
  ds_read_b64_tr_b16 v[72:73], v33 offset:40960
  ds_read_b64_tr_b16 v[74:75], v33 offset:41472
  s_waitcnt lgkmcnt(9)
  v_mfma_f32_32x32x16_bf16 a[16:31], v[88:91], v[84:87], a[16:31]
  ds_read_b128 v[84:87], v145 offset:10240
  ds_read_b64_tr_b16 v[88:89], v33 offset:43008
  ds_read_b64_tr_b16 v[90:91], v33 offset:43520
  s_waitcnt lgkmcnt(9)
  v_mfma_f32_32x32x16_bf16 a[16:31], v[104:107], v[100:103], a[16:31]
  ds_read_b128 v[100:103], v145 offset:12288
  ds_read_b64_tr_b16 v[104:105], v33 offset:45056
  ds_read_b64_tr_b16 v[106:107], v33 offset:45568
  s_waitcnt lgkmcnt(9)
  v_mfma_f32_32x32x16_bf16 a[16:31], v[120:123], v[116:119], a[16:31]
  ds_read_b128 v[116:119], v145 offset:14336
  ds_read_b64_tr_b16 v[120:121], v33 offset:47104
  ds_read_b64_tr_b16 v[122:123], v33 offset:47616
  s_waitcnt lgkmcnt(9)
  v_mfma_f32_32x32x16_bf16 a[16:31], v[72:75], v[68:71], a[16:31]
  v_sub_f32 v136, 1.0, v147
  v_sub_f32 v137, 1.0, v147
  s_barrier
  ds_read_b128 v[68:71], v144 offset:8192
  ds_read_b64_tr_b16 v[72:73], v32 offset:0
  ds_read_b64_tr_b16 v[74:75], v32 offset:512
  s_waitcnt lgkmcnt(9)
  v_mfma_f32_32x32x16_bf16 a[16:31], v[88:91], v[84:87], a[16:31]
  ds_read_b128 v[84:87], v144 offset:10240
  ds_read_b64_tr_b16 v[88:89], v32 offset:2048
  ds_read_b64_tr_b16 v[90:91], v32 offset:2560
  s_waitcnt lgkmcnt(9)
  v_mfma_f32_32x32x16_bf16 a[16:31], v[104:107], v[100:103], a[16:31]
  ds_read_b128 v[100:103], v144 offset:12288
  ds_read_b64_tr_b16 v[104:105], v32 offset:4096
  ds_read_b64_tr_b16 v[106:107], v32 offset:4608
  s_waitcnt lgkmcnt(9)
  v_mfma_f32_32x32x16_bf16 a[16:31], v[120:123], v[116:119], a[16:31]
  ds_read_b128 v[116:119], v144 offset:14336
  ds_read_b64_tr_b16 v[120:121], v32 offset:6144
  ds_read_b64_tr_b16 v[122:123], v32 offset:6656
  s_waitcnt lgkmcnt(9)
  v_mfma_f32_32x32x16_bf16 a[16:31], v[72:75], v[68:71], a[16:31]
  v_accvgpr_read_b32 v36, a0
  v_accvgpr_read_b32 v37, a1
  v_accvgpr_read_b32 v38, a2
  v_accvgpr_read_b32 v39, a3
  v_mul_f32 v36, v147, v36
  v_mul_f32 v37, v147, v37
  v_mul_f32 v38, v147, v38
  v_mul_f32 v39, v147, v39
  s_barrier
  ds_read_b128 v[68:71], v144 offset:57344
  ds_read_b64_tr_b16 v[72:73], v32 offset:16384
  ds_read_b64_tr_b16 v[74:75], v32 offset:16896
  s_waitcnt lgkmcnt(9)
  v_mfma_f32_32x32x16_bf16 a[16:31], v[88:91], v[84:87], a[16:31]
  ds_read_b128 v[84:87], v144 offset:59392
  ds_read_b64_tr_b16 v[88:89], v32 offset:18432
  ds_read_b64_tr_b16 v[90:91], v32 offset:18944
  s_waitcnt lgkmcnt(9)
  v_mfma_f32_32x32x16_bf16 a[16:31], v[104:107], v[100:103], a[16:31]
  ds_read_b128 v[100:103], v144 offset:61440
  ds_read_b64_tr_b16 v[104:105], v32 offset:20480
  ds_read_b64_tr_b16 v[106:107], v32 offset:20992
  s_waitcnt lgkmcnt(9)
  v_mfma_f32_32x32x16_bf16 a[16:31], v[120:123], v[116:119], a[16:31]
  ds_read_b128 v[116:119], v144 offset:63488
  ds_read_b64_tr_b16 v[120:121], v32 offset:22528
  ds_read_b64_tr_b16 v[122:123], v32 offset:23040
  s_waitcnt lgkmcnt(9)
  v_mfma_f32_32x32x16_bf16 a[16:31], v[72:75], v[68:71], a[16:31]
  v_accvgpr_read_b32 v40, a4
  v_accvgpr_read_b32 v41, a5
  v_accvgpr_read_b32 v42, a6
  v_accvgpr_read_b32 v43, a7
  v_mul_f32 v40, v147, v40
  v_mul_f32 v41, v147, v41
  v_mul_f32 v42, v147, v42
  v_mul_f32 v43, v147, v43
  s_barrier
  ds_read_b128 v[68:71], v144 offset:24576
  ds_read_b64_tr_b16 v[72:73], v32 offset:32768
  ds_read_b64_tr_b16 v[74:75], v32 offset:33280
  s_waitcnt lgkmcnt(9)
  v_mfma_f32_32x32x16_bf16 a[16:31], v[88:91], v[84:87], a[16:31]
  ds_read_b128 v[84:87], v144 offset:26624
  ds_read_b64_tr_b16 v[88:89], v32 offset:34816
  ds_read_b64_tr_b16 v[90:91], v32 offset:35328
  s_waitcnt lgkmcnt(9)
  v_mfma_f32_32x32x16_bf16 a[16:31], v[104:107], v[100:103], a[16:31]
  ds_read_b128 v[100:103], v144 offset:28672
  ds_read_b64_tr_b16 v[104:105], v32 offset:36864
  ds_read_b64_tr_b16 v[106:107], v32 offset:37376
  s_waitcnt lgkmcnt(9)
  v_mfma_f32_32x32x16_bf16 a[16:31], v[120:123], v[116:119], a[16:31]
  ds_read_b128 v[116:119], v144 offset:30720
  ds_read_b64_tr_b16 v[120:121], v32 offset:38912
  ds_read_b64_tr_b16 v[122:123], v32 offset:39424
  s_waitcnt lgkmcnt(9)
  v_mfma_f32_32x32x16_bf16 a[16:31], v[72:75], v[68:71], a[16:31]
  v_accvgpr_read_b32 v44, a8
  v_accvgpr_read_b32 v45, a9
  v_accvgpr_read_b32 v46, a10
  v_accvgpr_read_b32 v47, a11
  v_mul_f32 v44, v147, v44
  v_mul_f32 v45, v147, v45
  v_mul_f32 v46, v147, v46
  v_mul_f32 v47, v147, v47
  s_barrier
  ds_read_b128 v[68:71], v145 offset:0
  ds_read_b64_tr_b16 v[72:73], v32 offset:49152
  ds_read_b64_tr_b16 v[74:75], v32 offset:49664
  s_waitcnt lgkmcnt(9)
  v_mfma_f32_32x32x16_bf16 a[16:31], v[88:91], v[84:87], a[16:31]
  ds_read_b128 v[84:87], v145 offset:2048
  ds_read_b64_tr_b16 v[88:89], v32 offset:51200
  ds_read_b64_tr_b16 v[90:91], v32 offset:51712
  s_waitcnt lgkmcnt(9)
  v_mfma_f32_32x32x16_bf16 a[16:31], v[104:107], v[100:103], a[16:31]
  ds_read_b128 v[100:103], v145 offset:4096
  ds_read_b64_tr_b16 v[104:105], v32 offset:53248
  ds_read_b64_tr_b16 v[106:107], v32 offset:53760
  s_waitcnt lgkmcnt(9)
  v_mfma_f32_32x32x16_bf16 a[16:31], v[120:123], v[116:119], a[16:31]
  ds_read_b128 v[116:119], v145 offset:6144
  ds_read_b64_tr_b16 v[120:121], v32 offset:55296
  ds_read_b64_tr_b16 v[122:123], v32 offset:55808
  s_waitcnt lgkmcnt(9)
  v_mfma_f32_32x32x16_bf16 a[16:31], v[72:75], v[68:71], a[16:31]
  v_accvgpr_read_b32 v48, a12
  v_accvgpr_read_b32 v49, a13
  v_accvgpr_read_b32 v50, a14
  v_accvgpr_read_b32 v51, a15
  v_mul_f32 v48, v147, v48
  v_mul_f32 v49, v147, v49
  v_mul_f32 v50, v147, v50
  v_mul_f32 v51, v147, v51
  s_barrier
  ds_read_b128 v[68:71], v144 offset:40960
  ds_read_b64_tr_b16 v[72:73], v33 offset:16384
  ds_read_b64_tr_b16 v[74:75], v33 offset:16896
  s_waitcnt lgkmcnt(9)
  v_mfma_f32_32x32x16_bf16 a[16:31], v[88:91], v[84:87], a[16:31]
  ds_read_b128 v[84:87], v144 offset:43008
  ds_read_b64_tr_b16 v[88:89], v33 offset:18432
  ds_read_b64_tr_b16 v[90:91], v33 offset:18944
  s_waitcnt lgkmcnt(9)
  v_mfma_f32_32x32x16_bf16 a[16:31], v[104:107], v[100:103], a[16:31]
  ds_read_b128 v[100:103], v144 offset:45056
  ds_read_b64_tr_b16 v[104:105], v33 offset:20480
  ds_read_b64_tr_b16 v[106:107], v33 offset:20992
  s_waitcnt lgkmcnt(9)
  v_mfma_f32_32x32x16_bf16 a[16:31], v[120:123], v[116:119], a[16:31]
  ds_read_b128 v[116:119], v144 offset:47104
  ds_read_b64_tr_b16 v[120:121], v33 offset:22528
  ds_read_b64_tr_b16 v[122:123], v33 offset:23040
  s_waitcnt lgkmcnt(9)
  v_mfma_f32_32x32x16_bf16 a[16:31], v[72:75], v[68:71], a[16:31]
  s_barrier
  ds_read_b128 v[68:71], v145 offset:49152
  ds_read_b64_tr_b16 v[72:73], v33 offset:32768
  ds_read_b64_tr_b16 v[74:75], v33 offset:33280
  s_waitcnt lgkmcnt(9)
  v_mfma_f32_32x32x16_bf16 a[16:31], v[88:91], v[84:87], a[16:31]
  ds_read_b128 v[84:87], v145 offset:51200
  ds_read_b64_tr_b16 v[88:89], v33 offset:34816
  ds_read_b64_tr_b16 v[90:91], v33 offset:35328
  s_waitcnt lgkmcnt(9)
  v_mfma_f32_32x32x16_bf16 a[16:31], v[104:107], v[100:103], a[16:31]
  ds_read_b128 v[100:103], v145 offset:53248
  ds_read_b64_tr_b16 v[104:105], v33 offset:36864
  ds_read_b64_tr_b16 v[106:107], v33 offset:37376
  s_waitcnt lgkmcnt(9)
  v_mfma_f32_32x32x16_bf16 a[16:31], v[120:123], v[116:119], a[16:31]
  ds_read_b128 v[116:119], v145 offset:55296
  ds_read_b64_tr_b16 v[120:121], v33 offset:38912
  ds_read_b64_tr_b16 v[122:123], v33 offset:39424
  s_waitcnt lgkmcnt(9)
  v_mfma_f32_32x32x16_bf16 a[16:31], v[72:75], v[68:71], a[16:31]
  s_barrier
  ds_read_b128 v[68:71], v145 offset:24576
  ds_read_b64_tr_b16 v[72:73], v34 offset:8192
  ds_read_b64_tr_b16 v[74:75], v34 offset:8704
  s_waitcnt lgkmcnt(9)
  v_mfma_f32_32x32x16_bf16 a[16:31], v[88:91], v[84:87], a[16:31]
  ds_read_b128 v[84:87], v145 offset:26624
  ds_read_b64_tr_b16 v[88:89], v34 offset:10240
  ds_read_b64_tr_b16 v[90:91], v34 offset:10752
  s_waitcnt lgkmcnt(9)
  v_mfma_f32_32x32x16_bf16 a[16:31], v[104:107], v[100:103], a[16:31]
  ds_read_b128 v[100:103], v145 offset:28672
  ds_read_b64_tr_b16 v[104:105], v34 offset:12288
  ds_read_b64_tr_b16 v[106:107], v34 offset:12800
  s_waitcnt lgkmcnt(9)
  v_mfma_f32_32x32x16_bf16 a[16:31], v[120:123], v[116:119], a[16:31]
  ds_read_b128 v[116:119], v145 offset:30720
  ds_read_b64_tr_b16 v[120:121], v34 offset:14336
  ds_read_b64_tr_b16 v[122:123], v34 offset:14848
  s_waitcnt lgkmcnt(9)
  v_mfma_f32_32x32x16_bf16 a[16:31], v[72:75], v[68:71], a[16:31]
  s_barrier
  ds_read_b128 v[68:71], v145 offset:57344
  ds_read_b64_tr_b16 v[72:73], v34 offset:16384
  ds_read_b64_tr_b16 v[74:75], v34 offset:16896
  s_waitcnt lgkmcnt(9)
  v_mfma_f32_32x32x16_bf16 a[16:31], v[88:91], v[84:87], a[16:31]
  ds_read_b128 v[84:87], v145 offset:59392
  ds_read_b64_tr_b16 v[88:89], v34 offset:18432
  ds_read_b64_tr_b16 v[90:91], v34 offset:18944
  s_waitcnt lgkmcnt(9)
  v_mfma_f32_32x32x16_bf16 a[16:31], v[104:107], v[100:103], a[16:31]
  ds_read_b128 v[100:103], v145 offset:61440
  ds_read_b64_tr_b16 v[104:105], v34 offset:20480
  ds_read_b64_tr_b16 v[106:107], v34 offset:20992
  s_waitcnt lgkmcnt(9)
  v_mfma_f32_32x32x16_bf16 a[16:31], v[120:123], v[116:119], a[16:31]
  ds_read_b128 v[116:119], v145 offset:63488
  ds_read_b64_tr_b16 v[120:121], v34 offset:22528
  ds_read_b64_tr_b16 v[122:123], v34 offset:23040
  s_waitcnt lgkmcnt(9)
  v_mfma_f32_32x32x16_bf16 a[16:31], v[72:75], v[68:71], a[16:31]
  s_barrier
  ds_read_b128 v[68:71], v145 offset:8192
  ds_read_b64_tr_b16 v[72:73], v34 offset:0
  ds_read_b64_tr_b16 v[74:75], v34 offset:512
  s_waitcnt lgkmcnt(9)
  v_mfma_f32_32x32x16_bf16 a[16:31], v[88:91], v[84:87], a[16:31]
  ds_read_b128 v[84:87], v145 offset:10240
  ds_read_b64_tr_b16 v[88:89], v34 offset:2048
  ds_read_b64_tr_b16 v[90:91], v34 offset:2560
  s_waitcnt lgkmcnt(9)
  v_mfma_f32_32x32x16_bf16 a[16:31], v[104:107], v[100:103], a[16:31]
  ds_read_b128 v[100:103], v145 offset:12288
  ds_read_b64_tr_b16 v[104:105], v34 offset:4096
  ds_read_b64_tr_b16 v[106:107], v34 offset:4608
  s_waitcnt lgkmcnt(9)
  v_mfma_f32_32x32x16_bf16 a[16:31], v[120:123], v[116:119], a[16:31]
  ds_read_b128 v[116:119], v145 offset:14336
  ds_read_b64_tr_b16 v[120:121], v34 offset:6144
  ds_read_b64_tr_b16 v[122:123], v34 offset:6656
  s_waitcnt lgkmcnt(9)
  v_mfma_f32_32x32x16_bf16 a[16:31], v[72:75], v[68:71], a[16:31]
  s_waitcnt lgkmcnt(6)
  v_mfma_f32_32x32x16_bf16 a[16:31], v[88:91], v[84:87], a[16:31]
  s_waitcnt lgkmcnt(3)
  v_mfma_f32_32x32x16_bf16 a[16:31], v[104:107], v[100:103], a[16:31]
  s_waitcnt lgkmcnt(0)
  v_mfma_f32_32x32x16_bf16 a[16:31], v[120:123], v[116:119], a[16:31]
  s_nop 11
  v_accvgpr_read_b32 v52, a16
  v_accvgpr_read_b32 v53, a17
  v_accvgpr_read_b32 v54, a18
  v_accvgpr_read_b32 v55, a19
  v_accvgpr_read_b32 v56, a20
  v_accvgpr_read_b32 v57, a21
  v_accvgpr_read_b32 v58, a22
  v_accvgpr_read_b32 v59, a23
  v_pk_fma_f32 v[52:53], v[52:53], v[136:137], v[36:37]
  v_pk_fma_f32 v[54:55], v[54:55], v[136:137], v[38:39]
  v_pk_fma_f32 v[56:57], v[56:57], v[136:137], v[40:41]
  v_pk_fma_f32 v[58:59], v[58:59], v[136:137], v[42:43]
  v_cvt_pk_bf16_f32 v152, v52, v53
  v_cvt_pk_bf16_f32 v153, v54, v55
  v_cvt_pk_bf16_f32 v154, v56, v57
  v_cvt_pk_bf16_f32 v155, v58, v59
  s_nop 0
  v_permlane32_swap_b32 v152, v154
  v_permlane32_swap_b32 v153, v155
  buffer_store_dwordx4 v[152:155], v11, s[72:75], s24 offen offset:0
  v_accvgpr_read_b32 v60, a24
  v_accvgpr_read_b32 v61, a25
  v_accvgpr_read_b32 v62, a26
  v_accvgpr_read_b32 v63, a27
  v_accvgpr_read_b32 v64, a28
  v_accvgpr_read_b32 v65, a29
  v_accvgpr_read_b32 v66, a30
  v_accvgpr_read_b32 v67, a31
  v_pk_fma_f32 v[60:61], v[60:61], v[136:137], v[44:45]
  v_pk_fma_f32 v[62:63], v[62:63], v[136:137], v[46:47]
  v_pk_fma_f32 v[64:65], v[64:65], v[136:137], v[48:49]
  v_pk_fma_f32 v[66:67], v[66:67], v[136:137], v[50:51]
  v_cvt_pk_bf16_f32 v156, v60, v61
  v_cvt_pk_bf16_f32 v157, v62, v63
  v_cvt_pk_bf16_f32 v158, v64, v65
  v_cvt_pk_bf16_f32 v159, v66, v67
  s_nop 0
  v_permlane32_swap_b32 v156, v158
  v_permlane32_swap_b32 v157, v159
  buffer_store_dwordx4 v[156:159], v11, s[72:75], s24 offen offset:32
  s_endpgm
L_ss_59:
  s_mov_b32 s55, 0
L_sl_61:
  buffer_load_dwordx4 v[152:155], v35, s[56:59], s14 offen offset:0 sc1
  buffer_load_dwordx4 v[156:159], v35, s[56:59], s14 offen offset:1024 sc1
  buffer_load_dwordx4 v[160:163], v35, s[56:59], s14 offen offset:2048 sc1
  buffer_load_dwordx4 v[164:167], v35, s[56:59], s14 offen offset:3072 sc1
  buffer_load_dwordx4 v[168:171], v35, s[56:59], s15 offen offset:0 sc1
  buffer_load_dwordx4 v[172:175], v35, s[56:59], s15 offen offset:1024 sc1
  buffer_load_dwordx4 v[176:179], v35, s[56:59], s15 offen offset:2048 sc1
  s_waitcnt vmcnt(0)
  v_xor_b32 v1, s12, v154
  v_xor_b32 v2, s12, v158
  v_or_b32 v1, v1, v2
  v_xor_b32 v2, s12, v162
  v_or_b32 v1, v1, v2
  v_xor_b32 v2, s12, v166
  v_or_b32 v1, v1, v2
  v_xor_b32 v2, s12, v170
  v_or_b32 v1, v1, v2
  v_xor_b32 v2, s12, v174
  v_or_b32 v1, v1, v2
  v_xor_b32 v2, s12, v178
  v_or_b32 v1, v1, v2
  v_cmp_ne_u32 vcc, 0, v1
  s_nop 0
  s_cmp_eq_u64 vcc, 0
  s_cbranch_scc1 L_sb_60
  s_add_u32 s55, s55, 1
  s_cmp_lt_u32 s55, 200000
  s_cbranch_scc1 L_sl_61
  s_branch L_sb_60
L_ps_62:
  s_mov_b32 s55, 0
L_pl_64:
  buffer_load_dword v10, v9, s[56:59], 0 offen sc1
  s_waitcnt vmcnt(0)
  v_cmp_ne_u32 vcc, s12, v10
  s_nop 0
  s_cmp_eq_u64 vcc, 0
  s_cbranch_scc1 L_pb_63
  s_add_u32 s55, s55, 1
  s_cmp_lt_u32 s55, 200000
  s_cbranch_scc1 L_pl_64
  s_branch L_pb_63
L_pf_65:
  s_cmp_lg_u32 s3, 0
  s_cbranch_scc1 L_pfw_67
  s_lshl_b32 s54, s8, 18
  s_add_u32 s54, s54, 768
  v_lshlrev_b32 v1, 12, v0
  buffer_load_dword v2, v1, s[84:87], s54 offen
  s_branch L_pfb_66
L_pfw_67:
  s_cmp_lg_u32 s3, 1
  s_cbranch_scc1 L_pfw_68
  s_lshl_b32 s54, s8, 18
  s_add_u32 s54, s54, 896
  v_lshlrev_b32 v1, 12, v0
  buffer_load_dword v2, v1, s[84:87], s54 offen
  s_branch L_pfb_66
L_pfw_68:
  s_branch L_pfb_66
L_pf_69:
  s_cmp_lg_u32 s3, 0
  s_cbranch_scc1 L_pfw_71
  s_lshl_b32 s54, s8, 18
  s_add_u32 s54, s54, 1024
  v_lshlrev_b32 v1, 12, v0
  buffer_load_dword v2, v1, s[84:87], s54 offen
  s_branch L_pfb_70
L_pfw_71:
  s_cmp_lg_u32 s3, 1
  s_cbranch_scc1 L_pfw_72
  s_lshl_b32 s54, s8, 18
  s_add_u32 s54, s54, 1152
  v_lshlrev_b32 v1, 12, v0
  buffer_load_dword v2, v1, s[84:87], s54 offen
  s_branch L_pfb_70
L_pfw_72:
  s_branch L_pfb_70
L_pf_73:
  s_cmp_lg_u32 s3, 0
  s_cbranch_scc1 L_pfw_75
  s_lshl_b32 s54, s8, 18
  s_add_u32 s54, s54, 1280
  v_lshlrev_b32 v1, 12, v0
  buffer_load_dword v2, v1, s[84:87], s54 offen
  s_branch L_pfb_74
L_pfw_75:
  s_cmp_lg_u32 s3, 1
  s_cbranch_scc1 L_pfw_76
  s_lshl_b32 s54, s8, 18
  s_add_u32 s54, s54, 1408
  v_lshlrev_b32 v1, 12, v0
  buffer_load_dword v2, v1, s[84:87], s54 offen
  s_branch L_pfb_74
L_pfw_76:
  s_branch L_pfb_74
L_pf_77:
  s_cmp_lg_u32 s3, 0
  s_cbranch_scc1 L_pfw_79
  s_lshl_b32 s54, s8, 18
  s_add_u32 s54, s54, 1536
  v_lshlrev_b32 v1, 12, v0
  buffer_load_dword v2, v1, s[84:87], s54 offen
  s_branch L_pfb_78
L_pfw_79:
  s_cmp_lg_u32 s3, 1
  s_cbranch_scc1 L_pfw_80
  s_lshl_b32 s54, s8, 18
  s_add_u32 s54, s54, 1664
  v_lshlrev_b32 v1, 12, v0
  buffer_load_dword v2, v1, s[84:87], s54 offen
  s_branch L_pfb_78
L_pfw_80:
  s_branch L_pfb_78
L_pf_81:
  s_cmp_lg_u32 s3, 0
  s_cbranch_scc1 L_pfw_83
  s_lshl_b32 s54, s8, 18
  s_add_u32 s54, s54, 1792
  v_lshlrev_b32 v1, 12, v0
  buffer_load_dword v2, v1, s[84:87], s54 offen
  s_branch L_pfb_82
L_pfw_83:
  s_cmp_lg_u32 s3, 1
  s_cbranch_scc1 L_pfw_84
  s_lshl_b32 s54, s8, 18
  s_add_u32 s54, s54, 1920
  v_lshlrev_b32 v1, 12, v0
  buffer_load_dword v2, v1, s[84:87], s54 offen
  s_branch L_pfb_82
L_pfw_84:
  s_branch L_pfb_82
L_ps_85:
  s_mov_b32 s55, 0
L_pl_87:
  buffer_load_dword v10, v9, s[56:59], 0 offen sc1
  s_waitcnt vmcnt(0)
  v_cmp_ne_u32 vcc, s12, v10
  s_nop 0
  s_cmp_eq_u64 vcc, 0
  s_cbranch_scc1 L_pb_86
  s_add_u32 s55, s55, 1
  s_cmp_lt_u32 s55, 200000
  s_cbranch_scc1 L_pl_87
  s_branch L_pb_86
L_pf_88:
  s_cmp_lg_u32 s3, 0
  s_cbranch_scc1 L_pfw_90
  s_lshl_b32 s54, s8, 18
  s_add_u32 s54, s54, 2048
  v_lshlrev_b32 v1, 12, v0
  buffer_load_dword v2, v1, s[84:87], s54 offen
  s_branch L_pfb_89
L_pfw_90:
  s_cmp_lg_u32 s3, 1
  s_cbranch_scc1 L_pfw_91
  s_lshl_b32 s54, s8, 18
  s_add_u32 s54, s54, 2176
  v_lshlrev_b32 v1, 12, v0
  buffer_load_dword v2, v1, s[84:87], s54 offen
  s_branch L_pfb_89
L_pfw_91:
  s_branch L_pfb_89
L_pf_92:
  s_cmp_lg_u32 s3, 0
  s_cbranch_scc1 L_pfw_94
  s_lshl_b32 s54, s8, 18
  s_add_u32 s54, s54, 2304
  v_lshlrev_b32 v1, 12, v0
  buffer_load_dword v2, v1, s[84:87], s54 offen
  s_branch L_pfb_93
L_pfw_94:
  s_cmp_lg_u32 s3, 1
  s_cbranch_scc1 L_pfw_95
  s_lshl_b32 s54, s8, 18
  s_add_u32 s54, s54, 2432
  v_lshlrev_b32 v1, 12, v0
  buffer_load_dword v2, v1, s[84:87], s54 offen
  s_branch L_pfb_93
L_pfw_95:
  s_branch L_pfb_93
L_pf_96:
  s_cmp_lg_u32 s3, 0
  s_cbranch_scc1 L_pfw_98
  s_lshl_b32 s54, s8, 18
  s_add_u32 s54, s54, 2560
  v_lshlrev_b32 v1, 12, v0
  buffer_load_dword v2, v1, s[84:87], s54 offen
  s_branch L_pfb_97
L_pfw_98:
  s_branch L_pfb_97
L_pf_99:
  s_cmp_lg_u32 s3, 0
  s_cbranch_scc1 L_pfw_101
  s_lshl_b32 s54, s8, 18
  s_add_u32 s54, s54, 2688
  v_lshlrev_b32 v1, 12, v0
  buffer_load_dword v2, v1, s[84:87], s54 offen
  s_branch L_pfb_100
L_pfw_101:
  s_branch L_pfb_100
L_pf_102:
  s_cmp_lg_u32 s3, 0
  s_cbranch_scc1 L_pfw_104
  s_lshl_b32 s54, s8, 18
  s_add_u32 s54, s54, 2816
  v_lshlrev_b32 v1, 12, v0
  buffer_load_dword v2, v1, s[84:87], s54 offen
  s_branch L_pfb_103
L_pfw_104:
  s_branch L_pfb_103
L_pf_105:
  s_cmp_lg_u32 s3, 0
  s_cbranch_scc1 L_pfw_107
  s_lshl_b32 s54, s8, 18
  s_add_u32 s54, s54, 2944
  v_lshlrev_b32 v1, 12, v0
  buffer_load_dword v2, v1, s[84:87], s54 offen
  s_branch L_pfb_106
L_pfw_107:
  s_branch L_pfb_106
L_pf_108:
  s_cmp_lg_u32 s3, 0
  s_cbranch_scc1 L_pfw_110
  s_lshl_b32 s54, s8, 18
  s_add_u32 s54, s54, 3072
  v_lshlrev_b32 v1, 12, v0
  buffer_load_dword v2, v1, s[84:87], s54 offen
  s_branch L_pfb_109
L_pfw_110:
  s_branch L_pfb_109
L_pf_111:
  s_cmp_lg_u32 s3, 0
  s_cbranch_scc1 L_pfw_113
  s_lshl_b32 s54, s8, 18
  s_add_u32 s54, s54, 3200
  v_lshlrev_b32 v1, 12, v0
  buffer_load_dword v2, v1, s[84:87], s54 offen
  s_branch L_pfb_112
L_pfw_113:
  s_branch L_pfb_112
L_pf_114:
  s_cmp_lg_u32 s3, 0
  s_cbranch_scc1 L_pfw_116
  s_lshl_b32 s54, s8, 18
  s_add_u32 s54, s54, 3328
  v_lshlrev_b32 v1, 12, v0
  buffer_load_dword v2, v1, s[84:87], s54 offen
  s_branch L_pfb_115
L_pfw_116:
  s_branch L_pfb_115
L_pf_117:
  s_cmp_lg_u32 s3, 0
  s_cbranch_scc1 L_pfw_119
  s_lshl_b32 s54, s8, 18
  s_add_u32 s54, s54, 3456
  v_lshlrev_b32 v1, 12, v0
  buffer_load_dword v2, v1, s[84:87], s54 offen
  s_branch L_pfb_118
L_pfw_119:
  s_branch L_pfb_118
L_pf_120:
  s_cmp_lg_u32 s3, 0
  s_cbranch_scc1 L_pfw_122
  s_lshl_b32 s54, s8, 18
  s_add_u32 s54, s54, 3584
  v_lshlrev_b32 v1, 12, v0
  buffer_load_dword v2, v1, s[84:87], s54 offen
  s_branch L_pfb_121
L_pfw_122:
  s_branch L_pfb_121
L_pf_123:
  s_cmp_lg_u32 s3, 0
  s_cbranch_scc1 L_pfw_125
  s_lshl_b32 s54, s8, 18
  s_add_u32 s54, s54, 3712
  v_lshlrev_b32 v1, 12, v0
  buffer_load_dword v2, v1, s[84:87], s54 offen
  s_branch L_pfb_124
L_pfw_125:
  s_branch L_pfb_124
L_pf_126:
  s_cmp_lg_u32 s3, 0
  s_cbranch_scc1 L_pfw_128
  s_lshl_b32 s54, s8, 18
  s_add_u32 s54, s54, 3840
  v_lshlrev_b32 v1, 12, v0
  buffer_load_dword v2, v1, s[84:87], s54 offen
  s_branch L_pfb_127
L_pfw_128:
  s_branch L_pfb_127
L_pf_129:
  s_cmp_lg_u32 s3, 0
  s_cbranch_scc1 L_pfw_131
  s_lshl_b32 s54, s8, 18
  s_add_u32 s54, s54, 3968
  v_lshlrev_b32 v1, 12, v0
  buffer_load_dword v2, v1, s[84:87], s54 offen
  s_branch L_pfb_130
L_pfw_131:
  s_branch L_pfb_130
L_ps_132:
  s_mov_b32 s55, 0
L_pl_134:
  buffer_load_dword v10, v9, s[56:59], 0 offen sc1
  s_waitcnt vmcnt(0)
  v_cmp_ne_u32 vcc, s12, v10
  s_nop 0
  s_cmp_eq_u64 vcc, 0
  s_cbranch_scc1 L_pb_133
  s_add_u32 s55, s55, 1
  s_cmp_lt_u32 s55, 200000
  s_cbranch_scc1 L_pl_134
  s_branch L_pb_133
L_ps_135:
  s_mov_b32 s55, 0
L_pl_137:
  buffer_load_dword v10, v9, s[56:59], 0 offen sc1
  s_waitcnt vmcnt(0)
  v_cmp_ne_u32 vcc, s12, v10
  s_nop 0
  s_cmp_eq_u64 vcc, 0
  s_cbranch_scc1 L_pb_136
  s_add_u32 s55, s55, 1
  s_cmp_lt_u32 s55, 200000
  s_cbranch_scc1 L_pl_137
  s_branch L_pb_136
L_nu_138:
  s_mov_b32 s55, 0
L_nl_140:
  v_add_u32 v1, 0, v0
  v_lshlrev_b32 v1, 7, v1
  v_add_u32 v1, 36864, v1
  buffer_load_dword v148, v1, s[56:59], 0 offen sc1
  v_add_u32 v1, 64, v0
  v_lshlrev_b32 v1, 7, v1
  v_add_u32 v1, 36864, v1
  buffer_load_dword v149, v1, s[56:59], 0 offen sc1
  v_add_u32 v1, 128, v0
  v_lshlrev_b32 v1, 7, v1
  v_add_u32 v1, 36864, v1
  buffer_load_dword v150, v1, s[56:59], 0 offen sc1
  v_add_u32 v1, 192, v0
  v_lshlrev_b32 v1, 7, v1
  v_add_u32 v1, 36864, v1
  buffer_load_dword v151, v1, s[56:59], 0 offen sc1
  s_waitcnt vmcnt(0)
  v_xor_b32 v1, s12, v148
  v_xor_b32 v2, s12, v149
  v_or_b32 v1, v1, v2
  v_xor_b32 v2, s12, v150
  v_or_b32 v1, v1, v2
  v_xor_b32 v2, s12, v151
  v_or_b32 v1, v1, v2
  v_cmp_ne_u32 vcc, 0, v1
  s_nop 0
  s_cmp_eq_u64 vcc, 0
  s_cbranch_scc1 L_nw_141
  s_add_u32 s55, s55, 1
  s_cmp_lt_u32 s55, 200000
  s_cbranch_scc1 L_nl_140
L_nw_141:
  s_mov_b64 exec, 1
  buffer_store_dword v7, v8, s[56:59], 0 offen sc1
  s_mov_b64 exec, -1
  s_branch L_nb_139
L_entryL:
  s_mov_b32 s40, s16
  s_and_b32 s41, s17, 0xffff
  s_mov_b32 s42, 2097152
  s_mov_b32 s43, 0x20000
  s_mov_b32 s44, s24
  s_and_b32 s45, s25, 0xffff
  s_and_b32 s46, s13, 1835008
  s_mov_b32 s47, 0x20000
  s_cmp_eq_u32 s9, 7
  s_cbranch_scc1 L_L7
  s_add_u32 m0, s5, 0
  s_lshl_b32 s68, s84, 7
  s_add_u32 s68, s68, s69
  buffer_load_dwordx4 v5, s[40:43], s68 offen lds
  buffer_load_dwordx4 v6, s[40:43], s68 offen offset:1024 lds
  s_add_u32 m0, s5, 8192
  s_mul_i32 s68, s84, 229376
  s_add_u32 s68, s68, s70
  buffer_load_dwordx4 v7, s[44:47], s68 offen lds
  buffer_load_dwordx4 v8, s[44:47], s68 offen offset:1024 lds
  s_add_u32 m0, s5, 16384
  s_mul_i32 s68, s84, 229376
  s_add_u32 s68, s68, s70
  s_add_u32 s68, s68, 114688
  buffer_load_dwordx4 v7, s[44:47], s68 offen lds
  buffer_load_dwordx4 v8, s[44:47], s68 offen offset:1024 lds
  s_add_u32 s84, s84, 1
  s_and_b32 s84, s84, 7
  s_add_u32 m0, s5, 24576
  s_lshl_b32 s68, s84, 7
  s_add_u32 s68, s68, s69
  buffer_load_dwordx4 v5, s[40:43], s68 offen lds
  buffer_load_dwordx4 v6, s[40:43], s68 offen offset:1024 lds
  s_add_u32 m0, s5, 32768
  s_mul_i32 s68, s84, 229376
  s_add_u32 s68, s68, s70
  buffer_load_dwordx4 v7, s[44:47], s68 offen lds
  buffer_load_dwordx4 v8, s[44:47], s68 offen offset:1024 lds
  s_add_u32 m0, s5, 40960
  s_mul_i32 s68, s84, 229376
  s_add_u32 s68, s68, s70
  s_add_u32 s68, s68, 114688
  buffer_load_dwordx4 v7, s[44:47], s68 offen lds
  buffer_load_dwordx4 v8, s[44:47], s68 offen offset:1024 lds
  s_add_u32 s84, s84, 1
  s_and_b32 s84, s84, 7
  s_add_u32 m0, s5, 49152
  s_lshl_b32 s68, s84, 7
  s_add_u32 s68, s68, s69
  buffer_load_dwordx4 v5, s[40:43], s68 offen lds
  buffer_load_dwordx4 v6, s[40:43], s68 offen offset:1024 lds
  s_add_u32 m0, s5, 57344
  s_mul_i32 s68, s84, 229376
  s_add_u32 s68, s68, s70
  buffer_load_dwordx4 v7, s[44:47], s68 offen lds
  buffer_load_dwordx4 v8, s[44:47], s68 offen offset:1024 lds
  s_add_u32 m0, s5, 65536
  s_mul_i32 s68, s84, 229376
  s_add_u32 s68, s68, s70
  s_add_u32 s68, s68, 114688
  buffer_load_dwordx4 v7, s[44:47], s68 offen lds
  buffer_load_dwordx4 v8, s[44:47], s68 offen offset:1024 lds
  s_waitcnt vmcnt(12)
  s_barrier
  s_add_u32 s84, s84, 1
  s_and_b32 s84, s84, 7
  s_add_u32 m0, s5, 73728
  s_lshl_b32 s68, s84, 7
  s_add_u32 s68, s68, s69
  buffer_load_dwordx4 v5, s[40:43], s68 offen lds
  buffer_load_dwordx4 v6, s[40:43], s68 offen offset:1024 lds
  s_add_u32 m0, s5, 81920
  s_mul_i32 s68, s84, 229376
  s_add_u32 s68, s68, s70
  buffer_load_dwordx4 v7, s[44:47], s68 offen lds
  buffer_load_dwordx4 v8, s[44:47], s68 offen offset:1024 lds
  s_add_u32 m0, s5, 90112
  s_mul_i32 s68, s84, 229376
  s_add_u32 s68, s68, s70
  s_add_u32 s68, s68, 114688
  buffer_load_dwordx4 v7, s[44:47], s68 offen lds
  buffer_load_dwordx4 v8, s[44:47], s68 offen offset:1024 lds
  s_add_u32 s84, s84, 1
  s_and_b32 s84, s84, 7
  s_add_u32 m0, s5, 98304
  s_lshl_b32 s68, s84, 7
  s_add_u32 s68, s68, s69
  buffer_load_dwordx4 v5, s[40:43], s68 offen lds
  buffer_load_dwordx4 v6, s[40:43], s68 offen offset:1024 lds
  s_mov_b32 s48, s18
  s_and_b32 s49, s19, 0xffff
  s_mov_b32 s50, 1572864
  s_mov_b32 s51, 0x20000
  s_mov_b32 s52, s32
  s_and_b32 s53, s33, 0xffff
  s_mov_b32 s54, 1024
  s_mov_b32 s55, 0x20000
  s_mov_b32 s56, s38
  s_and_b32 s57, s39, 0xffff
  s_mov_b32 s58, 33554432
  s_mov_b32 s59, 0x20000
  s_mov_b32 s80, s38
  s_and_b32 s81, s39, 0xffff
  s_and_b32 s82, s13, 33554432
  s_mov_b32 s83, 0x20000
  s_mov_b32 s76, s26
  s_and_b32 s77, s27, 0xffff
  s_and_b32 s78, s13, 8388608
  s_mov_b32 s79, 0x20000
  s_mov_b32 s60, s20
  s_and_b32 s61, s21, 0xffff
  s_mov_b32 s62, 524288
  s_mov_b32 s63, 0x20000
  s_mov_b32 s64, s30
  s_and_b32 s65, s31, 0xffff
  s_mov_b32 s66, 917504
  s_mov_b32 s67, 0x20000
  s_mov_b32 s14, s75
  s_mov_b32 s15, s75
  s_mov_b32 s16, s75
  s_mov_b32 s17, s75
  s_mov_b32 s18, s75
  s_mul_i32 s19, s73, 0
  s_mul_i32 s6, s74, 0
  s_add_u32 s19, s19, s6
  s_and_b32 s19, s19, 31
  s_mov_b32 s20, s19
  s_lshl_b32 s21, s73, 1
  s_mul_i32 s6, s74, 3
  s_add_u32 s21, s21, s6
  s_cmp_ge_u32 s21, 14
  s_cselect_b32 s6, 14, 0
  s_sub_u32 s21, s21, s6
  s_mov_b32 s22, s21
  v_lshrrev_b32 v1, 4, v0
  v_and_b32 v1, 1, v1
  v_and_b32 v2, 7, v0
  v_lshrrev_b32 v3, 2, v2
  v_xor_b32 v3, v3, v1
  v_lshlrev_b32 v3, 2, v3
  v_and_b32 v2, 3, v2
  v_or_b32 v2, v2, v3
  v_lshrrev_b32 v1, 3, v0
  s_lshl_b32 s6, s4, 4
  v_add_u32 v1, s6, v1
  s_mov_b32 s6, 3072
  v_mul_lo_u32 v1, v1, s6
  v_lshl_add_u32 v9, v2, 4, v1
  v_add_u32 v10, 23552, v9
  v_lshlrev_b32 v11, 4, v0
  s_mov_b32 m0, 155648
  s_nop 0
  buffer_load_dwordx4 v11, s[52:55], 0 offen lds
  v_lshrrev_b32 v1, 4, v0
  v_lshlrev_b32 v1, 4, v1
  v_add_u32 v28, 155648, v1
  v_and_b32 v1, 15, v0
  s_lshl_b32 s6, s4, 4
  v_add_u32 v1, s6, v1
  v_lshrrev_b32 v2, 1, v1
  v_and_b32 v2, 7, v2
  v_lshrrev_b32 v3, 4, v0
  v_add_u32 v4, 0, v3
  v_xor_b32 v4, v4, v2
  v_lshlrev_b32 v4, 4, v4
  v_lshl_add_u32 v29, v1, 7, v4
  v_add_u32 v30, 0x10000, v29
  v_add_u32 v31, 0x20000, v29
  v_add_u32 v4, 4, v3
  v_xor_b32 v4, v4, v2
  v_lshlrev_b32 v4, 4, v4
  v_lshl_add_u32 v32, v1, 7, v4
  v_add_u32 v33, 0x10000, v32
  v_add_u32 v34, 0x20000, v32
  s_waitcnt vmcnt(15)
  s_barrier
  s_add_u32 m0, s5, 106496
  s_mul_i32 s68, s84, 229376
  s_add_u32 s68, s68, s70
  buffer_load_dwordx4 v7, s[44:47], s68 offen lds
  buffer_load_dwordx4 v8, s[44:47], s68 offen offset:1024 lds
  s_add_u32 m0, s5, 114688
  s_mul_i32 s68, s84, 229376
  s_add_u32 s68, s68, s70
  s_add_u32 s68, s68, 114688
  buffer_load_dwordx4 v7, s[44:47], s68 offen lds
  buffer_load_dwordx4 v8, s[44:47], s68 offen offset:1024 lds
  s_add_u32 s84, s84, 1
  s_and_b32 s84, s84, 7
  s_add_u32 m0, s5, 122880
  s_lshl_b32 s68, s84, 7
  s_add_u32 s68, s68, s69
  buffer_load_dwordx4 v5, s[40:43], s68 offen lds
  buffer_load_dwordx4 v6, s[40:43], s68 offen offset:1024 lds
  s_add_u32 m0, s5, 131072
  s_mul_i32 s68, s84, 229376
  s_add_u32 s68, s68, s70
  buffer_load_dwordx4 v7, s[44:47], s68 offen lds
  buffer_load_dwordx4 v8, s[44:47], s68 offen offset:1024 lds
  v_lshrrev_b32 v1, 3, v0
  s_lshl_b32 s6, s4, 4
  v_add_u32 v1, s6, v1
  s_mov_b32 s6, 4096
  v_mul_lo_u32 v1, v1, s6
  v_lshrrev_b32 v2, 4, v0
  v_and_b32 v3, 7, v0
  v_xor_b32 v2, v2, v3
  v_lshl_add_u32 v35, v2, 4, v1
  v_xor_b32 v2, 4, v2
  v_lshl_add_u32 v36, v2, 4, v1
  v_add_u32 v36, 31744, v36
  v_lshrrev_b32 v1, 4, v0
  v_and_b32 v1, 1, v1
  v_and_b32 v2, 7, v0
  v_lshrrev_b32 v3, 2, v2
  v_xor_b32 v3, v3, v1
  v_lshlrev_b32 v3, 2, v3
  v_and_b32 v2, 3, v2
  v_or_b32 v2, v2, v3
  v_lshrrev_b32 v1, 3, v0
  s_lshl_b32 s6, s4, 4
  v_add_u32 v1, s6, v1
  s_mov_b32 s6, 1024
  v_mul_lo_u32 v1, v1, s6
  v_lshl_add_u32 v37, v2, 4, v1
  v_add_u32 v38, 7168, v37
  s_lshl_b32 s23, s8, 18
  s_lshl_b32 s24, s9, 19
  s_add_u32 s24, s24, s5
  s_add_u32 s24, s24, 7340032
  s_lshl_b32 s25, s9, 7
  s_lshl_b32 s26, s4, 16
  s_lshl_b32 s6, s8, 11
  s_add_u32 s26, s26, s6
  s_add_u32 s26, s26, 15728640
  s_mul_i32 s27, s8, 114688
  s_add_u32 s27, s27, s5
  s_add_u32 s27, s27, 11534336
  s_waitcnt vmcnt(17)
  s_barrier
  s_add_u32 m0, s5, 8192
  s_mul_i32 s68, s84, 229376
  s_add_u32 s68, s68, s70
  s_add_u32 s68, s68, 114688
  buffer_load_dwordx4 v7, s[44:47], s68 offen lds
  buffer_load_dwordx4 v8, s[44:47], s68 offen offset:1024 lds
  s_add_u32 s84, s84, 1
  s_and_b32 s84, s84, 7
  s_add_u32 m0, s5, 139264
  s_lshl_b32 s68, s84, 7
  s_add_u32 s68, s68, s69
  buffer_load_dwordx4 v5, s[40:43], s68 offen lds
  buffer_load_dwordx4 v6, s[40:43], s68 offen offset:1024 lds
  s_add_u32 m0, s5, 16384
  s_mul_i32 s68, s84, 229376
  s_add_u32 s68, s68, s70
  buffer_load_dwordx4 v7, s[44:47], s68 offen lds
  buffer_load_dwordx4 v8, s[44:47], s68 offen offset:1024 lds
  s_add_u32 m0, s5, 147456
  s_mul_i32 s68, s84, 229376
  s_add_u32 s68, s68, s70
  s_add_u32 s68, s68, 114688
  buffer_load_dwordx4 v7, s[44:47], s68 offen lds
  buffer_load_dwordx4 v8, s[44:47], s68 offen offset:1024 lds
  s_waitcnt vmcnt(19)
  s_barrier
  s_waitcnt vmcnt(12)
  s_barrier
  s_add_u32 s84, s84, 1
  s_and_b32 s84, s84, 7
  s_add_u32 m0, s5, 57344
  s_lshl_b32 s68, s84, 7
  s_add_u32 s68, s68, s69
  buffer_load_dwordx4 v5, s[40:43], s68 offen lds
  buffer_load_dwordx4 v6, s[40:43], s68 offen offset:1024 lds
  s_add_u32 m0, s5, 32768
  s_mul_i32 s68, s84, 229376
  s_add_u32 s68, s68, s70
  buffer_load_dwordx4 v7, s[44:47], s68 offen lds
  buffer_load_dwordx4 v8, s[44:47], s68 offen offset:1024 lds
  s_add_u32 m0, s5, 40960
  s_mul_i32 s68, s84, 229376
  s_add_u32 s68, s68, s70
  s_add_u32 s68, s68, 114688
  buffer_load_dwordx4 v7, s[44:47], s68 offen lds
  buffer_load_dwordx4 v8, s[44:47], s68 offen offset:1024 lds
  s_add_u32 m0, s5, 65536
  s_mul_i32 s68, s14, 196608
  s_add_u32 s68, s68, s72
  buffer_load_dwordx4 v9, s[48:51], s68 offen lds
  buffer_load_dwordx4 v10, s[48:51], s68 offen offset:1024 lds
  s_waitcnt vmcnt(14)
  s_barrier
  s_add_u32 m0, s5, 81920
  s_mul_i32 s68, s14, 196608
  s_add_u32 s68, s68, s72
  s_add_u32 s68, s68, 1024
  buffer_load_dwordx4 v9, s[48:51], s68 offen lds
  buffer_load_dwordx4 v10, s[48:51], s68 offen offset:1024 lds
  s_add_u32 m0, s5, 90112
  s_mul_i32 s68, s14, 196608
  s_add_u32 s68, s68, s72
  s_add_u32 s68, s68, 2048
  buffer_load_dwordx4 v9, s[48:51], s68 offen lds
  buffer_load_dwordx4 v10, s[48:51], s68 offen offset:1024 lds
  s_waitcnt vmcnt(12)
  s_barrier
  s_add_u32 s14, s14, 1
  s_and_b32 s14, s14, 7
  s_add_u32 m0, s5, 106496
  s_mul_i32 s68, s14, 196608
  s_add_u32 s68, s68, s72
  buffer_load_dwordx4 v9, s[48:51], s68 offen lds
  buffer_load_dwordx4 v10, s[48:51], s68 offen offset:1024 lds
  s_add_u32 m0, s5, 114688
  s_mul_i32 s68, s14, 196608
  s_add_u32 s68, s68, s72
  s_add_u32 s68, s68, 1024
  buffer_load_dwordx4 v9, s[48:51], s68 offen lds
  buffer_load_dwordx4 v10, s[48:51], s68 offen offset:1024 lds
  s_waitcnt vmcnt(10)
  s_barrier
  s_add_u32 m0, s5, 8192
  s_mul_i32 s68, s14, 196608
  s_add_u32 s68, s68, s72
  s_add_u32 s68, s68, 2048
  buffer_load_dwordx4 v9, s[48:51], s68 offen lds
  buffer_load_dwordx4 v10, s[48:51], s68 offen offset:1024 lds
  s_add_u32 s14, s14, 1
  s_and_b32 s14, s14, 7
  s_add_u32 m0, s5, 131072
  s_mul_i32 s68, s14, 196608
  s_add_u32 s68, s68, s72
  buffer_load_dwordx4 v9, s[48:51], s68 offen lds
  buffer_load_dwordx4 v10, s[48:51], s68 offen offset:1024 lds
  s_waitcnt vmcnt(8)
  s_barrier
  s_add_u32 m0, s5, 16384
  s_mul_i32 s68, s14, 196608
  s_add_u32 s68, s68, s72
  s_add_u32 s68, s68, 1024
  buffer_load_dwordx4 v9, s[48:51], s68 offen lds
  s_lshl_b32 s6, s18, 7
  v_add_u32 v1, s6, v28
  ds_read_b128 v[12:15], v1 offset:0
  ds_read_b128 v[20:23], v29 offset:0
  ds_read_b128 v[16:19], v1 offset:64
  ds_read_b128 v[24:27], v32 offset:0
  buffer_load_dwordx4 v10, s[48:51], s68 offen offset:1024 lds
  s_add_u32 m0, s5, 147456
  s_mul_i32 s68, s14, 196608
  s_add_u32 s68, s68, s72
  s_add_u32 s68, s68, 2048
  buffer_load_dwordx4 v9, s[48:51], s68 offen lds
  buffer_load_dwordx4 v10, s[48:51], s68 offen offset:1024 lds
  s_waitcnt lgkmcnt(0)
  v_mfma_f32_16x16x32_bf16 a[0:3], v[12:15], v[20:23], 0
  v_mfma_f32_16x16x32_bf16 a[0:3], v[16:19], v[24:27], a[0:3]
  s_waitcnt vmcnt(6)
  s_barrier
  s_add_u32 s14, s14, 1
  s_and_b32 s14, s14, 7
  s_add_u32 m0, s5, 32768
  s_mul_i32 s68, s14, 196608
  s_add_u32 s68, s68, s72
  buffer_load_dwordx4 v9, s[48:51], s68 offen lds
  s_add_u32 s18, s18, 1
  s_and_b32 s18, s18, 7
  s_lshl_b32 s6, s18, 7
  v_add_u32 v1, s6, v28
  ds_read_b128 v[12:15], v1 offset:0
  ds_read_b128 v[20:23], v29 offset:24576
  ds_read_b128 v[16:19], v1 offset:64
  ds_read_b128 v[24:27], v32 offset:24576
  buffer_load_dwordx4 v10, s[48:51], s68 offen offset:1024 lds
  s_add_u32 m0, s5, 40960
  s_mul_i32 s68, s14, 196608
  s_add_u32 s68, s68, s72
  s_add_u32 s68, s68, 1024
  buffer_load_dwordx4 v9, s[48:51], s68 offen lds
  buffer_load_dwordx4 v10, s[48:51], s68 offen offset:1024 lds
  s_waitcnt lgkmcnt(0)
  v_mfma_f32_16x16x32_bf16 a[0:3], v[12:15], v[20:23], a[0:3]
  v_mfma_f32_16x16x32_bf16 a[0:3], v[16:19], v[24:27], a[0:3]
  s_waitcnt vmcnt(4)
  s_barrier
  s_add_u32 m0, s5, 65536
  s_mul_i32 s68, s14, 196608
  s_add_u32 s68, s68, s72
  s_add_u32 s68, s68, 2048
  buffer_load_dwordx4 v9, s[48:51], s68 offen lds
  s_add_u32 s18, s18, 1
  s_and_b32 s18, s18, 7
  s_lshl_b32 s6, s18, 7
  v_add_u32 v1, s6, v28
  ds_read_b128 v[12:15], v1 offset:0
  ds_read_b128 v[20:23], v29 offset:49152
  ds_read_b128 v[16:19], v1 offset:64
  ds_read_b128 v[24:27], v32 offset:49152
  buffer_load_dwordx4 v10, s[48:51], s68 offen offset:1024 lds
  s_add_u32 s14, s14, 1
  s_and_b32 s14, s14, 7
  s_add_u32 m0, s5, 81920
  s_mul_i32 s68, s14, 196608
  s_add_u32 s68, s68, s72
  buffer_load_dwordx4 v9, s[48:51], s68 offen lds
  buffer_load_dwordx4 v10, s[48:51], s68 offen offset:1024 lds
  s_add_u32 m0, s5, 90112
  s_mul_i32 s68, s14, 196608
  s_add_u32 s68, s68, s72
  s_add_u32 s68, s68, 1024
  buffer_load_dwordx4 v9, s[48:51], s68 offen lds
  s_waitcnt lgkmcnt(0)
  v_mfma_f32_16x16x32_bf16 a[0:3], v[12:15], v[20:23], a[0:3]
  v_mfma_f32_16x16x32_bf16 a[0:3], v[16:19], v[24:27], a[0:3]
  buffer_load_dwordx4 v10, s[48:51], s68 offen offset:1024 lds
  s_waitcnt vmcnt(4)
  s_barrier
  s_add_u32 m0, s5, 8192
  s_mul_i32 s68, s14, 196608
  s_add_u32 s68, s68, s72
  s_add_u32 s68, s68, 2048
  buffer_load_dwordx4 v9, s[48:51], s68 offen lds
  s_add_u32 s18, s18, 1
  s_and_b32 s18, s18, 7
  s_lshl_b32 s6, s18, 7
  v_add_u32 v1, s6, v28
  ds_read_b128 v[12:15], v1 offset:0
  ds_read_b128 v[20:23], v30 offset:8192
  ds_read_b128 v[16:19], v1 offset:64
  ds_read_b128 v[24:27], v33 offset:8192
  buffer_load_dwordx4 v10, s[48:51], s68 offen offset:1024 lds
  s_add_u32 s14, s14, 1
  s_and_b32 s14, s14, 7
  s_add_u32 m0, s5, 106496
  s_mul_i32 s68, s14, 196608
  s_add_u32 s68, s68, s72
  buffer_load_dwordx4 v9, s[48:51], s68 offen lds
  buffer_load_dwordx4 v10, s[48:51], s68 offen offset:1024 lds
  s_add_u32 m0, s5, 114688
  s_mul_i32 s68, s14, 196608
  s_add_u32 s68, s68, s72
  s_add_u32 s68, s68, 1024
  buffer_load_dwordx4 v9, s[48:51], s68 offen lds
  s_waitcnt lgkmcnt(0)
  v_mfma_f32_16x16x32_bf16 a[0:3], v[12:15], v[20:23], a[0:3]
  v_mfma_f32_16x16x32_bf16 a[0:3], v[16:19], v[24:27], a[0:3]
  buffer_load_dwordx4 v10, s[48:51], s68 offen offset:1024 lds
  s_waitcnt vmcnt(4)
  s_barrier
  s_add_u32 m0, s5, 16384
  s_mul_i32 s68, s14, 196608
  s_add_u32 s68, s68, s72
  s_add_u32 s68, s68, 2048
  buffer_load_dwordx4 v9, s[48:51], s68 offen lds
  s_add_u32 s18, s18, 1
  s_and_b32 s18, s18, 7
  s_lshl_b32 s6, s18, 7
  v_add_u32 v1, s6, v28
  ds_read_b128 v[12:15], v1 offset:0
  ds_read_b128 v[20:23], v30 offset:32768
  ds_read_b128 v[16:19], v1 offset:64
  ds_read_b128 v[24:27], v33 offset:32768
  buffer_load_dwordx4 v10, s[48:51], s68 offen offset:1024 lds
  s_add_u32 s14, s14, 1
  s_and_b32 s14, s14, 7
  s_add_u32 m0, s5, 131072
  s_mul_i32 s68, s14, 196608
  s_add_u32 s68, s68, s72
  buffer_load_dwordx4 v9, s[48:51], s68 offen lds
  buffer_load_dwordx4 v10, s[48:51], s68 offen offset:1024 lds
  s_add_u32 m0, s5, 147456
  s_mul_i32 s68, s14, 196608
  s_add_u32 s68, s68, s72
  s_add_u32 s68, s68, 1024
  buffer_load_dwordx4 v9, s[48:51], s68 offen lds
  s_waitcnt lgkmcnt(0)
  v_mfma_f32_16x16x32_bf16 a[0:3], v[12:15], v[20:23], a[0:3]
  v_mfma_f32_16x16x32_bf16 a[0:3], v[16:19], v[24:27], a[0:3]
  buffer_load_dwordx4 v10, s[48:51], s68 offen offset:1024 lds
  s_waitcnt vmcnt(4)
  s_barrier
  s_add_u32 m0, s5, 32768
  s_mul_i32 s68, s14, 196608
  s_add_u32 s68, s68, s72
  s_add_u32 s68, s68, 2048
  buffer_load_dwordx4 v9, s[48:51], s68 offen lds
  s_add_u32 s18, s18, 1
  s_and_b32 s18, s18, 7
  s_lshl_b32 s6, s18, 7
  v_add_u32 v1, s6, v28
  ds_read_b128 v[12:15], v1 offset:0
  ds_read_b128 v[20:23], v30 offset:57344
  ds_read_b128 v[16:19], v1 offset:64
  ds_read_b128 v[24:27], v33 offset:57344
  buffer_load_dwordx4 v10, s[48:51], s68 offen offset:1024 lds
  s_add_u32 s14, s14, 1
  s_and_b32 s14, s14, 7
  s_add_u32 m0, s5, 40960
  s_mul_i32 s68, s14, 196608
  s_add_u32 s68, s68, s72
  buffer_load_dwordx4 v9, s[48:51], s68 offen lds
  buffer_load_dwordx4 v10, s[48:51], s68 offen offset:1024 lds
  s_add_u32 m0, s5, 65536
  s_mul_i32 s68, s14, 196608
  s_add_u32 s68, s68, s72
  s_add_u32 s68, s68, 1024
  buffer_load_dwordx4 v9, s[48:51], s68 offen lds
  s_waitcnt lgkmcnt(0)
  v_mfma_f32_16x16x32_bf16 a[0:3], v[12:15], v[20:23], a[0:3]
  v_mfma_f32_16x16x32_bf16 a[0:3], v[16:19], v[24:27], a[0:3]
  buffer_load_dwordx4 v10, s[48:51], s68 offen offset:1024 lds
  s_waitcnt vmcnt(4)
  s_barrier
  s_add_u32 m0, s5, 8192
  s_mul_i32 s68, s14, 196608
  s_add_u32 s68, s68, s72
  s_add_u32 s68, s68, 2048
  buffer_load_dwordx4 v9, s[48:51], s68 offen lds
  s_add_u32 s18, s18, 1
  s_and_b32 s18, s18, 7
  s_lshl_b32 s6, s18, 7
  v_add_u32 v1, s6, v28
  ds_read_b128 v[12:15], v1 offset:0
  ds_read_b128 v[20:23], v31 offset:8192
  ds_read_b128 v[16:19], v1 offset:64
  ds_read_b128 v[24:27], v34 offset:8192
  buffer_load_dwordx4 v10, s[48:51], s68 offen offset:1024 lds
  s_add_u32 m0, s5, 81920
  s_mul_i32 s68, s15, 229376
  s_add_u32 s68, s68, s71
  buffer_load_dwordx4 v7, s[44:47], s68 offen lds
  buffer_load_dwordx4 v8, s[44:47], s68 offen offset:1024 lds
  s_add_u32 m0, s5, 90112
  s_mul_i32 s68, s15, 229376
  s_add_u32 s68, s68, s71
  s_add_u32 s68, s68, 114688
  buffer_load_dwordx4 v7, s[44:47], s68 offen lds
  s_waitcnt lgkmcnt(0)
  v_mfma_f32_16x16x32_bf16 a[0:3], v[12:15], v[20:23], a[0:3]
  v_mfma_f32_16x16x32_bf16 a[0:3], v[16:19], v[24:27], a[0:3]
  buffer_load_dwordx4 v8, s[44:47], s68 offen offset:1024 lds
  s_waitcnt vmcnt(4)
  s_barrier
  s_add_u32 s15, s15, 1
  s_and_b32 s15, s15, 7
  s_add_u32 m0, s5, 16384
  s_mul_i32 s68, s15, 229376
  s_add_u32 s68, s68, s71
  buffer_load_dwordx4 v7, s[44:47], s68 offen lds
  s_add_u32 s18, s18, 1
  s_and_b32 s18, s18, 7
  s_lshl_b32 s6, s18, 7
  v_add_u32 v1, s6, v28
  ds_read_b128 v[12:15], v1 offset:0
  ds_read_b128 v[20:23], v29 offset:57344
  ds_read_b128 v[16:19], v1 offset:64
  ds_read_b128 v[24:27], v32 offset:57344
  buffer_load_dwordx4 v8, s[44:47], s68 offen offset:1024 lds
  s_add_u32 m0, s5, 106496
  s_mul_i32 s68, s15, 229376
  s_add_u32 s68, s68, s71
  s_add_u32 s68, s68, 114688
  buffer_load_dwordx4 v7, s[44:47], s68 offen lds
  buffer_load_dwordx4 v8, s[44:47], s68 offen offset:1024 lds
  s_add_u32 s15, s15, 1
  s_and_b32 s15, s15, 7
  s_add_u32 m0, s5, 114688
  s_mul_i32 s68, s15, 229376
  s_add_u32 s68, s68, s71
  buffer_load_dwordx4 v7, s[44:47], s68 offen lds
  s_waitcnt lgkmcnt(0)
  v_mfma_f32_16x16x32_bf16 a[0:3], v[12:15], v[20:23], a[0:3]
  v_mfma_f32_16x16x32_bf16 a[0:3], v[16:19], v[24:27], a[0:3]
  buffer_load_dwordx4 v8, s[44:47], s68 offen offset:1024 lds
  s_waitcnt vmcnt(6)
  s_barrier
  s_nop 4
  v_accvgpr_read_b32 v1, a0
  v_mul_f32 v1, 0xbfb8aa3b, v1
  v_exp_f32 v1, v1
  s_nop 0
  v_add_f32 v1, 1.0, v1
  v_rcp_f32 v1, v1
  v_and_b32 v2, 15, v0
  s_lshl_b32 s6, s4, 4
  v_add_u32 v2, s6, v2
  v_lshlrev_b32 v2, 2, v2
  v_add_u32 v2, 156672, v2
  ds_write_b32 v2, v1
  s_add_u32 m0, s5, 32768
  s_mul_i32 s68, s15, 229376
  s_add_u32 s68, s68, s71
  s_add_u32 s68, s68, 114688
  buffer_load_dwordx4 v7, s[44:47], s68 offen lds
  buffer_load_dwordx4 v8, s[44:47], s68 offen offset:1024 lds
  s_add_u32 s15, s15, 1
  s_and_b32 s15, s15, 7
  s_add_u32 m0, s5, 131072
  s_mul_i32 s68, s15, 229376
  s_add_u32 s68, s68, s71
  buffer_load_dwordx4 v7, s[44:47], s68 offen lds
  buffer_load_dwordx4 v8, s[44:47], s68 offen offset:1024 lds
  s_add_u32 m0, s5, 147456
  s_mul_i32 s68, s15, 229376
  s_add_u32 s68, s68, s71
  s_add_u32 s68, s68, 114688
  buffer_load_dwordx4 v7, s[44:47], s68 offen lds
  buffer_load_dwordx4 v8, s[44:47], s68 offen offset:1024 lds
  s_waitcnt vmcnt(8)
  s_waitcnt lgkmcnt(0)
  s_barrier
  s_add_u32 s15, s15, 1
  s_and_b32 s15, s15, 7
  s_add_u32 m0, s5, 8192
  s_mul_i32 s68, s15, 229376
  s_add_u32 s68, s68, s71
  buffer_load_dwordx4 v7, s[44:47], s68 offen lds
  v_and_b32 v154, 31, v0
  v_lshrrev_b32 v155, 5, v0
  v_lshlrev_b32 v1, 2, v155
  v_sub_u32 v1, v154, v1
  v_mov_b32 v3, 0xff800000
  buffer_load_dwordx4 v8, s[44:47], s68 offen offset:1024 lds
  v_cmp_le_i32 vcc, 0, v1
  s_nop 1
  v_cndmask_b32_e64 v104, v3, 0, vcc
  v_cndmask_b32_e64 v88, 0, v3, vcc
  s_add_u32 m0, s5, 40960
  s_mul_i32 s68, s15, 229376
  s_add_u32 s68, s68, s71
  s_add_u32 s68, s68, 114688
  buffer_load_dwordx4 v7, s[44:47], s68 offen lds
  buffer_load_dwordx4 v8, s[44:47], s68 offen offset:1024 lds
  v_cmp_le_i32 vcc, 1, v1
  s_nop 1
  v_cndmask_b32_e64 v105, v3, 0, vcc
  v_cndmask_b32_e64 v89, 0, v3, vcc
  s_add_u32 s15, s15, 1
  s_and_b32 s15, s15, 7
  s_add_u32 m0, s5, 65536
  s_mul_i32 s68, s15, 229376
  s_add_u32 s68, s68, s71
  buffer_load_dwordx4 v7, s[44:47], s68 offen lds
  v_cmp_le_i32 vcc, 2, v1
  s_nop 1
  v_cndmask_b32_e64 v106, v3, 0, vcc
  v_cndmask_b32_e64 v90, 0, v3, vcc
  buffer_load_dwordx4 v8, s[44:47], s68 offen offset:1024 lds
  s_waitcnt vmcnt(10)
  s_barrier
  s_add_u32 m0, s5, 0
  s_mul_i32 s68, s15, 229376
  s_add_u32 s68, s68, s71
  s_add_u32 s68, s68, 114688
  buffer_load_dwordx4 v7, s[44:47], s68 offen lds
  v_cmp_le_i32 vcc, 3, v1
  s_nop 1
  v_cndmask_b32_e64 v107, v3, 0, vcc
  v_cndmask_b32_e64 v91, 0, v3, vcc
  buffer_load_dwordx4 v8, s[44:47], s68 offen offset:1024 lds
  v_cmp_le_i32 vcc, 8, v1
  s_nop 1
  v_cndmask_b32_e64 v108, v3, 0, vcc
  v_cndmask_b32_e64 v92, 0, v3, vcc
  s_add_u32 s15, s15, 1
  s_and_b32 s15, s15, 7
  s_add_u32 m0, s5, 81920
  s_mul_i32 s68, s15, 229376
  s_add_u32 s68, s68, s71
  buffer_load_dwordx4 v7, s[44:47], s68 offen lds
  buffer_load_dwordx4 v8, s[44:47], s68 offen offset:1024 lds
  v_cmp_le_i32 vcc, 9, v1
  s_nop 1
  v_cndmask_b32_e64 v109, v3, 0, vcc
  v_cndmask_b32_e64 v93, 0, v3, vcc
  s_add_u32 m0, s5, 90112
  s_mul_i32 s68, s15, 229376
  s_add_u32 s68, s68, s71
  s_add_u32 s68, s68, 114688
  buffer_load_dwordx4 v7, s[44:47], s68 offen lds
  v_cmp_le_i32 vcc, 10, v1
  s_nop 1
  v_cndmask_b32_e64 v110, v3, 0, vcc
  v_cndmask_b32_e64 v94, 0, v3, vcc
  buffer_load_dwordx4 v8, s[44:47], s68 offen offset:1024 lds
  s_waitcnt vmcnt(12)
  s_barrier
  s_add_u32 s15, s15, 1
  s_and_b32 s15, s15, 7
  s_add_u32 m0, s5, 106496
  s_mul_i32 s68, s15, 229376
  s_add_u32 s68, s68, s71
  buffer_load_dwordx4 v7, s[44:47], s68 offen lds
  v_cmp_le_i32 vcc, 11, v1
  s_nop 1
  v_cndmask_b32_e64 v111, v3, 0, vcc
  v_cndmask_b32_e64 v95, 0, v3, vcc
  v_cmp_le_i32 vcc, 16, v1
  s_nop 1
  v_cndmask_b32_e64 v112, v3, 0, vcc
  v_cndmask_b32_e64 v96, 0, v3, vcc
  buffer_load_dwordx4 v8, s[44:47], s68 offen offset:1024 lds
  v_cmp_le_i32 vcc, 17, v1
  s_nop 1
  v_cndmask_b32_e64 v113, v3, 0, vcc
  v_cndmask_b32_e64 v97, 0, v3, vcc
  v_cmp_le_i32 vcc, 18, v1
  s_nop 1
  v_cndmask_b32_e64 v114, v3, 0, vcc
  v_cndmask_b32_e64 v98, 0, v3, vcc
  s_waitcnt vmcnt(10)
  s_barrier
  s_add_u32 m0, s5, 49152
  s_mul_i32 s68, s15, 229376
  s_add_u32 s68, s68, s71
  s_add_u32 s68, s68, 114688
  buffer_load_dwordx4 v7, s[44:47], s68 offen lds
  v_cmp_le_i32 vcc, 19, v1
  s_nop 1
  v_cndmask_b32_e64 v115, v3, 0, vcc
  v_cndmask_b32_e64 v99, 0, v3, vcc
  buffer_load_dwordx4 v8, s[44:47], s68 offen offset:1024 lds
  v_cmp_le_i32 vcc, 24, v1
  s_nop 1
  v_cndmask_b32_e64 v116, v3, 0, vcc
  v_cndmask_b32_e64 v100, 0, v3, vcc
  s_add_u32 m0, s5, 16384
  s_lshl_b32 s68, s19, 7
  s_add_u32 s68, s68, s23
  buffer_load_dwordx4 v35, s[76:79], s68 offen lds
  v_cmp_le_i32 vcc, 25, v1
  s_nop 1
  v_cndmask_b32_e64 v117, v3, 0, vcc
  v_cndmask_b32_e64 v101, 0, v3, vcc
  buffer_load_dwordx4 v36, s[76:79], s68 offen offset:1024 lds
  v_cmp_le_i32 vcc, 26, v1
  s_nop 1
  v_cndmask_b32_e64 v118, v3, 0, vcc
  v_cndmask_b32_e64 v102, 0, v3, vcc
  s_waitcnt vmcnt(10)
  s_barrier
  v_cmp_le_i32 vcc, 27, v1
  s_nop 1
  v_cndmask_b32_e64 v119, v3, 0, vcc
  v_cndmask_b32_e64 v103, 0, v3, vcc
  v_mov_b32 v2, 0x3f803f80
  v_accvgpr_write_b32 a60, v2
  v_accvgpr_write_b32 a61, v2
  v_accvgpr_write_b32 a62, v2
  v_accvgpr_write_b32 a63, v2
  v_accvgpr_write_b32 a64, v2
  v_accvgpr_write_b32 a65, v2
  v_accvgpr_write_b32 a66, v2
  v_accvgpr_write_b32 a67, v2
  v_accvgpr_write_b32 a68, v2
  v_accvgpr_write_b32 a69, v2
  v_accvgpr_write_b32 a70, v2
  v_accvgpr_write_b32 a71, v2
  v_accvgpr_write_b32 a72, v2
  v_accvgpr_write_b32 a73, v2
  v_accvgpr_write_b32 a74, v2
  v_accvgpr_write_b32 a75, v2
  v_lshrrev_b32 v1, 3, v154
  v_and_b32 v1, 1, v1
  v_xor_b32 v1, v1, v155
  v_lshlrev_b32 v1, 4, v1
  v_lshl_add_u32 v162, v154, 5, v1
  s_lshl_b32 s6, s4, 10
  s_add_u32 s7, s6, 122880
  v_add_u32 v160, s7, v162
  v_and_b32 v1, 15, v0
  v_lshrrev_b32 v2, 3, v1
  v_xor_b32 v2, v2, v155
  v_lshlrev_b32 v2, 4, v2
  v_lshl_add_u32 v1, v1, 5, v2
  s_add_u32 s7, s6, 139264
  v_add_u32 v161, s7, v1
  v_lshlrev_b32 v1, 5, v154
  v_lshl_add_u32 v163, v155, 4, v1
  s_mov_b32 s34, 0xffff
  s_mov_b32 s35, 0xffff
  s_lshl_b32 s30, s10, 16
  s_lshl_b32 s6, s11, 13
  s_add_u32 s32, s30, s6
  s_sub_u32 s7, s6, 8192
  s_max_i32 s7, s7, 0
  s_add_u32 s31, s30, s7
  s_add_u32 s31, s31, s5
  s_add_u32 s30, s32, s5
  s_lshl_b32 s7, s4, 10
  s_add_u32 s32, s32, s7
  s_sub_u32 s28, 8, s4
  s_cmp_eq_u32 s11, 0
  s_cselect_b32 s28, s28, 0
  s_sub_u32 s29, 4, s4
  s_cmp_eq_u32 s11, 0
  s_cselect_b32 s29, s29, 0
  s_waitcnt vmcnt(6)
  s_barrier
  s_add_u32 s19, s19, 1
  s_and_b32 s19, s19, 31
  s_add_u32 m0, s5, 40960
  s_lshl_b32 s68, s19, 7
  s_add_u32 s68, s68, s23
  buffer_load_dwordx4 v35, s[76:79], s68 offen lds
  buffer_load_dwordx4 v36, s[76:79], s68 offen offset:1024 lds
  s_waitcnt vmcnt(4)
  s_barrier
  s_add_u32 m0, s5, 0
  s_lshl_b32 s68, s20, 14
  s_add_u32 s68, s68, s24
  buffer_load_dwordx4 v11, s[80:83], s68 offen sc1 lds
  buffer_load_dwordx4 v11, s[80:83], s68 offen offset:1024 sc1 lds
  s_add_u32 m0, s5, 8192
  s_lshl_b32 s68, s20, 14
  s_add_u32 s68, s68, s24
  s_add_u32 s68, s68, 8192
  buffer_load_dwordx4 v11, s[80:83], s68 offen sc1 lds
  buffer_load_dwordx4 v11, s[80:83], s68 offen offset:1024 sc1 lds
  s_add_u32 s20, s20, 1
  s_and_b32 s20, s20, 31
  s_add_u32 m0, s5, 24576
  s_lshl_b32 s68, s20, 14
  s_add_u32 s68, s68, s24
  buffer_load_dwordx4 v11, s[80:83], s68 offen sc1 lds
  buffer_load_dwordx4 v11, s[80:83], s68 offen offset:1024 sc1 lds
  s_add_u32 m0, s5, 32768
  s_lshl_b32 s68, s20, 14
  s_add_u32 s68, s68, s24
  s_add_u32 s68, s68, 8192
  buffer_load_dwordx4 v11, s[80:83], s68 offen sc1 lds
  buffer_load_dwordx4 v11, s[80:83], s68 offen offset:1024 sc1 lds
  s_add_u32 s19, s19, 1
  s_and_b32 s19, s19, 31
  s_add_u32 m0, s5, 65536
  s_lshl_b32 s68, s19, 7
  s_add_u32 s68, s68, s23
  buffer_load_dwordx4 v35, s[76:79], s68 offen lds
  buffer_load_dwordx4 v36, s[76:79], s68 offen offset:1024 lds
  s_waitcnt vmcnt(6)
  s_barrier
L_L_gentry:
  s_waitcnt vmcnt(2)
  s_barrier
  s_waitcnt vmcnt(0)
  s_barrier
  s_barrier
  s_barrier
  s_barrier
  s_add_u32 m0, s5, 122880
  s_add_u32 s68, s31, 3145728
  buffer_load_dwordx4 v11, s[56:59], s68 offen sc1 lds
  buffer_load_dwordx4 v11, s[56:59], s68 offen offset:1024 sc1 lds
  s_add_u32 m0, s5, 139264
  s_add_u32 s68, s31, 5242880
  buffer_load_dwordx4 v11, s[56:59], s68 offen sc1 lds
  buffer_load_dwordx4 v11, s[56:59], s68 offen offset:1024 sc1 lds
  s_add_u32 m0, s5, 131072
  s_add_u32 s68, s30, 3145728
  buffer_load_dwordx4 v11, s[56:59], s68 offen sc1 lds
  buffer_load_dwordx4 v11, s[56:59], s68 offen offset:1024 sc1 lds
  s_add_u32 m0, s5, 147456
  s_add_u32 s68, s30, 5242880
  buffer_load_dwordx4 v11, s[56:59], s68 offen sc1 lds
  buffer_load_dwordx4 v11, s[56:59], s68 offen offset:1024 sc1 lds
  s_add_u32 s6, s32, 1048576
  buffer_load_dwordx4 a[16:19], v163, s[56:59], s6 offen sc1
  s_add_u32 s6, s32, 1052672
  buffer_load_dwordx4 a[20:23], v163, s[56:59], s6 offen sc1
  s_barrier
  s_waitcnt vmcnt(0)
  s_barrier
  s_cmp_eq_u32 s11, 0
  s_cbranch_scc1 L_att_q0
  ds_read_b128 a[24:27], v160 offset:8192
  ds_read_b128 a[28:31], v160 offset:7168
  ds_read_b128 a[32:35], v160 offset:6144
  ds_read_b128 a[36:39], v160 offset:5120
  ds_read_b128 a[40:43], v160 offset:4096
  ds_read_b128 a[44:47], v160 offset:3072
  ds_read_b128 a[48:51], v160 offset:2048
  ds_read_b128 a[52:55], v160 offset:1024
  ds_read_b128 a[56:59], v160 offset:0
  s_waitcnt lgkmcnt(8)
  v_mfma_f32_32x32x16_bf16 v[40:55], a[24:27], a[16:19], v[104:119]
  s_waitcnt lgkmcnt(7)
  v_mfma_f32_32x32x16_bf16 v[56:71], a[28:31], a[16:19], 0
  s_waitcnt lgkmcnt(6)
  v_mfma_f32_32x32x16_bf16 v[72:87], a[32:35], a[16:19], 0
  s_nop 7
  v_max3_f32 v39, v40, v41, v42
  v_max_f32 v39, v39, v55
  v_max3_f32 v39, v39, v43, v44
  v_max3_f32 v39, v39, v45, v46
  v_max3_f32 v39, v39, v47, v48
  v_max3_f32 v39, v39, v49, v50
  v_max3_f32 v39, v39, v51, v52
  v_max3_f32 v39, v39, v53, v54
  s_waitcnt lgkmcnt(5)
  v_mfma_f32_32x32x16_bf16 v[40:55], a[36:39], a[16:19], 0
  v_max3_f32 v39, v39, v56, v57
  v_max3_f32 v39, v39, v58, v59
  v_max3_f32 v39, v39, v60, v61
  v_max3_f32 v39, v39, v62, v63
  v_max3_f32 v39, v39, v64, v65
  v_max3_f32 v39, v39, v66, v67
  v_max3_f32 v39, v39, v68, v69
  v_max3_f32 v39, v39, v70, v71
  s_waitcnt lgkmcnt(4)
  v_mfma_f32_32x32x16_bf16 v[56:71], a[40:43], a[16:19], 0
  v_max3_f32 v39, v39, v72, v73
  v_max3_f32 v39, v39, v74, v75
  v_max3_f32 v39, v39, v76, v77
  v_max3_f32 v39, v39, v78, v79
  v_max3_f32 v39, v39, v80, v81
  v_max3_f32 v39, v39, v82, v83
  v_max3_f32 v39, v39, v84, v85
  v_max3_f32 v39, v39, v86, v87
  s_waitcnt lgkmcnt(3)
  v_mfma_f32_32x32x16_bf16 v[72:87], a[44:47], a[16:19], 0
  v_max3_f32 v39, v39, v40, v41
  v_max3_f32 v39, v39, v42, v43
  v_max3_f32 v39, v39, v44, v45
  v_max3_f32 v39, v39, v46, v47
  v_max3_f32 v39, v39, v48, v49
  v_max3_f32 v39, v39, v50, v51
  v_max3_f32 v39, v39, v52, v53
  v_max3_f32 v39, v39, v54, v55
  s_waitcnt lgkmcnt(2)
  v_mfma_f32_32x32x16_bf16 v[40:55], a[48:51], a[16:19], 0
  v_max3_f32 v39, v39, v56, v57
  v_max3_f32 v39, v39, v58, v59
  v_max3_f32 v39, v39, v60, v61
  v_max3_f32 v39, v39, v62, v63
  v_max3_f32 v39, v39, v64, v65
  v_max3_f32 v39, v39, v66, v67
  v_max3_f32 v39, v39, v68, v69
  v_max3_f32 v39, v39, v70, v71
  s_waitcnt lgkmcnt(1)
  v_mfma_f32_32x32x16_bf16 v[56:71], a[52:55], a[16:19], 0
  v_max3_f32 v39, v39, v72, v73
  v_max3_f32 v39, v39, v74, v75
  v_max3_f32 v39, v39, v76, v77
  v_max3_f32 v39, v39, v78, v79
  v_max3_f32 v39, v39, v80, v81
  v_max3_f32 v39, v39, v82, v83
  v_max3_f32 v39, v39, v84, v85
  v_max3_f32 v39, v39, v86, v87
  s_barrier
  s_waitcnt lgkmcnt(0)
  v_mfma_f32_32x32x16_bf16 v[72:87], a[56:59], a[16:19], v[88:103]
  v_max3_f32 v39, v39, v40, v41
  v_max3_f32 v39, v39, v42, v43
  v_max3_f32 v39, v39, v44, v45
  v_max3_f32 v39, v39, v46, v47
  v_max3_f32 v39, v39, v48, v49
  v_max3_f32 v39, v39, v50, v51
  v_max3_f32 v39, v39, v52, v53
  v_max3_f32 v39, v39, v54, v55
  v_max3_f32 v39, v39, v56, v57
  v_max3_f32 v39, v39, v58, v59
  v_max3_f32 v39, v39, v60, v61
  v_max3_f32 v39, v39, v62, v63
  v_max3_f32 v39, v39, v64, v65
  v_max3_f32 v39, v39, v66, v67
  v_max3_f32 v39, v39, v68, v69
  v_max3_f32 v39, v39, v70, v71
  v_max3_f32 v39, v39, v72, v73
  v_max3_f32 v39, v39, v74, v75
  v_max3_f32 v39, v39, v76, v77
  v_max3_f32 v39, v39, v78, v79
  v_max3_f32 v39, v39, v80, v81
  v_max3_f32 v39, v39, v82, v83
  v_max3_f32 v39, v39, v84, v85
  v_max3_f32 v39, v39, v86, v87
  s_mov_b64 exec, s[34:35]
  ds_read_b128 a[60:63], v161 offset:8192
  ds_read_b128 a[64:67], v161 offset:8704
  s_mov_b64 exec, -1
  s_mov_b64 exec, s[34:35]
  ds_read_b128 a[68:71], v161 offset:7168
  ds_read_b128 a[72:75], v161 offset:7680
  s_mov_b64 exec, -1
  v_mov_b32 v153, v39
  s_nop 1
  v_permlane32_swap_b32 v153, v39
  v_max_f32 v39, v39, v153
  v_sub_f32 v153, 0, v39
  v_mov_b32 v120, v153
  v_mov_b32 v121, v153
  v_mov_b32 v122, v153
  v_mov_b32 v123, v153
  v_mov_b32 v124, v153
  v_mov_b32 v125, v153
  v_mov_b32 v126, v153
  v_mov_b32 v127, v153
  v_mov_b32 v128, v153
  v_mov_b32 v129, v153
  v_mov_b32 v130, v153
  v_mov_b32 v131, v153
  v_mov_b32 v132, v153
  v_mov_b32 v133, v153
  v_mov_b32 v134, v153
  v_mov_b32 v135, v153
  s_nop 1
  v_mfma_f32_32x32x16_bf16 v[40:55], a[24:27], a[16:19], v[120:135]
  v_mfma_f32_32x32x16_bf16 v[56:71], a[28:31], a[16:19], v[120:135]
  v_mfma_f32_32x32x16_bf16 v[72:87], a[32:35], a[16:19], v[120:135]
  s_nop 9
  v_add_f32 v40, v40, v104
  v_add_f32 v41, v41, v105
  v_add_f32 v42, v42, v106
  v_add_f32 v43, v43, v107
  v_add_f32 v44, v44, v108
  v_add_f32 v45, v45, v109
  v_add_f32 v46, v46, v110
  v_add_f32 v47, v47, v111
  v_exp_f32 v40, v40
  v_exp_f32 v41, v41
  v_exp_f32 v42, v42
  v_exp_f32 v43, v43
  s_barrier
  v_exp_f32 v44, v44
  v_exp_f32 v45, v45
  v_exp_f32 v46, v46
  v_exp_f32 v47, v47
  v_cvt_pk_bf16_f32 v136, v40, v41
  v_cvt_pk_bf16_f32 v137, v42, v43
  v_cvt_pk_bf16_f32 v138, v44, v45
  v_cvt_pk_bf16_f32 v139, v46, v47
  s_waitcnt lgkmcnt(2)
  s_nop 0
  v_mfma_f32_32x32x16_bf16 a[0:15], a[60:63], v[136:139], 0
  v_add_f32 v48, v48, v112
  v_add_f32 v49, v49, v113
  v_add_f32 v50, v50, v114
  v_add_f32 v51, v51, v115
  v_add_f32 v52, v52, v116
  v_add_f32 v53, v53, v117
  v_add_f32 v54, v54, v118
  v_add_f32 v55, v55, v119
  v_exp_f32 v48, v48
  v_exp_f32 v49, v49
  v_exp_f32 v50, v50
  v_exp_f32 v51, v51
  v_exp_f32 v52, v52
  v_exp_f32 v53, v53
  v_exp_f32 v54, v54
  v_exp_f32 v55, v55
  v_cvt_pk_bf16_f32 v140, v48, v49
  v_cvt_pk_bf16_f32 v141, v50, v51
  v_cvt_pk_bf16_f32 v142, v52, v53
  v_cvt_pk_bf16_f32 v143, v54, v55
  s_nop 1
  v_mfma_f32_32x32x16_bf16 a[0:15], a[64:67], v[140:143], a[0:15]
  s_mov_b64 exec, s[34:35]
  ds_read_b128 a[60:63], v161 offset:6144
  ds_read_b128 a[64:67], v161 offset:6656
  s_mov_b64 exec, -1
  v_mfma_f32_32x32x16_bf16 v[40:55], a[36:39], a[16:19], v[120:135]
  v_exp_f32 v56, v56
  v_exp_f32 v57, v57
  v_exp_f32 v58, v58
  v_exp_f32 v59, v59
  v_exp_f32 v60, v60
  v_exp_f32 v61, v61
  v_exp_f32 v62, v62
  v_exp_f32 v63, v63
  v_cvt_pk_bf16_f32 v136, v56, v57
  v_cvt_pk_bf16_f32 v137, v58, v59
  v_cvt_pk_bf16_f32 v138, v60, v61
  v_cvt_pk_bf16_f32 v139, v62, v63
  s_waitcnt lgkmcnt(2)
  s_nop 0
  v_mfma_f32_32x32x16_bf16 a[0:15], a[68:71], v[136:139], a[0:15]
  v_exp_f32 v64, v64
  v_exp_f32 v65, v65
  v_exp_f32 v66, v66
  v_exp_f32 v67, v67
  s_barrier
  v_exp_f32 v68, v68
  v_exp_f32 v69, v69
  v_exp_f32 v70, v70
  v_exp_f32 v71, v71
  v_cvt_pk_bf16_f32 v140, v64, v65
  v_cvt_pk_bf16_f32 v141, v66, v67
  v_cvt_pk_bf16_f32 v142, v68, v69
  v_cvt_pk_bf16_f32 v143, v70, v71
  s_nop 1
  v_mfma_f32_32x32x16_bf16 a[0:15], a[72:75], v[140:143], a[0:15]
  s_mov_b64 exec, s[34:35]
  ds_read_b128 a[68:71], v161 offset:5120
  ds_read_b128 a[72:75], v161 offset:5632
  s_mov_b64 exec, -1
  v_mfma_f32_32x32x16_bf16 v[56:71], a[40:43], a[16:19], v[120:135]
  v_exp_f32 v72, v72
  v_exp_f32 v73, v73
  v_exp_f32 v74, v74
  v_exp_f32 v75, v75
  v_exp_f32 v76, v76
  v_exp_f32 v77, v77
  v_exp_f32 v78, v78
  v_exp_f32 v79, v79
  v_cvt_pk_bf16_f32 v136, v72, v73
  v_cvt_pk_bf16_f32 v137, v74, v75
  v_cvt_pk_bf16_f32 v138, v76, v77
  v_cvt_pk_bf16_f32 v139, v78, v79
  s_waitcnt lgkmcnt(2)
  s_nop 0
  v_mfma_f32_32x32x16_bf16 a[0:15], a[60:63], v[136:139], a[0:15]
  v_exp_f32 v80, v80
  v_exp_f32 v81, v81
  v_exp_f32 v82, v82
  v_exp_f32 v83, v83
  v_exp_f32 v84, v84
  v_exp_f32 v85, v85
  v_exp_f32 v86, v86
  v_exp_f32 v87, v87
  v_cvt_pk_bf16_f32 v140, v80, v81
  v_cvt_pk_bf16_f32 v141, v82, v83
  v_cvt_pk_bf16_f32 v142, v84, v85
  v_cvt_pk_bf16_f32 v143, v86, v87
  s_nop 1
  v_mfma_f32_32x32x16_bf16 a[0:15], a[64:67], v[140:143], a[0:15]
  s_mov_b64 exec, s[34:35]
  ds_read_b128 a[60:63], v161 offset:4096
  ds_read_b128 a[64:67], v161 offset:4608
  s_mov_b64 exec, -1
  v_mfma_f32_32x32x16_bf16 v[72:87], a[44:47], a[16:19], v[120:135]
  v_exp_f32 v40, v40
  v_exp_f32 v41, v41
  v_exp_f32 v42, v42
  v_exp_f32 v43, v43
  s_barrier
  v_exp_f32 v44, v44
  v_exp_f32 v45, v45
  v_exp_f32 v46, v46
  v_exp_f32 v47, v47
  v_cvt_pk_bf16_f32 v136, v40, v41
  v_cvt_pk_bf16_f32 v137, v42, v43
  v_cvt_pk_bf16_f32 v138, v44, v45
  v_cvt_pk_bf16_f32 v139, v46, v47
  s_waitcnt lgkmcnt(2)
  s_nop 0
  v_mfma_f32_32x32x16_bf16 a[0:15], a[68:71], v[136:139], a[0:15]
  v_exp_f32 v48, v48
  v_exp_f32 v49, v49
  v_exp_f32 v50, v50
  v_exp_f32 v51, v51
  v_exp_f32 v52, v52
  v_exp_f32 v53, v53
  v_exp_f32 v54, v54
  v_exp_f32 v55, v55
  v_cvt_pk_bf16_f32 v140, v48, v49
  v_cvt_pk_bf16_f32 v141, v50, v51
  v_cvt_pk_bf16_f32 v142, v52, v53
  v_cvt_pk_bf16_f32 v143, v54, v55
  s_nop 1
  v_mfma_f32_32x32x16_bf16 a[0:15], a[72:75], v[140:143], a[0:15]
  s_mov_b64 exec, s[34:35]
  ds_read_b128 a[68:71], v161 offset:3072
  ds_read_b128 a[72:75], v161 offset:3584
  s_mov_b64 exec, -1
  v_mfma_f32_32x32x16_bf16 v[40:55], a[48:51], a[16:19], v[120:135]
  v_exp_f32 v56, v56
  v_exp_f32 v57, v57
  v_exp_f32 v58, v58
  v_exp_f32 v59, v59
  v_exp_f32 v60, v60
  v_exp_f32 v61, v61
  v_exp_f32 v62, v62
  v_exp_f32 v63, v63
  v_cvt_pk_bf16_f32 v136, v56, v57
  v_cvt_pk_bf16_f32 v137, v58, v59
  v_cvt_pk_bf16_f32 v138, v60, v61
  v_cvt_pk_bf16_f32 v139, v62, v63
  s_waitcnt lgkmcnt(2)
  s_nop 0
  v_mfma_f32_32x32x16_bf16 a[0:15], a[60:63], v[136:139], a[0:15]
  v_exp_f32 v64, v64
  v_exp_f32 v65, v65
  v_exp_f32 v66, v66
  v_exp_f32 v67, v67
  v_exp_f32 v68, v68
  v_exp_f32 v69, v69
  v_exp_f32 v70, v70
  v_exp_f32 v71, v71
  s_barrier
  v_cvt_pk_bf16_f32 v140, v64, v65
  v_cvt_pk_bf16_f32 v141, v66, v67
  v_cvt_pk_bf16_f32 v142, v68, v69
  v_cvt_pk_bf16_f32 v143, v70, v71
  s_nop 1
  v_mfma_f32_32x32x16_bf16 a[0:15], a[64:67], v[140:143], a[0:15]
  s_mov_b64 exec, s[34:35]
  ds_read_b128 a[60:63], v161 offset:2048
  ds_read_b128 a[64:67], v161 offset:2560
  s_mov_b64 exec, -1
  v_mfma_f32_32x32x16_bf16 v[56:71], a[52:55], a[16:19], v[120:135]
  v_exp_f32 v72, v72
  v_exp_f32 v73, v73
  v_exp_f32 v74, v74
  v_exp_f32 v75, v75
  v_exp_f32 v76, v76
  v_exp_f32 v77, v77
  v_exp_f32 v78, v78
  v_exp_f32 v79, v79
  v_cvt_pk_bf16_f32 v136, v72, v73
  v_cvt_pk_bf16_f32 v137, v74, v75
  v_cvt_pk_bf16_f32 v138, v76, v77
  v_cvt_pk_bf16_f32 v139, v78, v79
  s_waitcnt lgkmcnt(2)
  s_nop 0
  v_mfma_f32_32x32x16_bf16 a[0:15], a[68:71], v[136:139], a[0:15]
  v_exp_f32 v80, v80
  v_exp_f32 v81, v81
  v_exp_f32 v82, v82
  v_exp_f32 v83, v83
  v_exp_f32 v84, v84
  v_exp_f32 v85, v85
  v_exp_f32 v86, v86
  v_exp_f32 v87, v87
  v_cvt_pk_bf16_f32 v140, v80, v81
  v_cvt_pk_bf16_f32 v141, v82, v83
  v_cvt_pk_bf16_f32 v142, v84, v85
  v_cvt_pk_bf16_f32 v143, v86, v87
  s_nop 1
  v_mfma_f32_32x32x16_bf16 a[0:15], a[72:75], v[140:143], a[0:15]
  s_mov_b64 exec, s[34:35]
  ds_read_b128 a[68:71], v161 offset:1024
  ds_read_b128 a[72:75], v161 offset:1536
  s_mov_b64 exec, -1
  v_mfma_f32_32x32x16_bf16 v[72:87], a[56:59], a[16:19], v[120:135]
  v_exp_f32 v40, v40
  v_exp_f32 v41, v41
  v_exp_f32 v42, v42
  v_exp_f32 v43, v43
  v_exp_f32 v44, v44
  v_exp_f32 v45, v45
  v_exp_f32 v46, v46
  v_exp_f32 v47, v47
  s_barrier
  v_cvt_pk_bf16_f32 v136, v40, v41
  v_cvt_pk_bf16_f32 v137, v42, v43
  v_cvt_pk_bf16_f32 v138, v44, v45
  v_cvt_pk_bf16_f32 v139, v46, v47
  s_waitcnt lgkmcnt(2)
  s_nop 0
  v_mfma_f32_32x32x16_bf16 a[0:15], a[60:63], v[136:139], a[0:15]
  v_exp_f32 v48, v48
  v_exp_f32 v49, v49
  v_exp_f32 v50, v50
  v_exp_f32 v51, v51
  v_exp_f32 v52, v52
  v_exp_f32 v53, v53
  v_exp_f32 v54, v54
  v_exp_f32 v55, v55
  v_cvt_pk_bf16_f32 v140, v48, v49
  v_cvt_pk_bf16_f32 v141, v50, v51
  v_cvt_pk_bf16_f32 v142, v52, v53
  v_cvt_pk_bf16_f32 v143, v54, v55
  s_nop 1
  v_mfma_f32_32x32x16_bf16 a[0:15], a[64:67], v[140:143], a[0:15]
  s_mov_b64 exec, s[34:35]
  ds_read_b128 a[60:63], v161 offset:0
  ds_read_b128 a[64:67], v161 offset:512
  s_mov_b64 exec, -1
  v_exp_f32 v56, v56
  v_exp_f32 v57, v57
  v_exp_f32 v58, v58
  v_exp_f32 v59, v59
  v_exp_f32 v60, v60
  v_exp_f32 v61, v61
  v_exp_f32 v62, v62
  v_exp_f32 v63, v63
  v_cvt_pk_bf16_f32 v136, v56, v57
  v_cvt_pk_bf16_f32 v137, v58, v59
  v_cvt_pk_bf16_f32 v138, v60, v61
  v_cvt_pk_bf16_f32 v139, v62, v63
  s_waitcnt lgkmcnt(2)
  s_nop 0
  v_mfma_f32_32x32x16_bf16 a[0:15], a[68:71], v[136:139], a[0:15]
  v_exp_f32 v64, v64
  v_exp_f32 v65, v65
  v_exp_f32 v66, v66
  v_exp_f32 v67, v67
  v_exp_f32 v68, v68
  v_exp_f32 v69, v69
  v_exp_f32 v70, v70
  v_exp_f32 v71, v71
  v_cvt_pk_bf16_f32 v140, v64, v65
  v_cvt_pk_bf16_f32 v141, v66, v67
  v_cvt_pk_bf16_f32 v142, v68, v69
  v_cvt_pk_bf16_f32 v143, v70, v71
  s_nop 1
  v_mfma_f32_32x32x16_bf16 a[0:15], a[72:75], v[140:143], a[0:15]
  v_add_f32 v72, v72, v88
  v_add_f32 v73, v73, v89
  v_add_f32 v74, v74, v90
  v_add_f32 v75, v75, v91
  v_add_f32 v76, v76, v92
  v_add_f32 v77, v77, v93
  v_add_f32 v78, v78, v94
  v_add_f32 v79, v79, v95
  s_barrier
  v_exp_f32 v72, v72
  v_exp_f32 v73, v73
  v_exp_f32 v74, v74
  v_exp_f32 v75, v75
  v_exp_f32 v76, v76
  v_exp_f32 v77, v77
  v_exp_f32 v78, v78
  v_exp_f32 v79, v79
  v_cvt_pk_bf16_f32 v136, v72, v73
  v_cvt_pk_bf16_f32 v137, v74, v75
  v_cvt_pk_bf16_f32 v138, v76, v77
  v_cvt_pk_bf16_f32 v139, v78, v79
  s_waitcnt lgkmcnt(0)
  s_nop 0
  v_mfma_f32_32x32x16_bf16 a[0:15], a[60:63], v[136:139], a[0:15]
  v_add_f32 v80, v80, v96
  v_add_f32 v81, v81, v97
  v_add_f32 v82, v82, v98
  v_add_f32 v83, v83, v99
  v_add_f32 v84, v84, v100
  v_add_f32 v85, v85, v101
  v_add_f32 v86, v86, v102
  v_add_f32 v87, v87, v103
  v_exp_f32 v80, v80
  v_exp_f32 v81, v81
  v_exp_f32 v82, v82
  v_exp_f32 v83, v83
  v_exp_f32 v84, v84
  v_exp_f32 v85, v85
  v_exp_f32 v86, v86
  v_exp_f32 v87, v87
  v_cvt_pk_bf16_f32 v140, v80, v81
  v_cvt_pk_bf16_f32 v141, v82, v83
  v_cvt_pk_bf16_f32 v142, v84, v85
  v_cvt_pk_bf16_f32 v143, v86, v87
  s_nop 1
  v_mfma_f32_32x32x16_bf16 a[0:15], a[64:67], v[140:143], a[0:15]
  s_nop 11
  v_accvgpr_read_b32 v144, a0
  v_accvgpr_read_b32 v145, a1
  v_accvgpr_read_b32 v146, a2
  v_accvgpr_read_b32 v147, a3
  v_accvgpr_read_b32 v148, a4
  v_accvgpr_read_b32 v149, a5
  v_accvgpr_read_b32 v150, a6
  v_accvgpr_read_b32 v151, a7
  v_accvgpr_read_b32 v152, a8
  v_rcp_f32 v153, v152
  s_nop 0
  v_mul_f32 v144, v144, v153
  v_mul_f32 v145, v145, v153
  v_mul_f32 v146, v146, v153
  v_mul_f32 v147, v147, v153
  v_mul_f32 v148, v148, v153
  v_mul_f32 v149, v149, v153
  v_mul_f32 v150, v150, v153
  v_mul_f32 v151, v151, v153
  v_cvt_pk_bf16_f32 v156, v144, v145
  v_cvt_pk_bf16_f32 v157, v146, v147
  v_cvt_pk_bf16_f32 v158, v148, v149
  v_cvt_pk_bf16_f32 v159, v150, v151
  s_nop 0
  v_permlane32_swap_b32 v156, v158
  v_permlane32_swap_b32 v157, v159
  s_add_u32 s6, s32, 15728640
  buffer_store_dwordx4 v[156:159], v162, s[56:59], s6 offen sc1
  s_barrier
  ds_read_b128 a[24:27], v160 offset:12288
  ds_read_b128 a[28:31], v160 offset:11264
  ds_read_b128 a[32:35], v160 offset:10240
  ds_read_b128 a[36:39], v160 offset:9216
  ds_read_b128 a[40:43], v160 offset:8192
  ds_read_b128 a[44:47], v160 offset:7168
  ds_read_b128 a[48:51], v160 offset:6144
  ds_read_b128 a[52:55], v160 offset:5120
  ds_read_b128 a[56:59], v160 offset:4096
  s_waitcnt lgkmcnt(8)
  v_mfma_f32_32x32x16_bf16 v[40:55], a[24:27], a[20:23], v[104:119]
  s_waitcnt lgkmcnt(7)
  v_mfma_f32_32x32x16_bf16 v[56:71], a[28:31], a[20:23], 0
  s_waitcnt lgkmcnt(6)
  v_mfma_f32_32x32x16_bf16 v[72:87], a[32:35], a[20:23], 0
  s_nop 7
  v_max3_f32 v39, v40, v41, v42
  v_max_f32 v39, v39, v55
  v_max3_f32 v39, v39, v43, v44
  v_max3_f32 v39, v39, v45, v46
  v_max3_f32 v39, v39, v47, v48
  v_max3_f32 v39, v39, v49, v50
  v_max3_f32 v39, v39, v51, v52
  v_max3_f32 v39, v39, v53, v54
  s_waitcnt lgkmcnt(5)
  v_mfma_f32_32x32x16_bf16 v[40:55], a[36:39], a[20:23], 0
  v_max3_f32 v39, v39, v56, v57
  v_max3_f32 v39, v39, v58, v59
  v_max3_f32 v39, v39, v60, v61
  v_max3_f32 v39, v39, v62, v63
  v_max3_f32 v39, v39, v64, v65
  v_max3_f32 v39, v39, v66, v67
  v_max3_f32 v39, v39, v68, v69
  v_max3_f32 v39, v39, v70, v71
  s_waitcnt lgkmcnt(4)
  v_mfma_f32_32x32x16_bf16 v[56:71], a[40:43], a[20:23], 0
  v_max3_f32 v39, v39, v72, v73
  v_max3_f32 v39, v39, v74, v75
  v_max3_f32 v39, v39, v76, v77
  v_max3_f32 v39, v39, v78, v79
  v_max3_f32 v39, v39, v80, v81
  v_max3_f32 v39, v39, v82, v83
  v_max3_f32 v39, v39, v84, v85
  v_max3_f32 v39, v39, v86, v87
  s_waitcnt lgkmcnt(3)
  v_mfma_f32_32x32x16_bf16 v[72:87], a[44:47], a[20:23], 0
  v_max3_f32 v39, v39, v40, v41
  v_max3_f32 v39, v39, v42, v43
  v_max3_f32 v39, v39, v44, v45
  v_max3_f32 v39, v39, v46, v47
  v_max3_f32 v39, v39, v48, v49
  v_max3_f32 v39, v39, v50, v51
  v_max3_f32 v39, v39, v52, v53
  v_max3_f32 v39, v39, v54, v55
  s_waitcnt lgkmcnt(2)
  v_mfma_f32_32x32x16_bf16 v[40:55], a[48:51], a[20:23], 0
  v_max3_f32 v39, v39, v56, v57
  v_max3_f32 v39, v39, v58, v59
  v_max3_f32 v39, v39, v60, v61
  v_max3_f32 v39, v39, v62, v63
  v_max3_f32 v39, v39, v64, v65
  v_max3_f32 v39, v39, v66, v67
  v_max3_f32 v39, v39, v68, v69
  v_max3_f32 v39, v39, v70, v71
  s_waitcnt lgkmcnt(1)
  v_mfma_f32_32x32x16_bf16 v[56:71], a[52:55], a[20:23], 0
  v_max3_f32 v39, v39, v72, v73
  v_max3_f32 v39, v39, v74, v75
  v_max3_f32 v39, v39, v76, v77
  v_max3_f32 v39, v39, v78, v79
  v_max3_f32 v39, v39, v80, v81
  v_max3_f32 v39, v39, v82, v83
  v_max3_f32 v39, v39, v84, v85
  v_max3_f32 v39, v39, v86, v87
  s_barrier
  s_waitcnt lgkmcnt(0)
  v_mfma_f32_32x32x16_bf16 v[72:87], a[56:59], a[20:23], v[88:103]
  v_max3_f32 v39, v39, v40, v41
  v_max3_f32 v39, v39, v42, v43
  v_max3_f32 v39, v39, v44, v45
  v_max3_f32 v39, v39, v46, v47
  v_max3_f32 v39, v39, v48, v49
  v_max3_f32 v39, v39, v50, v51
  v_max3_f32 v39, v39, v52, v53
  v_max3_f32 v39, v39, v54, v55
  v_max3_f32 v39, v39, v56, v57
  v_max3_f32 v39, v39, v58, v59
  v_max3_f32 v39, v39, v60, v61
  v_max3_f32 v39, v39, v62, v63
  v_max3_f32 v39, v39, v64, v65
  v_max3_f32 v39, v39, v66, v67
  v_max3_f32 v39, v39, v68, v69
  v_max3_f32 v39, v39, v70, v71
  v_max3_f32 v39, v39, v72, v73
  v_max3_f32 v39, v39, v74, v75
  v_max3_f32 v39, v39, v76, v77
  v_max3_f32 v39, v39, v78, v79
  v_max3_f32 v39, v39, v80, v81
  v_max3_f32 v39, v39, v82, v83
  v_max3_f32 v39, v39, v84, v85
  v_max3_f32 v39, v39, v86, v87
  s_mov_b64 exec, s[34:35]
  ds_read_b128 a[60:63], v161 offset:12288
  ds_read_b128 a[64:67], v161 offset:12800
  s_mov_b64 exec, -1
  s_mov_b64 exec, s[34:35]
  ds_read_b128 a[68:71], v161 offset:11264
  ds_read_b128 a[72:75], v161 offset:11776
  s_mov_b64 exec, -1
  v_mov_b32 v153, v39
  s_nop 1
  v_permlane32_swap_b32 v153, v39
  v_max_f32 v39, v39, v153
  v_sub_f32 v153, 0, v39
  v_mov_b32 v120, v153
  v_mov_b32 v121, v153
  v_mov_b32 v122, v153
  v_mov_b32 v123, v153
  v_mov_b32 v124, v153
  v_mov_b32 v125, v153
  v_mov_b32 v126, v153
  v_mov_b32 v127, v153
  v_mov_b32 v128, v153
  v_mov_b32 v129, v153
  v_mov_b32 v130, v153
  v_mov_b32 v131, v153
  v_mov_b32 v132, v153
  v_mov_b32 v133, v153
  v_mov_b32 v134, v153
  v_mov_b32 v135, v153
  s_nop 1
  v_mfma_f32_32x32x16_bf16 v[40:55], a[24:27], a[20:23], v[120:135]
  v_mfma_f32_32x32x16_bf16 v[56:71], a[28:31], a[20:23], v[120:135]
  v_mfma_f32_32x32x16_bf16 v[72:87], a[32:35], a[20:23], v[120:135]
  s_nop 9
  v_add_f32 v40, v40, v104
  v_add_f32 v41, v41, v105
  v_add_f32 v42, v42, v106
  v_add_f32 v43, v43, v107
  v_add_f32 v44, v44, v108
  v_add_f32 v45, v45, v109
  v_add_f32 v46, v46, v110
  v_add_f32 v47, v47, v111
  v_exp_f32 v40, v40
  v_exp_f32 v41, v41
  v_exp_f32 v42, v42
  v_exp_f32 v43, v43
  s_barrier
  v_exp_f32 v44, v44
  v_exp_f32 v45, v45
  v_exp_f32 v46, v46
  v_exp_f32 v47, v47
  v_cvt_pk_bf16_f32 v136, v40, v41
  v_cvt_pk_bf16_f32 v137, v42, v43
  v_cvt_pk_bf16_f32 v138, v44, v45
  v_cvt_pk_bf16_f32 v139, v46, v47
  s_waitcnt lgkmcnt(2)
  s_nop 0
  v_mfma_f32_32x32x16_bf16 a[0:15], a[60:63], v[136:139], 0
  v_add_f32 v48, v48, v112
  v_add_f32 v49, v49, v113
  v_add_f32 v50, v50, v114
  v_add_f32 v51, v51, v115
  v_add_f32 v52, v52, v116
  v_add_f32 v53, v53, v117
  v_add_f32 v54, v54, v118
  v_add_f32 v55, v55, v119
  v_exp_f32 v48, v48
  v_exp_f32 v49, v49
  v_exp_f32 v50, v50
  v_exp_f32 v51, v51
  v_exp_f32 v52, v52
  v_exp_f32 v53, v53
  v_exp_f32 v54, v54
  v_exp_f32 v55, v55
  v_cvt_pk_bf16_f32 v140, v48, v49
  v_cvt_pk_bf16_f32 v141, v50, v51
  v_cvt_pk_bf16_f32 v142, v52, v53
  v_cvt_pk_bf16_f32 v143, v54, v55
  s_nop 1
  v_mfma_f32_32x32x16_bf16 a[0:15], a[64:67], v[140:143], a[0:15]
  s_mov_b64 exec, s[34:35]
  ds_read_b128 a[60:63], v161 offset:10240
  ds_read_b128 a[64:67], v161 offset:10752
  s_mov_b64 exec, -1
  v_mfma_f32_32x32x16_bf16 v[40:55], a[36:39], a[20:23], v[120:135]
  v_exp_f32 v56, v56
  v_exp_f32 v57, v57
  v_exp_f32 v58, v58
  v_exp_f32 v59, v59
  v_exp_f32 v60, v60
  v_exp_f32 v61, v61
  v_exp_f32 v62, v62
  v_exp_f32 v63, v63
  v_cvt_pk_bf16_f32 v136, v56, v57
  v_cvt_pk_bf16_f32 v137, v58, v59
  v_cvt_pk_bf16_f32 v138, v60, v61
  v_cvt_pk_bf16_f32 v139, v62, v63
  s_waitcnt lgkmcnt(2)
  s_nop 0
  v_mfma_f32_32x32x16_bf16 a[0:15], a[68:71], v[136:139], a[0:15]
  v_exp_f32 v64, v64
  v_exp_f32 v65, v65
  v_exp_f32 v66, v66
  v_exp_f32 v67, v67
  s_barrier
  v_exp_f32 v68, v68
  v_exp_f32 v69, v69
  v_exp_f32 v70, v70
  v_exp_f32 v71, v71
  v_cvt_pk_bf16_f32 v140, v64, v65
  v_cvt_pk_bf16_f32 v141, v66, v67
  v_cvt_pk_bf16_f32 v142, v68, v69
  v_cvt_pk_bf16_f32 v143, v70, v71
  s_nop 1
  v_mfma_f32_32x32x16_bf16 a[0:15], a[72:75], v[140:143], a[0:15]
  s_mov_b64 exec, s[34:35]
  ds_read_b128 a[68:71], v161 offset:9216
  ds_read_b128 a[72:75], v161 offset:9728
  s_mov_b64 exec, -1
  v_mfma_f32_32x32x16_bf16 v[56:71], a[40:43], a[20:23], v[120:135]
  v_exp_f32 v72, v72
  v_exp_f32 v73, v73
  v_exp_f32 v74, v74
  v_exp_f32 v75, v75
  v_exp_f32 v76, v76
  v_exp_f32 v77, v77
  v_exp_f32 v78, v78
  v_exp_f32 v79, v79
  v_cvt_pk_bf16_f32 v136, v72, v73
  v_cvt_pk_bf16_f32 v137, v74, v75
  v_cvt_pk_bf16_f32 v138, v76, v77
  v_cvt_pk_bf16_f32 v139, v78, v79
  s_waitcnt lgkmcnt(2)
  s_nop 0
  v_mfma_f32_32x32x16_bf16 a[0:15], a[60:63], v[136:139], a[0:15]
  v_exp_f32 v80, v80
  v_exp_f32 v81, v81
  v_exp_f32 v82, v82
  v_exp_f32 v83, v83
  v_exp_f32 v84, v84
  v_exp_f32 v85, v85
  v_exp_f32 v86, v86
  v_exp_f32 v87, v87
  v_cvt_pk_bf16_f32 v140, v80, v81
  v_cvt_pk_bf16_f32 v141, v82, v83
  v_cvt_pk_bf16_f32 v142, v84, v85
  v_cvt_pk_bf16_f32 v143, v86, v87
  s_nop 1
  v_mfma_f32_32x32x16_bf16 a[0:15], a[64:67], v[140:143], a[0:15]
  s_mov_b64 exec, s[34:35]
  ds_read_b128 a[60:63], v161 offset:8192
  ds_read_b128 a[64:67], v161 offset:8704
  s_mov_b64 exec, -1
  v_mfma_f32_32x32x16_bf16 v[72:87], a[44:47], a[20:23], v[120:135]
  v_exp_f32 v40, v40
  v_exp_f32 v41, v41
  v_exp_f32 v42, v42
  v_exp_f32 v43, v43
  s_barrier
  v_exp_f32 v44, v44
  v_exp_f32 v45, v45
  v_exp_f32 v46, v46
  v_exp_f32 v47, v47
  v_cvt_pk_bf16_f32 v136, v40, v41
  v_cvt_pk_bf16_f32 v137, v42, v43
  v_cvt_pk_bf16_f32 v138, v44, v45
  v_cvt_pk_bf16_f32 v139, v46, v47
  s_waitcnt lgkmcnt(2)
  s_nop 0
  v_mfma_f32_32x32x16_bf16 a[0:15], a[68:71], v[136:139], a[0:15]
  v_exp_f32 v48, v48
  v_exp_f32 v49, v49
  v_exp_f32 v50, v50
  v_exp_f32 v51, v51
  v_exp_f32 v52, v52
  v_exp_f32 v53, v53
  v_exp_f32 v54, v54
  v_exp_f32 v55, v55
  v_cvt_pk_bf16_f32 v140, v48, v49
  v_cvt_pk_bf16_f32 v141, v50, v51
  v_cvt_pk_bf16_f32 v142, v52, v53
  v_cvt_pk_bf16_f32 v143, v54, v55
  s_nop 1
  v_mfma_f32_32x32x16_bf16 a[0:15], a[72:75], v[140:143], a[0:15]
  s_mov_b64 exec, s[34:35]
  ds_read_b128 a[68:71], v161 offset:7168
  ds_read_b128 a[72:75], v161 offset:7680
  s_mov_b64 exec, -1
  v_mfma_f32_32x32x16_bf16 v[40:55], a[48:51], a[20:23], v[120:135]
  v_exp_f32 v56, v56
  v_exp_f32 v57, v57
  v_exp_f32 v58, v58
  v_exp_f32 v59, v59
  v_exp_f32 v60, v60
  v_exp_f32 v61, v61
  v_exp_f32 v62, v62
  v_exp_f32 v63, v63
  v_cvt_pk_bf16_f32 v136, v56, v57
  v_cvt_pk_bf16_f32 v137, v58, v59
  v_cvt_pk_bf16_f32 v138, v60, v61
  v_cvt_pk_bf16_f32 v139, v62, v63
  s_waitcnt lgkmcnt(2)
  s_nop 0
  v_mfma_f32_32x32x16_bf16 a[0:15], a[60:63], v[136:139], a[0:15]
  v_exp_f32 v64, v64
  v_exp_f32 v65, v65
  v_exp_f32 v66, v66
  v_exp_f32 v67, v67
  v_exp_f32 v68, v68
  v_exp_f32 v69, v69
  v_exp_f32 v70, v70
  v_exp_f32 v71, v71
  s_barrier
  v_cvt_pk_bf16_f32 v140, v64, v65
  v_cvt_pk_bf16_f32 v141, v66, v67
  v_cvt_pk_bf16_f32 v142, v68, v69
  v_cvt_pk_bf16_f32 v143, v70, v71
  s_nop 1
  v_mfma_f32_32x32x16_bf16 a[0:15], a[64:67], v[140:143], a[0:15]
  s_mov_b64 exec, s[34:35]
  ds_read_b128 a[60:63], v161 offset:6144
  ds_read_b128 a[64:67], v161 offset:6656
  s_mov_b64 exec, -1
  v_mfma_f32_32x32x16_bf16 v[56:71], a[52:55], a[20:23], v[120:135]
  v_exp_f32 v72, v72
  v_exp_f32 v73, v73
  v_exp_f32 v74, v74
  v_exp_f32 v75, v75
  v_exp_f32 v76, v76
  v_exp_f32 v77, v77
  v_exp_f32 v78, v78
  v_exp_f32 v79, v79
  v_cvt_pk_bf16_f32 v136, v72, v73
  v_cvt_pk_bf16_f32 v137, v74, v75
  v_cvt_pk_bf16_f32 v138, v76, v77
  v_cvt_pk_bf16_f32 v139, v78, v79
  s_waitcnt lgkmcnt(2)
  s_nop 0
  v_mfma_f32_32x32x16_bf16 a[0:15], a[68:71], v[136:139], a[0:15]
  v_exp_f32 v80, v80
  v_exp_f32 v81, v81
  v_exp_f32 v82, v82
  v_exp_f32 v83, v83
  v_exp_f32 v84, v84
  v_exp_f32 v85, v85
  v_exp_f32 v86, v86
  v_exp_f32 v87, v87
  v_cvt_pk_bf16_f32 v140, v80, v81
  v_cvt_pk_bf16_f32 v141, v82, v83
  v_cvt_pk_bf16_f32 v142, v84, v85
  v_cvt_pk_bf16_f32 v143, v86, v87
  s_nop 1
  v_mfma_f32_32x32x16_bf16 a[0:15], a[72:75], v[140:143], a[0:15]
  s_mov_b64 exec, s[34:35]
  ds_read_b128 a[68:71], v161 offset:5120
  ds_read_b128 a[72:75], v161 offset:5632
  s_mov_b64 exec, -1
  v_mfma_f32_32x32x16_bf16 v[72:87], a[56:59], a[20:23], v[120:135]
  v_exp_f32 v40, v40
  v_exp_f32 v41, v41
  v_exp_f32 v42, v42
  v_exp_f32 v43, v43
  v_exp_f32 v44, v44
  v_exp_f32 v45, v45
  v_exp_f32 v46, v46
  v_exp_f32 v47, v47
  s_barrier
  v_cvt_pk_bf16_f32 v136, v40, v41
  v_cvt_pk_bf16_f32 v137, v42, v43
  v_cvt_pk_bf16_f32 v138, v44, v45
  v_cvt_pk_bf16_f32 v139, v46, v47
  s_waitcnt lgkmcnt(2)
  s_nop 0
  v_mfma_f32_32x32x16_bf16 a[0:15], a[60:63], v[136:139], a[0:15]
  v_exp_f32 v48, v48
  v_exp_f32 v49, v49
  v_exp_f32 v50, v50
  v_exp_f32 v51, v51
  v_exp_f32 v52, v52
  v_exp_f32 v53, v53
  v_exp_f32 v54, v54
  v_exp_f32 v55, v55
  v_cvt_pk_bf16_f32 v140, v48, v49
  v_cvt_pk_bf16_f32 v141, v50, v51
  v_cvt_pk_bf16_f32 v142, v52, v53
  v_cvt_pk_bf16_f32 v143, v54, v55
  s_nop 1
  v_mfma_f32_32x32x16_bf16 a[0:15], a[64:67], v[140:143], a[0:15]
  s_mov_b64 exec, s[34:35]
  ds_read_b128 a[60:63], v161 offset:4096
  ds_read_b128 a[64:67], v161 offset:4608
  s_mov_b64 exec, -1
  v_exp_f32 v56, v56
  v_exp_f32 v57, v57
  v_exp_f32 v58, v58
  v_exp_f32 v59, v59
  v_exp_f32 v60, v60
  v_exp_f32 v61, v61
  v_exp_f32 v62, v62
  v_exp_f32 v63, v63
  v_cvt_pk_bf16_f32 v136, v56, v57
  v_cvt_pk_bf16_f32 v137, v58, v59
  v_cvt_pk_bf16_f32 v138, v60, v61
  v_cvt_pk_bf16_f32 v139, v62, v63
  s_waitcnt lgkmcnt(2)
  s_nop 0
  v_mfma_f32_32x32x16_bf16 a[0:15], a[68:71], v[136:139], a[0:15]
  v_exp_f32 v64, v64
  v_exp_f32 v65, v65
  v_exp_f32 v66, v66
  v_exp_f32 v67, v67
  v_exp_f32 v68, v68
  v_exp_f32 v69, v69
  v_exp_f32 v70, v70
  v_exp_f32 v71, v71
  v_cvt_pk_bf16_f32 v140, v64, v65
  v_cvt_pk_bf16_f32 v141, v66, v67
  v_cvt_pk_bf16_f32 v142, v68, v69
  v_cvt_pk_bf16_f32 v143, v70, v71
  s_nop 1
  v_mfma_f32_32x32x16_bf16 a[0:15], a[72:75], v[140:143], a[0:15]
  v_add_f32 v72, v72, v88
  v_add_f32 v73, v73, v89
  v_add_f32 v74, v74, v90
  v_add_f32 v75, v75, v91
  v_add_f32 v76, v76, v92
  v_add_f32 v77, v77, v93
  v_add_f32 v78, v78, v94
  v_add_f32 v79, v79, v95
  s_barrier
  v_exp_f32 v72, v72
  v_exp_f32 v73, v73
  v_exp_f32 v74, v74
  v_exp_f32 v75, v75
  v_exp_f32 v76, v76
  v_exp_f32 v77, v77
  v_exp_f32 v78, v78
  v_exp_f32 v79, v79
  v_cvt_pk_bf16_f32 v136, v72, v73
  v_cvt_pk_bf16_f32 v137, v74, v75
  v_cvt_pk_bf16_f32 v138, v76, v77
  v_cvt_pk_bf16_f32 v139, v78, v79
  s_waitcnt lgkmcnt(0)
  s_nop 0
  v_mfma_f32_32x32x16_bf16 a[0:15], a[60:63], v[136:139], a[0:15]
  v_add_f32 v80, v80, v96
  v_add_f32 v81, v81, v97
  v_add_f32 v82, v82, v98
  v_add_f32 v83, v83, v99
  v_add_f32 v84, v84, v100
  v_add_f32 v85, v85, v101
  v_add_f32 v86, v86, v102
  v_add_f32 v87, v87, v103
  v_exp_f32 v80, v80
  v_exp_f32 v81, v81
  v_exp_f32 v82, v82
  v_exp_f32 v83, v83
  v_exp_f32 v84, v84
  v_exp_f32 v85, v85
  v_exp_f32 v86, v86
  v_exp_f32 v87, v87
  v_cvt_pk_bf16_f32 v140, v80, v81
  v_cvt_pk_bf16_f32 v141, v82, v83
  v_cvt_pk_bf16_f32 v142, v84, v85
  v_cvt_pk_bf16_f32 v143, v86, v87
  s_nop 1
  v_mfma_f32_32x32x16_bf16 a[0:15], a[64:67], v[140:143], a[0:15]
  s_nop 11
  v_accvgpr_read_b32 v144, a0
  v_accvgpr_read_b32 v145, a1
  v_accvgpr_read_b32 v146, a2
  v_accvgpr_read_b32 v147, a3
  v_accvgpr_read_b32 v148, a4
  v_accvgpr_read_b32 v149, a5
  v_accvgpr_read_b32 v150, a6
  v_accvgpr_read_b32 v151, a7
  v_accvgpr_read_b32 v152, a8
  v_rcp_f32 v153, v152
  s_nop 0
  v_mul_f32 v144, v144, v153
  v_mul_f32 v145, v145, v153
  v_mul_f32 v146, v146, v153
  v_mul_f32 v147, v147, v153
  v_mul_f32 v148, v148, v153
  v_mul_f32 v149, v149, v153
  v_mul_f32 v150, v150, v153
  v_mul_f32 v151, v151, v153
  v_cvt_pk_bf16_f32 v156, v144, v145
  v_cvt_pk_bf16_f32 v157, v146, v147
  v_cvt_pk_bf16_f32 v158, v148, v149
  v_cvt_pk_bf16_f32 v159, v150, v151
  s_nop 0
  v_permlane32_swap_b32 v156, v158
  v_permlane32_swap_b32 v157, v159
  s_add_u32 s6, s32, 15732736
  buffer_store_dwordx4 v[156:159], v162, s[56:59], s6 offen sc1
  s_barrier
L_att_join:
  s_waitcnt vmcnt(0)
  s_barrier
  s_barrier
  s_barrier
  s_barrier
  s_barrier
  s_add_u32 m0, s5, 122880
  s_lshl_b32 s68, s16, 16
  s_add_u32 s68, s68, s25
  buffer_load_dwordx4 v37, s[60:63], s68 offen lds
  buffer_load_dwordx4 v38, s[60:63], s68 offen offset:1024 lds
  s_add_u32 s16, s16, 1
  s_and_b32 s16, s16, 7
  s_add_u32 m0, s5, 131072
  s_lshl_b32 s68, s16, 16
  s_add_u32 s68, s68, s25
  buffer_load_dwordx4 v37, s[60:63], s68 offen lds
  buffer_load_dwordx4 v38, s[60:63], s68 offen offset:1024 lds
  s_barrier
  s_add_u32 s16, s16, 1
  s_and_b32 s16, s16, 7
  s_add_u32 m0, s5, 49152
  s_lshl_b32 s68, s16, 16
  s_add_u32 s68, s68, s25
  buffer_load_dwordx4 v37, s[60:63], s68 offen lds
  buffer_load_dwordx4 v38, s[60:63], s68 offen offset:1024 lds
  s_add_u32 s16, s16, 1
  s_and_b32 s16, s16, 7
  s_add_u32 m0, s5, 57344
  s_lshl_b32 s68, s16, 16
  s_add_u32 s68, s68, s25
  buffer_load_dwordx4 v37, s[60:63], s68 offen lds
  buffer_load_dwordx4 v38, s[60:63], s68 offen offset:1024 lds
  s_add_u32 s16, s16, 1
  s_and_b32 s16, s16, 7
  s_add_u32 m0, s5, 65536
  s_lshl_b32 s68, s16, 16
  s_add_u32 s68, s68, s25
  buffer_load_dwordx4 v37, s[60:63], s68 offen lds
  buffer_load_dwordx4 v38, s[60:63], s68 offen offset:1024 lds
  s_add_u32 s16, s16, 1
  s_and_b32 s16, s16, 7
  s_add_u32 m0, s5, 139264
  s_lshl_b32 s68, s16, 16
  s_add_u32 s68, s68, s25
  buffer_load_dwordx4 v37, s[60:63], s68 offen lds
  buffer_load_dwordx4 v38, s[60:63], s68 offen offset:1024 lds
  s_add_u32 s16, s16, 1
  s_and_b32 s16, s16, 7
  s_add_u32 m0, s5, 147456
  s_lshl_b32 s68, s16, 16
  s_add_u32 s68, s68, s25
  buffer_load_dwordx4 v37, s[60:63], s68 offen lds
  buffer_load_dwordx4 v38, s[60:63], s68 offen offset:1024 lds
  s_barrier
  s_add_u32 s16, s16, 1
  s_and_b32 s16, s16, 7
  s_add_u32 m0, s5, 73728
  s_lshl_b32 s68, s16, 16
  s_add_u32 s68, s68, s25
  buffer_load_dwordx4 v37, s[60:63], s68 offen lds
  buffer_load_dwordx4 v38, s[60:63], s68 offen offset:1024 lds
  s_barrier
  s_barrier
  s_barrier
  s_add_u32 m0, s5, 0
  s_lshl_b32 s68, s17, 18
  s_add_u32 s68, s68, s26
  buffer_load_dwordx4 v11, s[56:59], s68 offen sc1 lds
  buffer_load_dwordx4 v11, s[56:59], s68 offen offset:1024 sc1 lds
  s_add_u32 m0, s5, 8192
  s_lshl_b32 s68, s21, 16
  s_add_u32 s68, s68, s25
  buffer_load_dwordx4 v37, s[64:67], s68 offen lds
  buffer_load_dwordx4 v38, s[64:67], s68 offen offset:1024 lds
  s_add_u32 s17, s17, 1
  s_and_b32 s17, s17, 7
  s_add_u32 m0, s5, 16384
  s_lshl_b32 s68, s17, 18
  s_add_u32 s68, s68, s26
  buffer_load_dwordx4 v11, s[56:59], s68 offen sc1 lds
  buffer_load_dwordx4 v11, s[56:59], s68 offen offset:1024 sc1 lds
  s_add_u32 s21, s21, 1
  s_cmp_eq_u32 s21, 14
  s_cselect_b32 s21, 0, s21
  s_add_u32 m0, s5, 24576
  s_lshl_b32 s68, s21, 16
  s_add_u32 s68, s68, s25
  buffer_load_dwordx4 v37, s[64:67], s68 offen lds
  buffer_load_dwordx4 v38, s[64:67], s68 offen offset:1024 lds
  s_barrier
  s_add_u32 s17, s17, 1
  s_and_b32 s17, s17, 7
  s_add_u32 m0, s5, 32768
  s_lshl_b32 s68, s17, 18
  s_add_u32 s68, s68, s26
  buffer_load_dwordx4 v11, s[56:59], s68 offen sc1 lds
  buffer_load_dwordx4 v11, s[56:59], s68 offen offset:1024 sc1 lds
  s_add_u32 s21, s21, 1
  s_cmp_eq_u32 s21, 14
  s_cselect_b32 s21, 0, s21
  s_add_u32 m0, s5, 40960
  s_lshl_b32 s68, s21, 16
  s_add_u32 s68, s68, s25
  buffer_load_dwordx4 v37, s[64:67], s68 offen lds
  buffer_load_dwordx4 v38, s[64:67], s68 offen offset:1024 lds
  s_add_u32 s17, s17, 1
  s_and_b32 s17, s17, 7
  s_add_u32 m0, s5, 81920
  s_lshl_b32 s68, s17, 18
  s_add_u32 s68, s68, s26
  buffer_load_dwordx4 v11, s[56:59], s68 offen sc1 lds
  buffer_load_dwordx4 v11, s[56:59], s68 offen offset:1024 sc1 lds
  s_add_u32 s21, s21, 1
  s_cmp_eq_u32 s21, 14
  s_cselect_b32 s21, 0, s21
  s_add_u32 m0, s5, 90112
  s_lshl_b32 s68, s21, 16
  s_add_u32 s68, s68, s25
  buffer_load_dwordx4 v37, s[64:67], s68 offen lds
  buffer_load_dwordx4 v38, s[64:67], s68 offen offset:1024 lds
  s_waitcnt vmcnt(14)
  s_barrier
  s_add_u32 s17, s17, 1
  s_and_b32 s17, s17, 7
  s_add_u32 m0, s5, 98304
  s_lshl_b32 s68, s17, 18
  s_add_u32 s68, s68, s26
  buffer_load_dwordx4 v11, s[56:59], s68 offen sc1 lds
  buffer_load_dwordx4 v11, s[56:59], s68 offen offset:1024 sc1 lds
  s_add_u32 s21, s21, 1
  s_cmp_eq_u32 s21, 14
  s_cselect_b32 s21, 0, s21
  s_add_u32 m0, s5, 106496
  s_lshl_b32 s68, s21, 16
  s_add_u32 s68, s68, s25
  buffer_load_dwordx4 v37, s[64:67], s68 offen lds
  buffer_load_dwordx4 v38, s[64:67], s68 offen offset:1024 lds
  s_add_u32 s17, s17, 1
  s_and_b32 s17, s17, 7
  s_add_u32 m0, s5, 114688
  s_lshl_b32 s68, s17, 18
  s_add_u32 s68, s68, s26
  buffer_load_dwordx4 v11, s[56:59], s68 offen sc1 lds
  buffer_load_dwordx4 v11, s[56:59], s68 offen offset:1024 sc1 lds
  s_waitcnt vmcnt(16)
  s_barrier
  s_waitcnt vmcnt(12)
  s_barrier
  s_add_u32 s21, s21, 1
  s_cmp_eq_u32 s21, 14
  s_cselect_b32 s21, 0, s21
  s_add_u32 m0, s5, 0
  s_lshl_b32 s68, s21, 16
  s_add_u32 s68, s68, s25
  buffer_load_dwordx4 v37, s[64:67], s68 offen lds
  buffer_load_dwordx4 v38, s[64:67], s68 offen offset:1024 lds
  s_add_u32 s17, s17, 1
  s_and_b32 s17, s17, 7
  s_add_u32 m0, s5, 122880
  s_lshl_b32 s68, s17, 18
  s_add_u32 s68, s68, s26
  buffer_load_dwordx4 v11, s[56:59], s68 offen sc1 lds
  buffer_load_dwordx4 v11, s[56:59], s68 offen offset:1024 sc1 lds
  s_waitcnt vmcnt(12)
  s_barrier
  s_add_u32 s21, s21, 1
  s_cmp_eq_u32 s21, 14
  s_cselect_b32 s21, 0, s21
  s_add_u32 m0, s5, 16384
  s_lshl_b32 s68, s21, 16
  s_add_u32 s68, s68, s25
  buffer_load_dwordx4 v37, s[64:67], s68 offen lds
  buffer_load_dwordx4 v38, s[64:67], s68 offen offset:1024 lds
  s_add_u32 s17, s17, 1
  s_and_b32 s17, s17, 7
  s_add_u32 m0, s5, 131072
  s_lshl_b32 s68, s17, 18
  s_add_u32 s68, s68, s26
  buffer_load_dwordx4 v11, s[56:59], s68 offen sc1 lds
  buffer_load_dwordx4 v11, s[56:59], s68 offen offset:1024 sc1 lds
  s_waitcnt vmcnt(12)
  s_barrier
  s_add_u32 s21, s21, 1
  s_cmp_eq_u32 s21, 14
  s_cselect_b32 s21, 0, s21
  s_add_u32 m0, s5, 32768
  s_lshl_b32 s68, s21, 16
  s_add_u32 s68, s68, s25
  buffer_load_dwordx4 v37, s[64:67], s68 offen lds
  buffer_load_dwordx4 v38, s[64:67], s68 offen offset:1024 lds
  s_add_u32 s21, s21, 1
  s_cmp_eq_u32 s21, 14
  s_cselect_b32 s21, 0, s21
  s_add_u32 m0, s5, 49152
  s_lshl_b32 s68, s21, 16
  s_add_u32 s68, s68, s25
  buffer_load_dwordx4 v37, s[64:67], s68 offen lds
  buffer_load_dwordx4 v38, s[64:67], s68 offen offset:1024 lds
  s_waitcnt vmcnt(12)
  s_barrier
  s_add_u32 m0, s5, 57344
  s_lshl_b32 s68, s22, 13
  s_add_u32 s68, s68, s27
  buffer_load_dwordx4 v11, s[56:59], s68 offen sc1 lds
  buffer_load_dwordx4 v11, s[56:59], s68 offen offset:1024 sc1 lds
  s_add_u32 s21, s21, 1
  s_cmp_eq_u32 s21, 14
  s_cselect_b32 s21, 0, s21
  s_add_u32 m0, s5, 81920
  s_lshl_b32 s68, s21, 16
  s_add_u32 s68, s68, s25
  buffer_load_dwordx4 v37, s[64:67], s68 offen lds
  buffer_load_dwordx4 v38, s[64:67], s68 offen offset:1024 lds
  s_waitcnt vmcnt(12)
  s_barrier
  s_add_u32 s22, s22, 1
  s_cmp_eq_u32 s22, 14
  s_cselect_b32 s22, 0, s22
  s_add_u32 m0, s5, 65536
  s_lshl_b32 s68, s22, 13
  s_add_u32 s68, s68, s27
  buffer_load_dwordx4 v11, s[56:59], s68 offen sc1 lds
  buffer_load_dwordx4 v11, s[56:59], s68 offen offset:1024 sc1 lds
  s_add_u32 s21, s21, 1
  s_cmp_eq_u32 s21, 14
  s_cselect_b32 s21, 0, s21
  s_add_u32 m0, s5, 98304
  s_lshl_b32 s68, s21, 16
  s_add_u32 s68, s68, s25
  buffer_load_dwordx4 v37, s[64:67], s68 offen lds
  buffer_load_dwordx4 v38, s[64:67], s68 offen offset:1024 lds
  s_waitcnt vmcnt(12)
  s_barrier
  s_add_u32 s22, s22, 1
  s_cmp_eq_u32 s22, 14
  s_cselect_b32 s22, 0, s22
  s_add_u32 m0, s5, 114688
  s_lshl_b32 s68, s22, 13
  s_add_u32 s68, s68, s27
  buffer_load_dwordx4 v11, s[56:59], s68 offen sc1 lds
  buffer_load_dwordx4 v11, s[56:59], s68 offen offset:1024 sc1 lds
  s_add_u32 s21, s21, 1
  s_cmp_eq_u32 s21, 14
  s_cselect_b32 s21, 0, s21
  s_add_u32 m0, s5, 139264
  s_lshl_b32 s68, s21, 16
  s_add_u32 s68, s68, s25
  buffer_load_dwordx4 v37, s[64:67], s68 offen lds
  buffer_load_dwordx4 v38, s[64:67], s68 offen offset:1024 lds
  s_waitcnt vmcnt(10)
  s_barrier
  s_add_u32 s22, s22, 1
  s_cmp_eq_u32 s22, 14
  s_cselect_b32 s22, 0, s22
  s_add_u32 m0, s5, 122880
  s_lshl_b32 s68, s22, 13
  s_add_u32 s68, s68, s27
  buffer_load_dwordx4 v11, s[56:59], s68 offen sc1 lds
  buffer_load_dwordx4 v11, s[56:59], s68 offen offset:1024 sc1 lds
  s_add_u32 s21, s21, 1
  s_cmp_eq_u32 s21, 14
  s_cselect_b32 s21, 0, s21
  s_add_u32 m0, s5, 147456
  s_lshl_b32 s68, s21, 16
  s_add_u32 s68, s68, s25
  buffer_load_dwordx4 v37, s[64:67], s68 offen lds
  buffer_load_dwordx4 v38, s[64:67], s68 offen offset:1024 lds
  s_waitcnt vmcnt(10)
  s_barrier
  s_add_u32 s22, s22, 1
  s_cmp_eq_u32 s22, 14
  s_cselect_b32 s22, 0, s22
  s_add_u32 m0, s5, 73728
  s_lshl_b32 s68, s22, 13
  s_add_u32 s68, s68, s27
  buffer_load_dwordx4 v11, s[56:59], s68 offen sc1 lds
  buffer_load_dwordx4 v11, s[56:59], s68 offen offset:1024 sc1 lds
  s_add_u32 s21, s21, 1
  s_cmp_eq_u32 s21, 14
  s_cselect_b32 s21, 0, s21
  s_add_u32 m0, s5, 131072
  s_lshl_b32 s68, s21, 16
  s_add_u32 s68, s68, s25
  buffer_load_dwordx4 v37, s[64:67], s68 offen lds
  buffer_load_dwordx4 v38, s[64:67], s68 offen offset:1024 lds
  s_waitcnt vmcnt(10)
  s_barrier
  s_add_u32 s22, s22, 1
  s_cmp_eq_u32 s22, 14
  s_cselect_b32 s22, 0, s22
  s_add_u32 m0, s5, 8192
  s_lshl_b32 s68, s22, 13
  s_add_u32 s68, s68, s27
  buffer_load_dwordx4 v11, s[56:59], s68 offen sc1 lds
  buffer_load_dwordx4 v11, s[56:59], s68 offen offset:1024 sc1 lds
  s_add_u32 s22, s22, 1
  s_cmp_eq_u32 s22, 14
  s_cselect_b32 s22, 0, s22
  s_add_u32 m0, s5, 57344
  s_lshl_b32 s68, s22, 13
  s_add_u32 s68, s68, s27
  buffer_load_dwordx4 v11, s[56:59], s68 offen sc1 lds
  buffer_load_dwordx4 v11, s[56:59], s68 offen offset:1024 sc1 lds
  s_waitcnt vmcnt(10)
  s_barrier
  s_add_u32 s22, s22, 1
  s_cmp_eq_u32 s22, 14
  s_cselect_b32 s22, 0, s22
  s_add_u32 m0, s5, 24576
  s_lshl_b32 s68, s22, 13
  s_add_u32 s68, s68, s27
  buffer_load_dwordx4 v11, s[56:59], s68 offen sc1 lds
  buffer_load_dwordx4 v11, s[56:59], s68 offen offset:1024 sc1 lds
  s_add_u32 s22, s22, 1
  s_cmp_eq_u32 s22, 14
  s_cselect_b32 s22, 0, s22
  s_add_u32 m0, s5, 65536
  s_lshl_b32 s68, s22, 13
  s_add_u32 s68, s68, s27
  buffer_load_dwordx4 v11, s[56:59], s68 offen sc1 lds
  buffer_load_dwordx4 v11, s[56:59], s68 offen offset:1024 sc1 lds
  s_waitcnt vmcnt(10)
  s_barrier
  s_add_u32 s22, s22, 1
  s_cmp_eq_u32 s22, 14
  s_cselect_b32 s22, 0, s22
  s_add_u32 m0, s5, 40960
  s_lshl_b32 s68, s22, 13
  s_add_u32 s68, s68, s27
  buffer_load_dwordx4 v11, s[56:59], s68 offen sc1 lds
  buffer_load_dwordx4 v11, s[56:59], s68 offen offset:1024 sc1 lds
  s_add_u32 s22, s22, 1
  s_cmp_eq_u32 s22, 14
  s_cselect_b32 s22, 0, s22
  s_add_u32 m0, s5, 114688
  s_lshl_b32 s68, s22, 13
  s_add_u32 s68, s68, s27
  buffer_load_dwordx4 v11, s[56:59], s68 offen sc1 lds
  buffer_load_dwordx4 v11, s[56:59], s68 offen offset:1024 sc1 lds
  s_waitcnt vmcnt(10)
  s_barrier
  s_add_u32 s22, s22, 1
  s_cmp_eq_u32 s22, 14
  s_cselect_b32 s22, 0, s22
  s_add_u32 m0, s5, 90112
  s_lshl_b32 s68, s22, 13
  s_add_u32 s68, s68, s27
  buffer_load_dwordx4 v11, s[56:59], s68 offen sc1 lds
  buffer_load_dwordx4 v11, s[56:59], s68 offen offset:1024 sc1 lds
  s_add_u32 s22, s22, 1
  s_cmp_eq_u32 s22, 14
  s_cselect_b32 s22, 0, s22
  s_add_u32 m0, s5, 122880
  s_lshl_b32 s68, s22, 13
  s_add_u32 s68, s68, s27
  buffer_load_dwordx4 v11, s[56:59], s68 offen sc1 lds
  buffer_load_dwordx4 v11, s[56:59], s68 offen offset:1024 sc1 lds
  s_waitcnt vmcnt(12)
  s_barrier
  s_add_u32 s22, s22, 1
  s_cmp_eq_u32 s22, 14
  s_cselect_b32 s22, 0, s22
  s_add_u32 m0, s5, 73728
  s_lshl_b32 s68, s22, 13
  s_add_u32 s68, s68, s27
  buffer_load_dwordx4 v11, s[56:59], s68 offen sc1 lds
  buffer_load_dwordx4 v11, s[56:59], s68 offen offset:1024 sc1 lds
  s_waitcnt vmcnt(12)
  s_barrier
  s_waitcnt vmcnt(10)
  s_barrier
  s_waitcnt vmcnt(8)
  s_barrier
  s_waitcnt vmcnt(6)
  s_barrier
  s_waitcnt vmcnt(4)
  s_barrier
  s_waitcnt vmcnt(2)
  s_barrier
  s_waitcnt vmcnt(0)
  s_barrier
  s_endpgm
L_att_q0:
  ds_read_b128 a[24:27], v160 offset:8192
  ds_read_b128 a[28:31], v160 offset:7168
  ds_read_b128 a[32:35], v160 offset:6144
  ds_read_b128 a[36:39], v160 offset:5120
  ds_read_b128 a[40:43], v160 offset:4096
  ds_read_b128 a[44:47], v160 offset:3072
  ds_read_b128 a[48:51], v160 offset:2048
  ds_read_b128 a[52:55], v160 offset:1024
  ds_read_b128 a[56:59], v160 offset:0
  s_waitcnt lgkmcnt(8)
  v_mfma_f32_32x32x16_bf16 v[40:55], a[24:27], a[16:19], v[104:119]
  s_waitcnt lgkmcnt(7)
  v_mfma_f32_32x32x16_bf16 v[56:71], a[28:31], a[16:19], 0
  s_waitcnt lgkmcnt(6)
  v_mfma_f32_32x32x16_bf16 v[72:87], a[32:35], a[16:19], 0
  s_nop 7
  v_max3_f32 v39, v40, v41, v42
  v_max_f32 v39, v39, v55
  v_max3_f32 v39, v39, v43, v44
  v_max3_f32 v39, v39, v45, v46
  v_max3_f32 v39, v39, v47, v48
  v_max3_f32 v39, v39, v49, v50
  v_max3_f32 v39, v39, v51, v52
  v_max3_f32 v39, v39, v53, v54
  s_waitcnt lgkmcnt(5)
  v_mfma_f32_32x32x16_bf16 v[40:55], a[36:39], a[16:19], 0
  s_cmp_gt_u32 s28, 7
  s_cbranch_scc1 L_as_1
  v_max3_f32 v39, v39, v56, v57
  v_max3_f32 v39, v39, v58, v59
  v_max3_f32 v39, v39, v60, v61
  v_max3_f32 v39, v39, v62, v63
  v_max3_f32 v39, v39, v64, v65
  v_max3_f32 v39, v39, v66, v67
  v_max3_f32 v39, v39, v68, v69
  v_max3_f32 v39, v39, v70, v71
L_as_1:
  s_waitcnt lgkmcnt(4)
  v_mfma_f32_32x32x16_bf16 v[56:71], a[40:43], a[16:19], 0
  s_cmp_gt_u32 s28, 6
  s_cbranch_scc1 L_as_2
  v_max3_f32 v39, v39, v72, v73
  v_max3_f32 v39, v39, v74, v75
  v_max3_f32 v39, v39, v76, v77
  v_max3_f32 v39, v39, v78, v79
  v_max3_f32 v39, v39, v80, v81
  v_max3_f32 v39, v39, v82, v83
  v_max3_f32 v39, v39, v84, v85
  v_max3_f32 v39, v39, v86, v87
L_as_2:
  s_waitcnt lgkmcnt(3)
  v_mfma_f32_32x32x16_bf16 v[72:87], a[44:47], a[16:19], 0
  s_cmp_gt_u32 s28, 5
  s_cbranch_scc1 L_as_3
  s_nop 1
  v_max3_f32 v39, v39, v40, v41
  v_max3_f32 v39, v39, v42, v43
  v_max3_f32 v39, v39, v44, v45
  v_max3_f32 v39, v39, v46, v47
  v_max3_f32 v39, v39, v48, v49
  v_max3_f32 v39, v39, v50, v51
  v_max3_f32 v39, v39, v52, v53
  v_max3_f32 v39, v39, v54, v55
L_as_3:
  s_waitcnt lgkmcnt(2)
  v_mfma_f32_32x32x16_bf16 v[40:55], a[48:51], a[16:19], 0
  s_cmp_gt_u32 s28, 4
  s_cbranch_scc1 L_as_4
  s_nop 1
  v_max3_f32 v39, v39, v56, v57
  v_max3_f32 v39, v39, v58, v59
  v_max3_f32 v39, v39, v60, v61
  v_max3_f32 v39, v39, v62, v63
  v_max3_f32 v39, v39, v64, v65
  v_max3_f32 v39, v39, v66, v67
  v_max3_f32 v39, v39, v68, v69
  v_max3_f32 v39, v39, v70, v71
L_as_4:
  s_waitcnt lgkmcnt(1)
  v_mfma_f32_32x32x16_bf16 v[56:71], a[52:55], a[16:19], 0
  s_cmp_gt_u32 s28, 3
  s_cbranch_scc1 L_as_5
  s_nop 1
  v_max3_f32 v39, v39, v72, v73
  v_max3_f32 v39, v39, v74, v75
  v_max3_f32 v39, v39, v76, v77
  v_max3_f32 v39, v39, v78, v79
  v_max3_f32 v39, v39, v80, v81
  v_max3_f32 v39, v39, v82, v83
  v_max3_f32 v39, v39, v84, v85
  v_max3_f32 v39, v39, v86, v87
L_as_5:
  s_barrier
  s_waitcnt lgkmcnt(0)
  v_mfma_f32_32x32x16_bf16 v[72:87], a[56:59], a[16:19], v[88:103]
  s_cmp_gt_u32 s28, 2
  s_cbranch_scc1 L_as_6
  s_nop 0
  v_max3_f32 v39, v39, v40, v41
  v_max3_f32 v39, v39, v42, v43
  v_max3_f32 v39, v39, v44, v45
  v_max3_f32 v39, v39, v46, v47
  v_max3_f32 v39, v39, v48, v49
  v_max3_f32 v39, v39, v50, v51
  v_max3_f32 v39, v39, v52, v53
  v_max3_f32 v39, v39, v54, v55
L_as_6:
  s_cmp_gt_u32 s28, 1
  s_cbranch_scc1 L_as_7
  s_nop 2
  v_max3_f32 v39, v39, v56, v57
  v_max3_f32 v39, v39, v58, v59
  v_max3_f32 v39, v39, v60, v61
  v_max3_f32 v39, v39, v62, v63
  v_max3_f32 v39, v39, v64, v65
  v_max3_f32 v39, v39, v66, v67
  v_max3_f32 v39, v39, v68, v69
  v_max3_f32 v39, v39, v70, v71
L_as_7:
  s_cmp_gt_u32 s28, 0
  s_cbranch_scc1 L_as_8
  s_nop 5
  v_max3_f32 v39, v39, v72, v73
  v_max3_f32 v39, v39, v74, v75
  v_max3_f32 v39, v39, v76, v77
  v_max3_f32 v39, v39, v78, v79
  v_max3_f32 v39, v39, v80, v81
  v_max3_f32 v39, v39, v82, v83
  v_max3_f32 v39, v39, v84, v85
  v_max3_f32 v39, v39, v86, v87
L_as_8:
  s_mov_b64 exec, s[34:35]
  ds_read_b128 a[60:63], v161 offset:8192
  ds_read_b128 a[64:67], v161 offset:8704
  s_mov_b64 exec, -1
  s_mov_b64 exec, s[34:35]
  ds_read_b128 a[68:71], v161 offset:7168
  ds_read_b128 a[72:75], v161 offset:7680
  s_mov_b64 exec, -1
  v_mov_b32 v153, v39
  s_nop 1
  v_permlane32_swap_b32 v153, v39
  v_max_f32 v39, v39, v153
  v_sub_f32 v153, 0, v39
  v_mov_b32 v120, v153
  v_mov_b32 v121, v153
  v_mov_b32 v122, v153
  v_mov_b32 v123, v153
  v_mov_b32 v124, v153
  v_mov_b32 v125, v153
  v_mov_b32 v126, v153
  v_mov_b32 v127, v153
  v_mov_b32 v128, v153
  v_mov_b32 v129, v153
  v_mov_b32 v130, v153
  v_mov_b32 v131, v153
  v_mov_b32 v132, v153
  v_mov_b32 v133, v153
  v_mov_b32 v134, v153
  v_mov_b32 v135, v153
  s_nop 1
  v_mfma_f32_32x32x16_bf16 v[40:55], a[24:27], a[16:19], v[120:135]
  v_mfma_f32_32x32x16_bf16 v[56:71], a[28:31], a[16:19], v[120:135]
  v_mfma_f32_32x32x16_bf16 v[72:87], a[32:35], a[16:19], v[120:135]
  s_nop 9
  v_add_f32 v40, v40, v104
  v_add_f32 v41, v41, v105
  v_add_f32 v42, v42, v106
  v_add_f32 v43, v43, v107
  v_add_f32 v44, v44, v108
  v_add_f32 v45, v45, v109
  v_add_f32 v46, v46, v110
  v_add_f32 v47, v47, v111
  v_exp_f32 v40, v40
  v_exp_f32 v41, v41
  v_exp_f32 v42, v42
  v_exp_f32 v43, v43
  s_barrier
  v_exp_f32 v44, v44
  v_exp_f32 v45, v45
  v_exp_f32 v46, v46
  v_exp_f32 v47, v47
  v_cvt_pk_bf16_f32 v136, v40, v41
  v_cvt_pk_bf16_f32 v137, v42, v43
  v_cvt_pk_bf16_f32 v138, v44, v45
  v_cvt_pk_bf16_f32 v139, v46, v47
  s_waitcnt lgkmcnt(2)
  s_nop 0
  v_mfma_f32_32x32x16_bf16 a[0:15], a[60:63], v[136:139], 0
  v_add_f32 v48, v48, v112
  v_add_f32 v49, v49, v113
  v_add_f32 v50, v50, v114
  v_add_f32 v51, v51, v115
  v_add_f32 v52, v52, v116
  v_add_f32 v53, v53, v117
  v_add_f32 v54, v54, v118
  v_add_f32 v55, v55, v119
  v_exp_f32 v48, v48
  v_exp_f32 v49, v49
  v_exp_f32 v50, v50
  v_exp_f32 v51, v51
  v_exp_f32 v52, v52
  v_exp_f32 v53, v53
  v_exp_f32 v54, v54
  v_exp_f32 v55, v55
  v_cvt_pk_bf16_f32 v140, v48, v49
  v_cvt_pk_bf16_f32 v141, v50, v51
  v_cvt_pk_bf16_f32 v142, v52, v53
  v_cvt_pk_bf16_f32 v143, v54, v55
  s_nop 1
  v_mfma_f32_32x32x16_bf16 a[0:15], a[64:67], v[140:143], a[0:15]
  s_mov_b64 exec, s[34:35]
  ds_read_b128 a[60:63], v161 offset:6144
  ds_read_b128 a[64:67], v161 offset:6656
  s_mov_b64 exec, -1
  v_mfma_f32_32x32x16_bf16 v[40:55], a[36:39], a[16:19], v[120:135]
  s_cmp_gt_u32 s28, 7
  s_cbranch_scc1 L_as_9
  v_exp_f32 v56, v56
  v_exp_f32 v57, v57
  v_exp_f32 v58, v58
  v_exp_f32 v59, v59
  v_exp_f32 v60, v60
  v_exp_f32 v61, v61
  v_exp_f32 v62, v62
  v_exp_f32 v63, v63
  v_cvt_pk_bf16_f32 v136, v56, v57
  v_cvt_pk_bf16_f32 v137, v58, v59
  v_cvt_pk_bf16_f32 v138, v60, v61
  v_cvt_pk_bf16_f32 v139, v62, v63
L_as_9:
  s_waitcnt lgkmcnt(2)
  s_cmp_gt_u32 s28, 7
  s_cbranch_scc1 L_as_10
  v_mfma_f32_32x32x16_bf16 a[0:15], a[68:71], v[136:139], a[0:15]
  v_exp_f32 v64, v64
  v_exp_f32 v65, v65
  v_exp_f32 v66, v66
  v_exp_f32 v67, v67
L_as_10:
  s_barrier
  s_cmp_gt_u32 s28, 7
  s_cbranch_scc1 L_as_11
  v_exp_f32 v68, v68
  v_exp_f32 v69, v69
  v_exp_f32 v70, v70
  v_exp_f32 v71, v71
  v_cvt_pk_bf16_f32 v140, v64, v65
  v_cvt_pk_bf16_f32 v141, v66, v67
  v_cvt_pk_bf16_f32 v142, v68, v69
  v_cvt_pk_bf16_f32 v143, v70, v71
  s_nop 1
  v_mfma_f32_32x32x16_bf16 a[0:15], a[72:75], v[140:143], a[0:15]
L_as_11:
  s_mov_b64 exec, s[34:35]
  ds_read_b128 a[68:71], v161 offset:5120
  ds_read_b128 a[72:75], v161 offset:5632
  s_mov_b64 exec, -1
  v_mfma_f32_32x32x16_bf16 v[56:71], a[40:43], a[16:19], v[120:135]
  s_cmp_gt_u32 s28, 6
  s_cbranch_scc1 L_as_12
  v_exp_f32 v72, v72
  v_exp_f32 v73, v73
  v_exp_f32 v74, v74
  v_exp_f32 v75, v75
  v_exp_f32 v76, v76
  v_exp_f32 v77, v77
  v_exp_f32 v78, v78
  v_exp_f32 v79, v79
  v_cvt_pk_bf16_f32 v136, v72, v73
  v_cvt_pk_bf16_f32 v137, v74, v75
  v_cvt_pk_bf16_f32 v138, v76, v77
  v_cvt_pk_bf16_f32 v139, v78, v79
L_as_12:
  s_waitcnt lgkmcnt(2)
  s_cmp_gt_u32 s28, 6
  s_cbranch_scc1 L_as_13
  v_mfma_f32_32x32x16_bf16 a[0:15], a[60:63], v[136:139], a[0:15]
  v_exp_f32 v80, v80
  v_exp_f32 v81, v81
  v_exp_f32 v82, v82
  v_exp_f32 v83, v83
  v_exp_f32 v84, v84
  v_exp_f32 v85, v85
  v_exp_f32 v86, v86
  v_exp_f32 v87, v87
  v_cvt_pk_bf16_f32 v140, v80, v81
  v_cvt_pk_bf16_f32 v141, v82, v83
  v_cvt_pk_bf16_f32 v142, v84, v85
  v_cvt_pk_bf16_f32 v143, v86, v87
  s_nop 1
  v_mfma_f32_32x32x16_bf16 a[0:15], a[64:67], v[140:143], a[0:15]
L_as_13:
  s_mov_b64 exec, s[34:35]
  ds_read_b128 a[60:63], v161 offset:4096
  ds_read_b128 a[64:67], v161 offset:4608
  s_mov_b64 exec, -1
  v_mfma_f32_32x32x16_bf16 v[72:87], a[44:47], a[16:19], v[120:135]
  s_cmp_gt_u32 s28, 5
  s_cbranch_scc1 L_as_14
  v_exp_f32 v40, v40
  v_exp_f32 v41, v41
  v_exp_f32 v42, v42
  v_exp_f32 v43, v43
L_as_14:
  s_barrier
  s_cmp_gt_u32 s28, 5
  s_cbranch_scc1 L_as_15
  v_exp_f32 v44, v44
  v_exp_f32 v45, v45
  v_exp_f32 v46, v46
  v_exp_f32 v47, v47
  v_cvt_pk_bf16_f32 v136, v40, v41
  v_cvt_pk_bf16_f32 v137, v42, v43
  v_cvt_pk_bf16_f32 v138, v44, v45
  v_cvt_pk_bf16_f32 v139, v46, v47
L_as_15:
  s_waitcnt lgkmcnt(2)
  s_cmp_gt_u32 s28, 5
  s_cbranch_scc1 L_as_16
  v_mfma_f32_32x32x16_bf16 a[0:15], a[68:71], v[136:139], a[0:15]
  v_exp_f32 v48, v48
  v_exp_f32 v49, v49
  v_exp_f32 v50, v50
  v_exp_f32 v51, v51
  v_exp_f32 v52, v52
  v_exp_f32 v53, v53
  v_exp_f32 v54, v54
  v_exp_f32 v55, v55
  v_cvt_pk_bf16_f32 v140, v48, v49
  v_cvt_pk_bf16_f32 v141, v50, v51
  v_cvt_pk_bf16_f32 v142, v52, v53
  v_cvt_pk_bf16_f32 v143, v54, v55
  s_nop 1
  v_mfma_f32_32x32x16_bf16 a[0:15], a[72:75], v[140:143], a[0:15]
L_as_16:
  s_mov_b64 exec, s[34:35]
  ds_read_b128 a[68:71], v161 offset:3072
  ds_read_b128 a[72:75], v161 offset:3584
  s_mov_b64 exec, -1
  v_mfma_f32_32x32x16_bf16 v[40:55], a[48:51], a[16:19], v[120:135]
  s_cmp_gt_u32 s28, 4
  s_cbranch_scc1 L_as_17
  v_exp_f32 v56, v56
  v_exp_f32 v57, v57
  v_exp_f32 v58, v58
  v_exp_f32 v59, v59
  v_exp_f32 v60, v60
  v_exp_f32 v61, v61
  v_exp_f32 v62, v62
  v_exp_f32 v63, v63
  v_cvt_pk_bf16_f32 v136, v56, v57
  v_cvt_pk_bf16_f32 v137, v58, v59
  v_cvt_pk_bf16_f32 v138, v60, v61
  v_cvt_pk_bf16_f32 v139, v62, v63
L_as_17:
  s_waitcnt lgkmcnt(2)
  s_cmp_gt_u32 s28, 4
  s_cbranch_scc1 L_as_18
  v_mfma_f32_32x32x16_bf16 a[0:15], a[60:63], v[136:139], a[0:15]
  v_exp_f32 v64, v64
  v_exp_f32 v65, v65
  v_exp_f32 v66, v66
  v_exp_f32 v67, v67
  v_exp_f32 v68, v68
  v_exp_f32 v69, v69
  v_exp_f32 v70, v70
  v_exp_f32 v71, v71
L_as_18:
  s_barrier
  s_cmp_gt_u32 s28, 4
  s_cbranch_scc1 L_as_19
  v_cvt_pk_bf16_f32 v140, v64, v65
  v_cvt_pk_bf16_f32 v141, v66, v67
  v_cvt_pk_bf16_f32 v142, v68, v69
  v_cvt_pk_bf16_f32 v143, v70, v71
  s_nop 1
  v_mfma_f32_32x32x16_bf16 a[0:15], a[64:67], v[140:143], a[0:15]
L_as_19:
  s_mov_b64 exec, s[34:35]
  ds_read_b128 a[60:63], v161 offset:2048
  ds_read_b128 a[64:67], v161 offset:2560
  s_mov_b64 exec, -1
  v_mfma_f32_32x32x16_bf16 v[56:71], a[52:55], a[16:19], v[120:135]
  s_cmp_gt_u32 s28, 3
  s_cbranch_scc1 L_as_20
  v_exp_f32 v72, v72
  v_exp_f32 v73, v73
  v_exp_f32 v74, v74
  v_exp_f32 v75, v75
  v_exp_f32 v76, v76
  v_exp_f32 v77, v77
  v_exp_f32 v78, v78
  v_exp_f32 v79, v79
  v_cvt_pk_bf16_f32 v136, v72, v73
  v_cvt_pk_bf16_f32 v137, v74, v75
  v_cvt_pk_bf16_f32 v138, v76, v77
  v_cvt_pk_bf16_f32 v139, v78, v79
L_as_20:
  s_waitcnt lgkmcnt(2)
  s_cmp_gt_u32 s28, 3
  s_cbranch_scc1 L_as_21
  v_mfma_f32_32x32x16_bf16 a[0:15], a[68:71], v[136:139], a[0:15]
  v_exp_f32 v80, v80
  v_exp_f32 v81, v81
  v_exp_f32 v82, v82
  v_exp_f32 v83, v83
  v_exp_f32 v84, v84
  v_exp_f32 v85, v85
  v_exp_f32 v86, v86
  v_exp_f32 v87, v87
  v_cvt_pk_bf16_f32 v140, v80, v81
  v_cvt_pk_bf16_f32 v141, v82, v83
  v_cvt_pk_bf16_f32 v142, v84, v85
  v_cvt_pk_bf16_f32 v143, v86, v87
  s_nop 1
  v_mfma_f32_32x32x16_bf16 a[0:15], a[72:75], v[140:143], a[0:15]
L_as_21:
  s_mov_b64 exec, s[34:35]
  ds_read_b128 a[68:71], v161 offset:1024
  ds_read_b128 a[72:75], v161 offset:1536
  s_mov_b64 exec, -1
  v_mfma_f32_32x32x16_bf16 v[72:87], a[56:59], a[16:19], v[120:135]
  s_cmp_gt_u32 s28, 2
  s_cbranch_scc1 L_as_22
  v_exp_f32 v40, v40
  v_exp_f32 v41, v41
  v_exp_f32 v42, v42
  v_exp_f32 v43, v43
  v_exp_f32 v44, v44
  v_exp_f32 v45, v45
  v_exp_f32 v46, v46
  v_exp_f32 v47, v47
L_as_22:
  s_barrier
  s_cmp_gt_u32 s28, 2
  s_cbranch_scc1 L_as_23
  v_cvt_pk_bf16_f32 v136, v40, v41
  v_cvt_pk_bf16_f32 v137, v42, v43
  v_cvt_pk_bf16_f32 v138, v44, v45
  v_cvt_pk_bf16_f32 v139, v46, v47
L_as_23:
  s_waitcnt lgkmcnt(2)
  s_cmp_gt_u32 s28, 2
  s_cbranch_scc1 L_as_24
  v_mfma_f32_32x32x16_bf16 a[0:15], a[60:63], v[136:139], a[0:15]
  v_exp_f32 v48, v48
  v_exp_f32 v49, v49
  v_exp_f32 v50, v50
  v_exp_f32 v51, v51
  v_exp_f32 v52, v52
  v_exp_f32 v53, v53
  v_exp_f32 v54, v54
  v_exp_f32 v55, v55
  v_cvt_pk_bf16_f32 v140, v48, v49
  v_cvt_pk_bf16_f32 v141, v50, v51
  v_cvt_pk_bf16_f32 v142, v52, v53
  v_cvt_pk_bf16_f32 v143, v54, v55
  s_nop 1
  v_mfma_f32_32x32x16_bf16 a[0:15], a[64:67], v[140:143], a[0:15]
L_as_24:
  s_mov_b64 exec, s[34:35]
  ds_read_b128 a[60:63], v161 offset:0
  ds_read_b128 a[64:67], v161 offset:512
  s_mov_b64 exec, -1
  s_cmp_gt_u32 s28, 1
  s_cbranch_scc1 L_as_25
  v_exp_f32 v56, v56
  v_exp_f32 v57, v57
  v_exp_f32 v58, v58
  v_exp_f32 v59, v59
  v_exp_f32 v60, v60
  v_exp_f32 v61, v61
  v_exp_f32 v62, v62
  v_exp_f32 v63, v63
  v_cvt_pk_bf16_f32 v136, v56, v57
  v_cvt_pk_bf16_f32 v137, v58, v59
  v_cvt_pk_bf16_f32 v138, v60, v61
  v_cvt_pk_bf16_f32 v139, v62, v63
L_as_25:
  s_waitcnt lgkmcnt(2)
  s_cmp_gt_u32 s28, 1
  s_cbranch_scc1 L_as_26
  v_mfma_f32_32x32x16_bf16 a[0:15], a[68:71], v[136:139], a[0:15]
  v_exp_f32 v64, v64
  v_exp_f32 v65, v65
  v_exp_f32 v66, v66
  v_exp_f32 v67, v67
  v_exp_f32 v68, v68
  v_exp_f32 v69, v69
  v_exp_f32 v70, v70
  v_exp_f32 v71, v71
  v_cvt_pk_bf16_f32 v140, v64, v65
  v_cvt_pk_bf16_f32 v141, v66, v67
  v_cvt_pk_bf16_f32 v142, v68, v69
  v_cvt_pk_bf16_f32 v143, v70, v71
  s_nop 1
  v_mfma_f32_32x32x16_bf16 a[0:15], a[72:75], v[140:143], a[0:15]
L_as_26:
  s_cmp_gt_u32 s28, 0
  s_cbranch_scc1 L_as_27
  v_add_f32 v72, v72, v88
  v_add_f32 v73, v73, v89
  v_add_f32 v74, v74, v90
  v_add_f32 v75, v75, v91
  v_add_f32 v76, v76, v92
  v_add_f32 v77, v77, v93
  v_add_f32 v78, v78, v94
  v_add_f32 v79, v79, v95
L_as_27:
  s_barrier
  s_cmp_gt_u32 s28, 0
  s_cbranch_scc1 L_as_28
  v_exp_f32 v72, v72
  v_exp_f32 v73, v73
  v_exp_f32 v74, v74
  v_exp_f32 v75, v75
  v_exp_f32 v76, v76
  v_exp_f32 v77, v77
  v_exp_f32 v78, v78
  v_exp_f32 v79, v79
  v_cvt_pk_bf16_f32 v136, v72, v73
  v_cvt_pk_bf16_f32 v137, v74, v75
  v_cvt_pk_bf16_f32 v138, v76, v77
  v_cvt_pk_bf16_f32 v139, v78, v79
L_as_28:
  s_waitcnt lgkmcnt(0)
  s_cmp_gt_u32 s28, 0
  s_cbranch_scc1 L_as_29
  v_mfma_f32_32x32x16_bf16 a[0:15], a[60:63], v[136:139], a[0:15]
  v_add_f32 v80, v80, v96
  v_add_f32 v81, v81, v97
  v_add_f32 v82, v82, v98
  v_add_f32 v83, v83, v99
  v_add_f32 v84, v84, v100
  v_add_f32 v85, v85, v101
  v_add_f32 v86, v86, v102
  v_add_f32 v87, v87, v103
  v_exp_f32 v80, v80
  v_exp_f32 v81, v81
  v_exp_f32 v82, v82
  v_exp_f32 v83, v83
  v_exp_f32 v84, v84
  v_exp_f32 v85, v85
  v_exp_f32 v86, v86
  v_exp_f32 v87, v87
  v_cvt_pk_bf16_f32 v140, v80, v81
  v_cvt_pk_bf16_f32 v141, v82, v83
  v_cvt_pk_bf16_f32 v142, v84, v85
  v_cvt_pk_bf16_f32 v143, v86, v87
  s_nop 1
  v_mfma_f32_32x32x16_bf16 a[0:15], a[64:67], v[140:143], a[0:15]
L_as_29:
  s_nop 11
  v_accvgpr_read_b32 v144, a0
  v_accvgpr_read_b32 v145, a1
  v_accvgpr_read_b32 v146, a2
  v_accvgpr_read_b32 v147, a3
  v_accvgpr_read_b32 v148, a4
  v_accvgpr_read_b32 v149, a5
  v_accvgpr_read_b32 v150, a6
  v_accvgpr_read_b32 v151, a7
  v_accvgpr_read_b32 v152, a8
  v_rcp_f32 v153, v152
  s_nop 0
  v_mul_f32 v144, v144, v153
  v_mul_f32 v145, v145, v153
  v_mul_f32 v146, v146, v153
  v_mul_f32 v147, v147, v153
  v_mul_f32 v148, v148, v153
  v_mul_f32 v149, v149, v153
  v_mul_f32 v150, v150, v153
  v_mul_f32 v151, v151, v153
  v_cvt_pk_bf16_f32 v156, v144, v145
  v_cvt_pk_bf16_f32 v157, v146, v147
  v_cvt_pk_bf16_f32 v158, v148, v149
  v_cvt_pk_bf16_f32 v159, v150, v151
  s_nop 0
  v_permlane32_swap_b32 v156, v158
  v_permlane32_swap_b32 v157, v159
  s_add_u32 s6, s32, 15728640
  buffer_store_dwordx4 v[156:159], v162, s[56:59], s6 offen sc1
  s_barrier
  ds_read_b128 a[24:27], v160 offset:12288
  ds_read_b128 a[28:31], v160 offset:11264
  ds_read_b128 a[32:35], v160 offset:10240
  ds_read_b128 a[36:39], v160 offset:9216
  ds_read_b128 a[40:43], v160 offset:8192
  ds_read_b128 a[44:47], v160 offset:7168
  ds_read_b128 a[48:51], v160 offset:6144
  ds_read_b128 a[52:55], v160 offset:5120
  ds_read_b128 a[56:59], v160 offset:4096
  s_waitcnt lgkmcnt(8)
  v_mfma_f32_32x32x16_bf16 v[40:55], a[24:27], a[20:23], v[104:119]
  s_waitcnt lgkmcnt(7)
  v_mfma_f32_32x32x16_bf16 v[56:71], a[28:31], a[20:23], 0
  s_waitcnt lgkmcnt(6)
  v_mfma_f32_32x32x16_bf16 v[72:87], a[32:35], a[20:23], 0
  s_nop 7
  v_max3_f32 v39, v40, v41, v42
  v_max_f32 v39, v39, v55
  v_max3_f32 v39, v39, v43, v44
  v_max3_f32 v39, v39, v45, v46
  v_max3_f32 v39, v39, v47, v48
  v_max3_f32 v39, v39, v49, v50
  v_max3_f32 v39, v39, v51, v52
  v_max3_f32 v39, v39, v53, v54
  s_waitcnt lgkmcnt(5)
  v_mfma_f32_32x32x16_bf16 v[40:55], a[36:39], a[20:23], 0
  s_cmp_gt_u32 s29, 7
  s_cbranch_scc1 L_as_30
  v_max3_f32 v39, v39, v56, v57
  v_max3_f32 v39, v39, v58, v59
  v_max3_f32 v39, v39, v60, v61
  v_max3_f32 v39, v39, v62, v63
  v_max3_f32 v39, v39, v64, v65
  v_max3_f32 v39, v39, v66, v67
  v_max3_f32 v39, v39, v68, v69
  v_max3_f32 v39, v39, v70, v71
L_as_30:
  s_waitcnt lgkmcnt(4)
  v_mfma_f32_32x32x16_bf16 v[56:71], a[40:43], a[20:23], 0
  s_cmp_gt_u32 s29, 6
  s_cbranch_scc1 L_as_31
  v_max3_f32 v39, v39, v72, v73
  v_max3_f32 v39, v39, v74, v75
  v_max3_f32 v39, v39, v76, v77
  v_max3_f32 v39, v39, v78, v79
  v_max3_f32 v39, v39, v80, v81
  v_max3_f32 v39, v39, v82, v83
  v_max3_f32 v39, v39, v84, v85
  v_max3_f32 v39, v39, v86, v87
L_as_31:
  s_waitcnt lgkmcnt(3)
  v_mfma_f32_32x32x16_bf16 v[72:87], a[44:47], a[20:23], 0
  s_cmp_gt_u32 s29, 5
  s_cbranch_scc1 L_as_32
  s_nop 1
  v_max3_f32 v39, v39, v40, v41
  v_max3_f32 v39, v39, v42, v43
  v_max3_f32 v39, v39, v44, v45
  v_max3_f32 v39, v39, v46, v47
  v_max3_f32 v39, v39, v48, v49
  v_max3_f32 v39, v39, v50, v51
  v_max3_f32 v39, v39, v52, v53
  v_max3_f32 v39, v39, v54, v55
L_as_32:
  s_waitcnt lgkmcnt(2)
  v_mfma_f32_32x32x16_bf16 v[40:55], a[48:51], a[20:23], 0
  s_cmp_gt_u32 s29, 4
  s_cbranch_scc1 L_as_33
  s_nop 1
  v_max3_f32 v39, v39, v56, v57
  v_max3_f32 v39, v39, v58, v59
  v_max3_f32 v39, v39, v60, v61
  v_max3_f32 v39, v39, v62, v63
  v_max3_f32 v39, v39, v64, v65
  v_max3_f32 v39, v39, v66, v67
  v_max3_f32 v39, v39, v68, v69
  v_max3_f32 v39, v39, v70, v71
L_as_33:
  s_waitcnt lgkmcnt(1)
  v_mfma_f32_32x32x16_bf16 v[56:71], a[52:55], a[20:23], 0
  s_cmp_gt_u32 s29, 3
  s_cbranch_scc1 L_as_34
  s_nop 1
  v_max3_f32 v39, v39, v72, v73
  v_max3_f32 v39, v39, v74, v75
  v_max3_f32 v39, v39, v76, v77
  v_max3_f32 v39, v39, v78, v79
  v_max3_f32 v39, v39, v80, v81
  v_max3_f32 v39, v39, v82, v83
  v_max3_f32 v39, v39, v84, v85
  v_max3_f32 v39, v39, v86, v87
L_as_34:
  s_barrier
  s_waitcnt lgkmcnt(0)
  v_mfma_f32_32x32x16_bf16 v[72:87], a[56:59], a[20:23], v[88:103]
  s_cmp_gt_u32 s29, 2
  s_cbranch_scc1 L_as_35
  s_nop 0
  v_max3_f32 v39, v39, v40, v41
  v_max3_f32 v39, v39, v42, v43
  v_max3_f32 v39, v39, v44, v45
  v_max3_f32 v39, v39, v46, v47
  v_max3_f32 v39, v39, v48, v49
  v_max3_f32 v39, v39, v50, v51
  v_max3_f32 v39, v39, v52, v53
  v_max3_f32 v39, v39, v54, v55
L_as_35:
  s_cmp_gt_u32 s29, 1
  s_cbranch_scc1 L_as_36
  s_nop 2
  v_max3_f32 v39, v39, v56, v57
  v_max3_f32 v39, v39, v58, v59
  v_max3_f32 v39, v39, v60, v61
  v_max3_f32 v39, v39, v62, v63
  v_max3_f32 v39, v39, v64, v65
  v_max3_f32 v39, v39, v66, v67
  v_max3_f32 v39, v39, v68, v69
  v_max3_f32 v39, v39, v70, v71
L_as_36:
  s_cmp_gt_u32 s29, 0
  s_cbranch_scc1 L_as_37
  s_nop 5
  v_max3_f32 v39, v39, v72, v73
  v_max3_f32 v39, v39, v74, v75
  v_max3_f32 v39, v39, v76, v77
  v_max3_f32 v39, v39, v78, v79
  v_max3_f32 v39, v39, v80, v81
  v_max3_f32 v39, v39, v82, v83
  v_max3_f32 v39, v39, v84, v85
  v_max3_f32 v39, v39, v86, v87
L_as_37:
  s_mov_b64 exec, s[34:35]
  ds_read_b128 a[60:63], v161 offset:12288
  ds_read_b128 a[64:67], v161 offset:12800
  s_mov_b64 exec, -1
  s_mov_b64 exec, s[34:35]
  ds_read_b128 a[68:71], v161 offset:11264
  ds_read_b128 a[72:75], v161 offset:11776
  s_mov_b64 exec, -1
  v_mov_b32 v153, v39
  s_nop 1
  v_permlane32_swap_b32 v153, v39
  v_max_f32 v39, v39, v153
  v_sub_f32 v153, 0, v39
  v_mov_b32 v120, v153
  v_mov_b32 v121, v153
  v_mov_b32 v122, v153
  v_mov_b32 v123, v153
  v_mov_b32 v124, v153
  v_mov_b32 v125, v153
  v_mov_b32 v126, v153
  v_mov_b32 v127, v153
  v_mov_b32 v128, v153
  v_mov_b32 v129, v153
  v_mov_b32 v130, v153
  v_mov_b32 v131, v153
  v_mov_b32 v132, v153
  v_mov_b32 v133, v153
  v_mov_b32 v134, v153
  v_mov_b32 v135, v153
  s_nop 1
  v_mfma_f32_32x32x16_bf16 v[40:55], a[24:27], a[20:23], v[120:135]
  v_mfma_f32_32x32x16_bf16 v[56:71], a[28:31], a[20:23], v[120:135]
  v_mfma_f32_32x32x16_bf16 v[72:87], a[32:35], a[20:23], v[120:135]
  s_nop 9
  v_add_f32 v40, v40, v104
  v_add_f32 v41, v41, v105
  v_add_f32 v42, v42, v106
  v_add_f32 v43, v43, v107
  v_add_f32 v44, v44, v108
  v_add_f32 v45, v45, v109
  v_add_f32 v46, v46, v110
  v_add_f32 v47, v47, v111
  v_exp_f32 v40, v40
  v_exp_f32 v41, v41
  v_exp_f32 v42, v42
  v_exp_f32 v43, v43
  s_barrier
  v_exp_f32 v44, v44
  v_exp_f32 v45, v45
  v_exp_f32 v46, v46
  v_exp_f32 v47, v47
  v_cvt_pk_bf16_f32 v136, v40, v41
  v_cvt_pk_bf16_f32 v137, v42, v43
  v_cvt_pk_bf16_f32 v138, v44, v45
  v_cvt_pk_bf16_f32 v139, v46, v47
  s_waitcnt lgkmcnt(2)
  s_nop 0
  v_mfma_f32_32x32x16_bf16 a[0:15], a[60:63], v[136:139], 0
  v_add_f32 v48, v48, v112
  v_add_f32 v49, v49, v113
  v_add_f32 v50, v50, v114
  v_add_f32 v51, v51, v115
  v_add_f32 v52, v52, v116
  v_add_f32 v53, v53, v117
  v_add_f32 v54, v54, v118
  v_add_f32 v55, v55, v119
  v_exp_f32 v48, v48
  v_exp_f32 v49, v49
  v_exp_f32 v50, v50
  v_exp_f32 v51, v51
  v_exp_f32 v52, v52
  v_exp_f32 v53, v53
  v_exp_f32 v54, v54
  v_exp_f32 v55, v55
  v_cvt_pk_bf16_f32 v140, v48, v49
  v_cvt_pk_bf16_f32 v141, v50, v51
  v_cvt_pk_bf16_f32 v142, v52, v53
  v_cvt_pk_bf16_f32 v143, v54, v55
  s_nop 1
  v_mfma_f32_32x32x16_bf16 a[0:15], a[64:67], v[140:143], a[0:15]
  s_mov_b64 exec, s[34:35]
  ds_read_b128 a[60:63], v161 offset:10240
  ds_read_b128 a[64:67], v161 offset:10752
  s_mov_b64 exec, -1
  v_mfma_f32_32x32x16_bf16 v[40:55], a[36:39], a[20:23], v[120:135]
  s_cmp_gt_u32 s29, 7
  s_cbranch_scc1 L_as_38
  v_exp_f32 v56, v56
  v_exp_f32 v57, v57
  v_exp_f32 v58, v58
  v_exp_f32 v59, v59
  v_exp_f32 v60, v60
  v_exp_f32 v61, v61
  v_exp_f32 v62, v62
  v_exp_f32 v63, v63
  v_cvt_pk_bf16_f32 v136, v56, v57
  v_cvt_pk_bf16_f32 v137, v58, v59
  v_cvt_pk_bf16_f32 v138, v60, v61
  v_cvt_pk_bf16_f32 v139, v62, v63
L_as_38:
  s_waitcnt lgkmcnt(2)
  s_cmp_gt_u32 s29, 7
  s_cbranch_scc1 L_as_39
  v_mfma_f32_32x32x16_bf16 a[0:15], a[68:71], v[136:139], a[0:15]
  v_exp_f32 v64, v64
  v_exp_f32 v65, v65
  v_exp_f32 v66, v66
  v_exp_f32 v67, v67
L_as_39:
  s_barrier
  s_cmp_gt_u32 s29, 7
  s_cbranch_scc1 L_as_40
  v_exp_f32 v68, v68
  v_exp_f32 v69, v69
  v_exp_f32 v70, v70
  v_exp_f32 v71, v71
  v_cvt_pk_bf16_f32 v140, v64, v65
  v_cvt_pk_bf16_f32 v141, v66, v67
  v_cvt_pk_bf16_f32 v142, v68, v69
  v_cvt_pk_bf16_f32 v143, v70, v71
  s_nop 1
  v_mfma_f32_32x32x16_bf16 a[0:15], a[72:75], v[140:143], a[0:15]
L_as_40:
  s_mov_b64 exec, s[34:35]
  ds_read_b128 a[68:71], v161 offset:9216
  ds_read_b128 a[72:75], v161 offset:9728
  s_mov_b64 exec, -1
  v_mfma_f32_32x32x16_bf16 v[56:71], a[40:43], a[20:23], v[120:135]
  s_cmp_gt_u32 s29, 6
  s_cbranch_scc1 L_as_41
  v_exp_f32 v72, v72
  v_exp_f32 v73, v73
  v_exp_f32 v74, v74
  v_exp_f32 v75, v75
  v_exp_f32 v76, v76
  v_exp_f32 v77, v77
  v_exp_f32 v78, v78
  v_exp_f32 v79, v79
  v_cvt_pk_bf16_f32 v136, v72, v73
  v_cvt_pk_bf16_f32 v137, v74, v75
  v_cvt_pk_bf16_f32 v138, v76, v77
  v_cvt_pk_bf16_f32 v139, v78, v79
L_as_41:
  s_waitcnt lgkmcnt(2)
  s_cmp_gt_u32 s29, 6
  s_cbranch_scc1 L_as_42
  v_mfma_f32_32x32x16_bf16 a[0:15], a[60:63], v[136:139], a[0:15]
  v_exp_f32 v80, v80
  v_exp_f32 v81, v81
  v_exp_f32 v82, v82
  v_exp_f32 v83, v83
  v_exp_f32 v84, v84
  v_exp_f32 v85, v85
  v_exp_f32 v86, v86
  v_exp_f32 v87, v87
  v_cvt_pk_bf16_f32 v140, v80, v81
  v_cvt_pk_bf16_f32 v141, v82, v83
  v_cvt_pk_bf16_f32 v142, v84, v85
  v_cvt_pk_bf16_f32 v143, v86, v87
  s_nop 1
  v_mfma_f32_32x32x16_bf16 a[0:15], a[64:67], v[140:143], a[0:15]
L_as_42:
  s_mov_b64 exec, s[34:35]
  ds_read_b128 a[60:63], v161 offset:8192
  ds_read_b128 a[64:67], v161 offset:8704
  s_mov_b64 exec, -1
  v_mfma_f32_32x32x16_bf16 v[72:87], a[44:47], a[20:23], v[120:135]
  s_cmp_gt_u32 s29, 5
  s_cbranch_scc1 L_as_43
  v_exp_f32 v40, v40
  v_exp_f32 v41, v41
  v_exp_f32 v42, v42
  v_exp_f32 v43, v43
L_as_43:
  s_barrier
  s_cmp_gt_u32 s29, 5
  s_cbranch_scc1 L_as_44
  v_exp_f32 v44, v44
  v_exp_f32 v45, v45
  v_exp_f32 v46, v46
  v_exp_f32 v47, v47
  v_cvt_pk_bf16_f32 v136, v40, v41
  v_cvt_pk_bf16_f32 v137, v42, v43
  v_cvt_pk_bf16_f32 v138, v44, v45
  v_cvt_pk_bf16_f32 v139, v46, v47
L_as_44:
  s_waitcnt lgkmcnt(2)
  s_cmp_gt_u32 s29, 5
  s_cbranch_scc1 L_as_45
  v_mfma_f32_32x32x16_bf16 a[0:15], a[68:71], v[136:139], a[0:15]
  v_exp_f32 v48, v48
  v_exp_f32 v49, v49
  v_exp_f32 v50, v50
  v_exp_f32 v51, v51
  v_exp_f32 v52, v52
  v_exp_f32 v53, v53
  v_exp_f32 v54, v54
  v_exp_f32 v55, v55
  v_cvt_pk_bf16_f32 v140, v48, v49
  v_cvt_pk_bf16_f32 v141, v50, v51
  v_cvt_pk_bf16_f32 v142, v52, v53
  v_cvt_pk_bf16_f32 v143, v54, v55
  s_nop 1
  v_mfma_f32_32x32x16_bf16 a[0:15], a[72:75], v[140:143], a[0:15]
L_as_45:
  s_mov_b64 exec, s[34:35]
  ds_read_b128 a[68:71], v161 offset:7168
  ds_read_b128 a[72:75], v161 offset:7680
  s_mov_b64 exec, -1
  v_mfma_f32_32x32x16_bf16 v[40:55], a[48:51], a[20:23], v[120:135]
  s_cmp_gt_u32 s29, 4
  s_cbranch_scc1 L_as_46
  v_exp_f32 v56, v56
  v_exp_f32 v57, v57
  v_exp_f32 v58, v58
  v_exp_f32 v59, v59
  v_exp_f32 v60, v60
  v_exp_f32 v61, v61
  v_exp_f32 v62, v62
  v_exp_f32 v63, v63
  v_cvt_pk_bf16_f32 v136, v56, v57
  v_cvt_pk_bf16_f32 v137, v58, v59
  v_cvt_pk_bf16_f32 v138, v60, v61
  v_cvt_pk_bf16_f32 v139, v62, v63
L_as_46:
  s_waitcnt lgkmcnt(2)
  s_cmp_gt_u32 s29, 4
  s_cbranch_scc1 L_as_47
  v_mfma_f32_32x32x16_bf16 a[0:15], a[60:63], v[136:139], a[0:15]
  v_exp_f32 v64, v64
  v_exp_f32 v65, v65
  v_exp_f32 v66, v66
  v_exp_f32 v67, v67
  v_exp_f32 v68, v68
  v_exp_f32 v69, v69
  v_exp_f32 v70, v70
  v_exp_f32 v71, v71
L_as_47:
  s_barrier
  s_cmp_gt_u32 s29, 4
  s_cbranch_scc1 L_as_48
  v_cvt_pk_bf16_f32 v140, v64, v65
  v_cvt_pk_bf16_f32 v141, v66, v67
  v_cvt_pk_bf16_f32 v142, v68, v69
  v_cvt_pk_bf16_f32 v143, v70, v71
  s_nop 1
  v_mfma_f32_32x32x16_bf16 a[0:15], a[64:67], v[140:143], a[0:15]
L_as_48:
  s_mov_b64 exec, s[34:35]
  ds_read_b128 a[60:63], v161 offset:6144
  ds_read_b128 a[64:67], v161 offset:6656
  s_mov_b64 exec, -1
  v_mfma_f32_32x32x16_bf16 v[56:71], a[52:55], a[20:23], v[120:135]
  s_cmp_gt_u32 s29, 3
  s_cbranch_scc1 L_as_49
  v_exp_f32 v72, v72
  v_exp_f32 v73, v73
  v_exp_f32 v74, v74
  v_exp_f32 v75, v75
  v_exp_f32 v76, v76
  v_exp_f32 v77, v77
  v_exp_f32 v78, v78
  v_exp_f32 v79, v79
  v_cvt_pk_bf16_f32 v136, v72, v73
  v_cvt_pk_bf16_f32 v137, v74, v75
  v_cvt_pk_bf16_f32 v138, v76, v77
  v_cvt_pk_bf16_f32 v139, v78, v79
L_as_49:
  s_waitcnt lgkmcnt(2)
  s_cmp_gt_u32 s29, 3
  s_cbranch_scc1 L_as_50
  v_mfma_f32_32x32x16_bf16 a[0:15], a[68:71], v[136:139], a[0:15]
  v_exp_f32 v80, v80
  v_exp_f32 v81, v81
  v_exp_f32 v82, v82
  v_exp_f32 v83, v83
  v_exp_f32 v84, v84
  v_exp_f32 v85, v85
  v_exp_f32 v86, v86
  v_exp_f32 v87, v87
  v_cvt_pk_bf16_f32 v140, v80, v81
  v_cvt_pk_bf16_f32 v141, v82, v83
  v_cvt_pk_bf16_f32 v142, v84, v85
  v_cvt_pk_bf16_f32 v143, v86, v87
  s_nop 1
  v_mfma_f32_32x32x16_bf16 a[0:15], a[72:75], v[140:143], a[0:15]
L_as_50:
  s_mov_b64 exec, s[34:35]
  ds_read_b128 a[68:71], v161 offset:5120
  ds_read_b128 a[72:75], v161 offset:5632
  s_mov_b64 exec, -1
  v_mfma_f32_32x32x16_bf16 v[72:87], a[56:59], a[20:23], v[120:135]
  s_cmp_gt_u32 s29, 2
  s_cbranch_scc1 L_as_51
  v_exp_f32 v40, v40
  v_exp_f32 v41, v41
  v_exp_f32 v42, v42
  v_exp_f32 v43, v43
  v_exp_f32 v44, v44
  v_exp_f32 v45, v45
  v_exp_f32 v46, v46
  v_exp_f32 v47, v47
L_as_51:
  s_barrier
  s_cmp_gt_u32 s29, 2
  s_cbranch_scc1 L_as_52
  v_cvt_pk_bf16_f32 v136, v40, v41
  v_cvt_pk_bf16_f32 v137, v42, v43
  v_cvt_pk_bf16_f32 v138, v44, v45
  v_cvt_pk_bf16_f32 v139, v46, v47
L_as_52:
  s_waitcnt lgkmcnt(2)
  s_cmp_gt_u32 s29, 2
  s_cbranch_scc1 L_as_53
  v_mfma_f32_32x32x16_bf16 a[0:15], a[60:63], v[136:139], a[0:15]
  v_exp_f32 v48, v48
  v_exp_f32 v49, v49
  v_exp_f32 v50, v50
  v_exp_f32 v51, v51
  v_exp_f32 v52, v52
  v_exp_f32 v53, v53
  v_exp_f32 v54, v54
  v_exp_f32 v55, v55
  v_cvt_pk_bf16_f32 v140, v48, v49
  v_cvt_pk_bf16_f32 v141, v50, v51
  v_cvt_pk_bf16_f32 v142, v52, v53
  v_cvt_pk_bf16_f32 v143, v54, v55
  s_nop 1
  v_mfma_f32_32x32x16_bf16 a[0:15], a[64:67], v[140:143], a[0:15]
L_as_53:
  s_mov_b64 exec, s[34:35]
  ds_read_b128 a[60:63], v161 offset:4096
  ds_read_b128 a[64:67], v161 offset:4608
  s_mov_b64 exec, -1
  s_cmp_gt_u32 s29, 1
  s_cbranch_scc1 L_as_54
  v_exp_f32 v56, v56
  v_exp_f32 v57, v57
  v_exp_f32 v58, v58
  v_exp_f32 v59, v59
  v_exp_f32 v60, v60
  v_exp_f32 v61, v61
  v_exp_f32 v62, v62
  v_exp_f32 v63, v63
  v_cvt_pk_bf16_f32 v136, v56, v57
  v_cvt_pk_bf16_f32 v137, v58, v59
  v_cvt_pk_bf16_f32 v138, v60, v61
  v_cvt_pk_bf16_f32 v139, v62, v63
L_as_54:
  s_waitcnt lgkmcnt(2)
  s_cmp_gt_u32 s29, 1
  s_cbranch_scc1 L_as_55
  v_mfma_f32_32x32x16_bf16 a[0:15], a[68:71], v[136:139], a[0:15]
  v_exp_f32 v64, v64
  v_exp_f32 v65, v65
  v_exp_f32 v66, v66
  v_exp_f32 v67, v67
  v_exp_f32 v68, v68
  v_exp_f32 v69, v69
  v_exp_f32 v70, v70
  v_exp_f32 v71, v71
  v_cvt_pk_bf16_f32 v140, v64, v65
  v_cvt_pk_bf16_f32 v141, v66, v67
  v_cvt_pk_bf16_f32 v142, v68, v69
  v_cvt_pk_bf16_f32 v143, v70, v71
  s_nop 1
  v_mfma_f32_32x32x16_bf16 a[0:15], a[72:75], v[140:143], a[0:15]
L_as_55:
  s_cmp_gt_u32 s29, 0
  s_cbranch_scc1 L_as_56
  v_add_f32 v72, v72, v88
  v_add_f32 v73, v73, v89
  v_add_f32 v74, v74, v90
  v_add_f32 v75, v75, v91
  v_add_f32 v76, v76, v92
  v_add_f32 v77, v77, v93
  v_add_f32 v78, v78, v94
  v_add_f32 v79, v79, v95
L_as_56:
  s_barrier
  s_cmp_gt_u32 s29, 0
  s_cbranch_scc1 L_as_57
  v_exp_f32 v72, v72
  v_exp_f32 v73, v73
  v_exp_f32 v74, v74
  v_exp_f32 v75, v75
  v_exp_f32 v76, v76
  v_exp_f32 v77, v77
  v_exp_f32 v78, v78
  v_exp_f32 v79, v79
  v_cvt_pk_bf16_f32 v136, v72, v73
  v_cvt_pk_bf16_f32 v137, v74, v75
  v_cvt_pk_bf16_f32 v138, v76, v77
  v_cvt_pk_bf16_f32 v139, v78, v79
L_as_57:
  s_waitcnt lgkmcnt(0)
  s_cmp_gt_u32 s29, 0
  s_cbranch_scc1 L_as_58
  v_mfma_f32_32x32x16_bf16 a[0:15], a[60:63], v[136:139], a[0:15]
  v_add_f32 v80, v80, v96
  v_add_f32 v81, v81, v97
  v_add_f32 v82, v82, v98
  v_add_f32 v83, v83, v99
  v_add_f32 v84, v84, v100
  v_add_f32 v85, v85, v101
  v_add_f32 v86, v86, v102
  v_add_f32 v87, v87, v103
  v_exp_f32 v80, v80
  v_exp_f32 v81, v81
  v_exp_f32 v82, v82
  v_exp_f32 v83, v83
  v_exp_f32 v84, v84
  v_exp_f32 v85, v85
  v_exp_f32 v86, v86
  v_exp_f32 v87, v87
  v_cvt_pk_bf16_f32 v140, v80, v81
  v_cvt_pk_bf16_f32 v141, v82, v83
  v_cvt_pk_bf16_f32 v142, v84, v85
  v_cvt_pk_bf16_f32 v143, v86, v87
  s_nop 1
  v_mfma_f32_32x32x16_bf16 a[0:15], a[64:67], v[140:143], a[0:15]
L_as_58:
  s_nop 11
  v_accvgpr_read_b32 v144, a0
  v_accvgpr_read_b32 v145, a1
  v_accvgpr_read_b32 v146, a2
  v_accvgpr_read_b32 v147, a3
  v_accvgpr_read_b32 v148, a4
  v_accvgpr_read_b32 v149, a5
  v_accvgpr_read_b32 v150, a6
  v_accvgpr_read_b32 v151, a7
  v_accvgpr_read_b32 v152, a8
  v_rcp_f32 v153, v152
  s_nop 0
  v_mul_f32 v144, v144, v153
  v_mul_f32 v145, v145, v153
  v_mul_f32 v146, v146, v153
  v_mul_f32 v147, v147, v153
  v_mul_f32 v148, v148, v153
  v_mul_f32 v149, v149, v153
  v_mul_f32 v150, v150, v153
  v_mul_f32 v151, v151, v153
  v_cvt_pk_bf16_f32 v156, v144, v145
  v_cvt_pk_bf16_f32 v157, v146, v147
  v_cvt_pk_bf16_f32 v158, v148, v149
  v_cvt_pk_bf16_f32 v159, v150, v151
  s_nop 0
  v_permlane32_swap_b32 v156, v158
  v_permlane32_swap_b32 v157, v159
  s_add_u32 s6, s32, 15732736
  buffer_store_dwordx4 v[156:159], v162, s[56:59], s6 offen sc1
  s_barrier
  s_branch L_att_join
L_C7:
  s_barrier
  ds_read_b128 v[68:71], v12 offset:0
  ds_read_b64_tr_b16 v[72:73], v32 offset:8192
  ds_read_b64_tr_b16 v[74:75], v32 offset:8704
  ds_read_b64_tr_b16 v[76:77], v32 offset:16384
  ds_read_b64_tr_b16 v[78:79], v32 offset:16896
  ds_read_b64_tr_b16 v[80:81], v32 offset:24576
  ds_read_b64_tr_b16 v[82:83], v32 offset:25088
  ds_read_b128 v[84:87], v15 offset:0
  ds_read_b64_tr_b16 v[88:89], v32 offset:10240
  ds_read_b64_tr_b16 v[90:91], v32 offset:10752
  ds_read_b64_tr_b16 v[92:93], v32 offset:18432
  ds_read_b64_tr_b16 v[94:95], v32 offset:18944
  ds_read_b64_tr_b16 v[96:97], v32 offset:26624
  ds_read_b64_tr_b16 v[98:99], v32 offset:27136
  s_waitcnt lgkmcnt(7)
  v_mfma_f32_32x32x16_bf16 a[0:15], v[72:75], v[68:71], 0
  ds_read_b128 v[100:103], v18 offset:0
  ds_read_b64_tr_b16 v[104:105], v32 offset:12288
  ds_read_b64_tr_b16 v[106:107], v32 offset:12800
  v_mfma_f32_32x32x16_bf16 a[16:31], v[76:79], v[68:71], 0
  ds_read_b64_tr_b16 v[108:109], v32 offset:20480
  ds_read_b64_tr_b16 v[110:111], v32 offset:20992
  ds_read_b64_tr_b16 v[112:113], v32 offset:28672
  v_mfma_f32_32x32x16_bf16 a[32:47], v[68:71], v[80:83], 0
  ds_read_b64_tr_b16 v[114:115], v32 offset:29184
  s_waitcnt lgkmcnt(7)
  v_mfma_f32_32x32x16_bf16 a[0:15], v[88:91], v[84:87], a[0:15]
  ds_read_b128 v[116:119], v21 offset:0
  ds_read_b64_tr_b16 v[120:121], v32 offset:14336
  ds_read_b64_tr_b16 v[122:123], v32 offset:14848
  v_mfma_f32_32x32x16_bf16 a[16:31], v[92:95], v[84:87], a[16:31]
  ds_read_b64_tr_b16 v[124:125], v32 offset:22528
  ds_read_b64_tr_b16 v[126:127], v32 offset:23040
  ds_read_b64_tr_b16 v[128:129], v32 offset:30720
  v_mfma_f32_32x32x16_bf16 a[32:47], v[84:87], v[96:99], a[32:47]
  ds_read_b64_tr_b16 v[130:131], v32 offset:31232
  s_barrier
  s_waitcnt lgkmcnt(7)
  v_mfma_f32_32x32x16_bf16 a[0:15], v[104:107], v[100:103], a[0:15]
  ds_read_b128 v[68:71], v12 offset:32768
  ds_read_b64_tr_b16 v[72:73], v32 offset:40960
  ds_read_b64_tr_b16 v[74:75], v32 offset:41472
  v_mfma_f32_32x32x16_bf16 a[16:31], v[108:111], v[100:103], a[16:31]
  ds_read_b64_tr_b16 v[76:77], v32 offset:49152
  ds_read_b64_tr_b16 v[78:79], v32 offset:49664
  ds_read_b64_tr_b16 v[80:81], v32 offset:57344
  v_mfma_f32_32x32x16_bf16 a[32:47], v[100:103], v[112:115], a[32:47]
  ds_read_b64_tr_b16 v[82:83], v32 offset:57856
  s_waitcnt lgkmcnt(7)
  v_mfma_f32_32x32x16_bf16 a[0:15], v[120:123], v[116:119], a[0:15]
  ds_read_b128 v[84:87], v15 offset:32768
  ds_read_b64_tr_b16 v[88:89], v32 offset:43008
  ds_read_b64_tr_b16 v[90:91], v32 offset:43520
  v_mfma_f32_32x32x16_bf16 a[16:31], v[124:127], v[116:119], a[16:31]
  ds_read_b64_tr_b16 v[92:93], v32 offset:51200
  ds_read_b64_tr_b16 v[94:95], v32 offset:51712
  ds_read_b64_tr_b16 v[96:97], v32 offset:59392
  v_mfma_f32_32x32x16_bf16 a[32:47], v[116:119], v[128:131], a[32:47]
  ds_read_b64_tr_b16 v[98:99], v32 offset:59904
  s_waitcnt lgkmcnt(7)
  v_mfma_f32_32x32x16_bf16 a[0:15], v[72:75], v[68:71], a[0:15]
  ds_read_b128 v[100:103], v18 offset:32768
  ds_read_b64_tr_b16 v[104:105], v32 offset:45056
  ds_read_b64_tr_b16 v[106:107], v32 offset:45568
  v_mfma_f32_32x32x16_bf16 a[16:31], v[76:79], v[68:71], a[16:31]
  ds_read_b64_tr_b16 v[108:109], v32 offset:53248
  ds_read_b64_tr_b16 v[110:111], v32 offset:53760
  ds_read_b64_tr_b16 v[112:113], v32 offset:61440
  v_mfma_f32_32x32x16_bf16 a[32:47], v[68:71], v[80:83], a[32:47]
  ds_read_b64_tr_b16 v[114:115], v32 offset:61952
  s_waitcnt lgkmcnt(7)
  v_mfma_f32_32x32x16_bf16 a[0:15], v[88:91], v[84:87], a[0:15]
  ds_read_b128 v[116:119], v21 offset:32768
  ds_read_b64_tr_b16 v[120:121], v32 offset:47104
  ds_read_b64_tr_b16 v[122:123], v32 offset:47616
  v_mfma_f32_32x32x16_bf16 a[16:31], v[92:95], v[84:87], a[16:31]
  ds_read_b64_tr_b16 v[124:125], v32 offset:55296
  ds_read_b64_tr_b16 v[126:127], v32 offset:55808
  ds_read_b64_tr_b16 v[128:129], v32 offset:63488
  v_mfma_f32_32x32x16_bf16 a[32:47], v[84:87], v[96:99], a[32:47]
  ds_read_b64_tr_b16 v[130:131], v32 offset:64000
  s_barrier
  s_waitcnt lgkmcnt(7)
  v_mfma_f32_32x32x16_bf16 a[0:15], v[104:107], v[100:103], a[0:15]
  ds_read_b128 v[68:71], v13 offset:0
  ds_read_b64_tr_b16 v[72:73], v33 offset:8192
  ds_read_b64_tr_b16 v[74:75], v33 offset:8704
  v_mfma_f32_32x32x16_bf16 a[16:31], v[108:111], v[100:103], a[16:31]
  ds_read_b64_tr_b16 v[76:77], v33 offset:16384
  ds_read_b64_tr_b16 v[78:79], v33 offset:16896
  ds_read_b64_tr_b16 v[80:81], v33 offset:24576
  v_mfma_f32_32x32x16_bf16 a[32:47], v[100:103], v[112:115], a[32:47]
  ds_read_b64_tr_b16 v[82:83], v33 offset:25088
  s_waitcnt lgkmcnt(7)
  v_mfma_f32_32x32x16_bf16 a[0:15], v[120:123], v[116:119], a[0:15]
  ds_read_b128 v[84:87], v16 offset:0
  ds_read_b64_tr_b16 v[88:89], v33 offset:10240
  ds_read_b64_tr_b16 v[90:91], v33 offset:10752
  v_mfma_f32_32x32x16_bf16 a[16:31], v[124:127], v[116:119], a[16:31]
  ds_read_b64_tr_b16 v[92:93], v33 offset:18432
  ds_read_b64_tr_b16 v[94:95], v33 offset:18944
  ds_read_b64_tr_b16 v[96:97], v33 offset:26624
  v_mfma_f32_32x32x16_bf16 a[32:47], v[116:119], v[128:131], a[32:47]
  ds_read_b64_tr_b16 v[98:99], v33 offset:27136
  s_waitcnt lgkmcnt(7)
  v_mfma_f32_32x32x16_bf16 a[0:15], v[72:75], v[68:71], a[0:15]
  ds_read_b128 v[100:103], v19 offset:0
  ds_read_b64_tr_b16 v[104:105], v33 offset:12288
  ds_read_b64_tr_b16 v[106:107], v33 offset:12800
  v_mfma_f32_32x32x16_bf16 a[16:31], v[76:79], v[68:71], a[16:31]
  ds_read_b64_tr_b16 v[108:109], v33 offset:20480
  ds_read_b64_tr_b16 v[110:111], v33 offset:20992
  ds_read_b64_tr_b16 v[112:113], v33 offset:28672
  v_mfma_f32_32x32x16_bf16 a[32:47], v[68:71], v[80:83], a[32:47]
  ds_read_b64_tr_b16 v[114:115], v33 offset:29184
  s_waitcnt lgkmcnt(7)
  v_mfma_f32_32x32x16_bf16 a[0:15], v[88:91], v[84:87], a[0:15]
  ds_read_b128 v[116:119], v22 offset:0
  ds_read_b64_tr_b16 v[120:121], v33 offset:14336
  ds_read_b64_tr_b16 v[122:123], v33 offset:14848
  v_mfma_f32_32x32x16_bf16 a[16:31], v[92:95], v[84:87], a[16:31]
  ds_read_b64_tr_b16 v[124:125], v33 offset:22528
  ds_read_b64_tr_b16 v[126:127], v33 offset:23040
  ds_read_b64_tr_b16 v[128:129], v33 offset:30720
  v_mfma_f32_32x32x16_bf16 a[32:47], v[84:87], v[96:99], a[32:47]
  ds_read_b64_tr_b16 v[130:131], v33 offset:31232
  s_barrier
  s_waitcnt lgkmcnt(7)
  v_mfma_f32_32x32x16_bf16 a[0:15], v[104:107], v[100:103], a[0:15]
  ds_read_b128 v[68:71], v13 offset:32768
  ds_read_b64_tr_b16 v[72:73], v33 offset:40960
  ds_read_b64_tr_b16 v[74:75], v33 offset:41472
  v_mfma_f32_32x32x16_bf16 a[16:31], v[108:111], v[100:103], a[16:31]
  ds_read_b64_tr_b16 v[76:77], v33 offset:49152
  ds_read_b64_tr_b16 v[78:79], v33 offset:49664
  ds_read_b64_tr_b16 v[80:81], v33 offset:57344
  v_mfma_f32_32x32x16_bf16 a[32:47], v[100:103], v[112:115], a[32:47]
  ds_read_b64_tr_b16 v[82:83], v33 offset:57856
  s_waitcnt lgkmcnt(7)
  v_mfma_f32_32x32x16_bf16 a[0:15], v[120:123], v[116:119], a[0:15]
  ds_read_b128 v[84:87], v16 offset:32768
  ds_read_b64_tr_b16 v[88:89], v33 offset:43008
  ds_read_b64_tr_b16 v[90:91], v33 offset:43520
  v_mfma_f32_32x32x16_bf16 a[16:31], v[124:127], v[116:119], a[16:31]
  ds_read_b64_tr_b16 v[92:93], v33 offset:51200
  ds_read_b64_tr_b16 v[94:95], v33 offset:51712
  ds_read_b64_tr_b16 v[96:97], v33 offset:59392
  v_mfma_f32_32x32x16_bf16 a[32:47], v[116:119], v[128:131], a[32:47]
  ds_read_b64_tr_b16 v[98:99], v33 offset:59904
  s_waitcnt lgkmcnt(7)
  v_mfma_f32_32x32x16_bf16 a[0:15], v[72:75], v[68:71], a[0:15]
  ds_read_b128 v[100:103], v19 offset:32768
  ds_read_b64_tr_b16 v[104:105], v33 offset:45056
  ds_read_b64_tr_b16 v[106:107], v33 offset:45568
  v_mfma_f32_32x32x16_bf16 a[16:31], v[76:79], v[68:71], a[16:31]
  ds_read_b64_tr_b16 v[108:109], v33 offset:53248
  ds_read_b64_tr_b16 v[110:111], v33 offset:53760
  ds_read_b64_tr_b16 v[112:113], v33 offset:61440
  v_mfma_f32_32x32x16_bf16 a[32:47], v[68:71], v[80:83], a[32:47]
  ds_read_b64_tr_b16 v[114:115], v33 offset:61952
  s_waitcnt lgkmcnt(7)
  v_mfma_f32_32x32x16_bf16 a[0:15], v[88:91], v[84:87], a[0:15]
  ds_read_b128 v[116:119], v22 offset:32768
  ds_read_b64_tr_b16 v[120:121], v33 offset:47104
  ds_read_b64_tr_b16 v[122:123], v33 offset:47616
  v_mfma_f32_32x32x16_bf16 a[16:31], v[92:95], v[84:87], a[16:31]
  ds_read_b64_tr_b16 v[124:125], v33 offset:55296
  ds_read_b64_tr_b16 v[126:127], v33 offset:55808
  ds_read_b64_tr_b16 v[128:129], v33 offset:63488
  v_mfma_f32_32x32x16_bf16 a[32:47], v[84:87], v[96:99], a[32:47]
  ds_read_b64_tr_b16 v[130:131], v33 offset:64000
  s_barrier
  s_waitcnt lgkmcnt(7)
  v_mfma_f32_32x32x16_bf16 a[0:15], v[104:107], v[100:103], a[0:15]
  ds_read_b128 v[68:71], v14 offset:0
  ds_read_b64_tr_b16 v[72:73], v34 offset:8192
  ds_read_b64_tr_b16 v[74:75], v34 offset:8704
  v_mfma_f32_32x32x16_bf16 a[16:31], v[108:111], v[100:103], a[16:31]
  ds_read_b64_tr_b16 v[76:77], v32 offset:0
  ds_read_b64_tr_b16 v[78:79], v32 offset:512
  ds_read_b64_tr_b16 v[80:81], v32 offset:8192
  v_mfma_f32_32x32x16_bf16 a[32:47], v[100:103], v[112:115], a[32:47]
  ds_read_b64_tr_b16 v[82:83], v32 offset:8704
  s_waitcnt lgkmcnt(7)
  v_mfma_f32_32x32x16_bf16 a[0:15], v[120:123], v[116:119], a[0:15]
  ds_read_b128 v[84:87], v17 offset:0
  ds_read_b64_tr_b16 v[88:89], v34 offset:10240
  ds_read_b64_tr_b16 v[90:91], v34 offset:10752
  v_mfma_f32_32x32x16_bf16 a[16:31], v[124:127], v[116:119], a[16:31]
  ds_read_b64_tr_b16 v[92:93], v32 offset:2048
  ds_read_b64_tr_b16 v[94:95], v32 offset:2560
  ds_read_b64_tr_b16 v[96:97], v32 offset:10240
  v_mfma_f32_32x32x16_bf16 a[32:47], v[116:119], v[128:131], a[32:47]
  ds_read_b64_tr_b16 v[98:99], v32 offset:10752
  s_waitcnt lgkmcnt(7)
  v_mfma_f32_32x32x16_bf16 a[0:15], v[72:75], v[68:71], a[0:15]
  ds_read_b128 v[100:103], v20 offset:0
  ds_read_b64_tr_b16 v[104:105], v34 offset:12288
  ds_read_b64_tr_b16 v[106:107], v34 offset:12800
  v_mfma_f32_32x32x16_bf16 a[16:31], v[76:79], v[68:71], a[16:31]
  ds_read_b64_tr_b16 v[108:109], v32 offset:4096
  ds_read_b64_tr_b16 v[110:111], v32 offset:4608
  ds_read_b64_tr_b16 v[112:113], v32 offset:12288
  v_mfma_f32_32x32x16_bf16 a[32:47], v[68:71], v[80:83], a[32:47]
  ds_read_b64_tr_b16 v[114:115], v32 offset:12800
  s_waitcnt lgkmcnt(7)
  v_mfma_f32_32x32x16_bf16 a[0:15], v[88:91], v[84:87], a[0:15]
  ds_read_b128 v[116:119], v23 offset:0
  ds_read_b64_tr_b16 v[120:121], v34 offset:14336
  ds_read_b64_tr_b16 v[122:123], v34 offset:14848
  v_mfma_f32_32x32x16_bf16 a[16:31], v[92:95], v[84:87], a[16:31]
  ds_read_b64_tr_b16 v[124:125], v32 offset:6144
  ds_read_b64_tr_b16 v[126:127], v32 offset:6656
  ds_read_b64_tr_b16 v[128:129], v32 offset:14336
  v_mfma_f32_32x32x16_bf16 a[32:47], v[84:87], v[96:99], a[32:47]
  ds_read_b64_tr_b16 v[130:131], v32 offset:14848
  s_barrier
  s_waitcnt lgkmcnt(7)
  v_mfma_f32_32x32x16_bf16 a[0:15], v[104:107], v[100:103], a[0:15]
  ds_read_b128 v[68:71], v12 offset:16384
  ds_read_b64_tr_b16 v[72:73], v32 offset:24576
  ds_read_b64_tr_b16 v[74:75], v32 offset:25088
  v_mfma_f32_32x32x16_bf16 a[16:31], v[108:111], v[100:103], a[16:31]
  ds_read_b64_tr_b16 v[76:77], v34 offset:16384
  ds_read_b64_tr_b16 v[78:79], v34 offset:16896
  ds_read_b64_tr_b16 v[80:81], v32 offset:32768
  v_mfma_f32_32x32x16_bf16 a[32:47], v[100:103], v[112:115], a[32:47]
  ds_read_b64_tr_b16 v[82:83], v32 offset:33280
  s_waitcnt lgkmcnt(7)
  v_mfma_f32_32x32x16_bf16 a[0:15], v[120:123], v[116:119], a[0:15]
  ds_read_b128 v[84:87], v15 offset:16384
  ds_read_b64_tr_b16 v[88:89], v32 offset:26624
  ds_read_b64_tr_b16 v[90:91], v32 offset:27136
  v_mfma_f32_32x32x16_bf16 a[16:31], v[124:127], v[116:119], a[16:31]
  ds_read_b64_tr_b16 v[92:93], v34 offset:18432
  ds_read_b64_tr_b16 v[94:95], v34 offset:18944
  ds_read_b64_tr_b16 v[96:97], v32 offset:34816
  v_mfma_f32_32x32x16_bf16 a[32:47], v[116:119], v[128:131], a[32:47]
  ds_read_b64_tr_b16 v[98:99], v32 offset:35328
  s_waitcnt lgkmcnt(7)
  v_mfma_f32_32x32x16_bf16 a[0:15], v[72:75], v[68:71], a[0:15]
  ds_read_b128 v[100:103], v18 offset:16384
  ds_read_b64_tr_b16 v[104:105], v32 offset:28672
  ds_read_b64_tr_b16 v[106:107], v32 offset:29184
  v_mfma_f32_32x32x16_bf16 a[16:31], v[76:79], v[68:71], a[16:31]
  ds_read_b64_tr_b16 v[108:109], v34 offset:20480
  ds_read_b64_tr_b16 v[110:111], v34 offset:20992
  ds_read_b64_tr_b16 v[112:113], v32 offset:36864
  v_mfma_f32_32x32x16_bf16 a[32:47], v[68:71], v[80:83], a[32:47]
  ds_read_b64_tr_b16 v[114:115], v32 offset:37376
  s_waitcnt lgkmcnt(7)
  v_mfma_f32_32x32x16_bf16 a[0:15], v[88:91], v[84:87], a[0:15]
  ds_read_b128 v[116:119], v21 offset:16384
  ds_read_b64_tr_b16 v[120:121], v32 offset:30720
  ds_read_b64_tr_b16 v[122:123], v32 offset:31232
  v_mfma_f32_32x32x16_bf16 a[16:31], v[92:95], v[84:87], a[16:31]
  ds_read_b64_tr_b16 v[124:125], v34 offset:22528
  ds_read_b64_tr_b16 v[126:127], v34 offset:23040
  ds_read_b64_tr_b16 v[128:129], v32 offset:38912
  v_mfma_f32_32x32x16_bf16 a[32:47], v[84:87], v[96:99], a[32:47]
  ds_read_b64_tr_b16 v[130:131], v32 offset:39424
  s_barrier
  s_waitcnt lgkmcnt(7)
  v_mfma_f32_32x32x16_bf16 a[0:15], v[104:107], v[100:103], a[0:15]
  ds_read_b128 v[68:71], v12 offset:40960
  ds_read_b64_tr_b16 v[72:73], v32 offset:49152
  ds_read_b64_tr_b16 v[74:75], v32 offset:49664
  v_mfma_f32_32x32x16_bf16 a[16:31], v[108:111], v[100:103], a[16:31]
  ds_read_b64_tr_b16 v[76:77], v32 offset:57344
  ds_read_b64_tr_b16 v[78:79], v32 offset:57856
  ds_read_b64_tr_b16 v[80:81], v33 offset:0
  v_mfma_f32_32x32x16_bf16 a[32:47], v[100:103], v[112:115], a[32:47]
  ds_read_b64_tr_b16 v[82:83], v33 offset:512
  s_waitcnt lgkmcnt(7)
  v_mfma_f32_32x32x16_bf16 a[0:15], v[120:123], v[116:119], a[0:15]
  ds_read_b128 v[84:87], v15 offset:40960
  ds_read_b64_tr_b16 v[88:89], v32 offset:51200
  ds_read_b64_tr_b16 v[90:91], v32 offset:51712
  v_mfma_f32_32x32x16_bf16 a[16:31], v[124:127], v[116:119], a[16:31]
  ds_read_b64_tr_b16 v[92:93], v32 offset:59392
  ds_read_b64_tr_b16 v[94:95], v32 offset:59904
  ds_read_b64_tr_b16 v[96:97], v33 offset:2048
  v_mfma_f32_32x32x16_bf16 a[32:47], v[116:119], v[128:131], a[32:47]
  ds_read_b64_tr_b16 v[98:99], v33 offset:2560
  s_waitcnt lgkmcnt(7)
  v_mfma_f32_32x32x16_bf16 a[0:15], v[72:75], v[68:71], a[0:15]
  ds_read_b128 v[100:103], v18 offset:40960
  ds_read_b64_tr_b16 v[104:105], v32 offset:53248
  ds_read_b64_tr_b16 v[106:107], v32 offset:53760
  v_mfma_f32_32x32x16_bf16 a[16:31], v[76:79], v[68:71], a[16:31]
  ds_read_b64_tr_b16 v[108:109], v32 offset:61440
  ds_read_b64_tr_b16 v[110:111], v32 offset:61952
  ds_read_b64_tr_b16 v[112:113], v33 offset:4096
  v_mfma_f32_32x32x16_bf16 a[32:47], v[68:71], v[80:83], a[32:47]
  ds_read_b64_tr_b16 v[114:115], v33 offset:4608
  s_waitcnt lgkmcnt(7)
  v_mfma_f32_32x32x16_bf16 a[0:15], v[88:91], v[84:87], a[0:15]
  ds_read_b128 v[116:119], v21 offset:40960
  ds_read_b64_tr_b16 v[120:121], v32 offset:55296
  ds_read_b64_tr_b16 v[122:123], v32 offset:55808
  v_mfma_f32_32x32x16_bf16 a[16:31], v[92:95], v[84:87], a[16:31]
  ds_read_b64_tr_b16 v[124:125], v32 offset:63488
  ds_read_b64_tr_b16 v[126:127], v32 offset:64000
  ds_read_b64_tr_b16 v[128:129], v33 offset:6144
  v_mfma_f32_32x32x16_bf16 a[32:47], v[84:87], v[96:99], a[32:47]
  ds_read_b64_tr_b16 v[130:131], v33 offset:6656
  s_barrier
  s_waitcnt lgkmcnt(7)
  v_mfma_f32_32x32x16_bf16 a[0:15], v[104:107], v[100:103], a[0:15]
  ds_read_b128 v[68:71], v13 offset:8192
  ds_read_b64_tr_b16 v[72:73], v33 offset:16384
  ds_read_b64_tr_b16 v[74:75], v33 offset:16896
  v_mfma_f32_32x32x16_bf16 a[16:31], v[108:111], v[100:103], a[16:31]
  ds_read_b64_tr_b16 v[76:77], v33 offset:24576
  ds_read_b64_tr_b16 v[78:79], v33 offset:25088
  ds_read_b64_tr_b16 v[80:81], v33 offset:32768
  v_mfma_f32_32x32x16_bf16 a[32:47], v[100:103], v[112:115], a[32:47]
  ds_read_b64_tr_b16 v[82:83], v33 offset:33280
  s_waitcnt lgkmcnt(7)
  v_mfma_f32_32x32x16_bf16 a[0:15], v[120:123], v[116:119], a[0:15]
  ds_read_b128 v[84:87], v16 offset:8192
  ds_read_b64_tr_b16 v[88:89], v33 offset:18432
  ds_read_b64_tr_b16 v[90:91], v33 offset:18944
  v_mfma_f32_32x32x16_bf16 a[16:31], v[124:127], v[116:119], a[16:31]
  ds_read_b64_tr_b16 v[92:93], v33 offset:26624
  ds_read_b64_tr_b16 v[94:95], v33 offset:27136
  ds_read_b64_tr_b16 v[96:97], v33 offset:34816
  v_mfma_f32_32x32x16_bf16 a[32:47], v[116:119], v[128:131], a[32:47]
  ds_read_b64_tr_b16 v[98:99], v33 offset:35328
  s_waitcnt lgkmcnt(7)
  v_mfma_f32_32x32x16_bf16 a[0:15], v[72:75], v[68:71], a[0:15]
  ds_read_b128 v[100:103], v19 offset:8192
  ds_read_b64_tr_b16 v[104:105], v33 offset:20480
  ds_read_b64_tr_b16 v[106:107], v33 offset:20992
  v_mfma_f32_32x32x16_bf16 a[16:31], v[76:79], v[68:71], a[16:31]
  ds_read_b64_tr_b16 v[108:109], v33 offset:28672
  ds_read_b64_tr_b16 v[110:111], v33 offset:29184
  ds_read_b64_tr_b16 v[112:113], v33 offset:36864
  v_mfma_f32_32x32x16_bf16 a[32:47], v[68:71], v[80:83], a[32:47]
  ds_read_b64_tr_b16 v[114:115], v33 offset:37376
  s_waitcnt lgkmcnt(7)
  v_mfma_f32_32x32x16_bf16 a[0:15], v[88:91], v[84:87], a[0:15]
  ds_read_b128 v[116:119], v22 offset:8192
  ds_read_b64_tr_b16 v[120:121], v33 offset:22528
  ds_read_b64_tr_b16 v[122:123], v33 offset:23040
  v_mfma_f32_32x32x16_bf16 a[16:31], v[92:95], v[84:87], a[16:31]
  ds_read_b64_tr_b16 v[124:125], v33 offset:30720
  ds_read_b64_tr_b16 v[126:127], v33 offset:31232
  ds_read_b64_tr_b16 v[128:129], v33 offset:38912
  v_mfma_f32_32x32x16_bf16 a[32:47], v[84:87], v[96:99], a[32:47]
  ds_read_b64_tr_b16 v[130:131], v33 offset:39424
  s_barrier
  s_waitcnt lgkmcnt(7)
  v_mfma_f32_32x32x16_bf16 a[0:15], v[104:107], v[100:103], a[0:15]
  v_mfma_f32_32x32x16_bf16 a[16:31], v[108:111], v[100:103], a[16:31]
  v_mfma_f32_32x32x16_bf16 a[32:47], v[100:103], v[112:115], a[32:47]
  s_waitcnt lgkmcnt(0)
  v_mfma_f32_32x32x16_bf16 a[0:15], v[120:123], v[116:119], a[0:15]
  v_mfma_f32_32x32x16_bf16 a[16:31], v[124:127], v[116:119], a[16:31]
  v_mfma_f32_32x32x16_bf16 a[32:47], v[116:119], v[128:131], a[32:47]
  s_lshl_b32 s26, s9, 1
  s_add_u32 s26, s26, s53
  s_lshl_b32 s26, s26, 17
  s_lshl_b32 s27, s8, 11
  s_add_u32 s26, s26, s27
  s_lshl_b32 s27, s52, 10
  s_add_u32 s26, s26, s27
  v_lshlrev_b32 v1, 5, v5
  v_lshl_add_u32 v1, v6, 4, v1
  v_lshrrev_b32 v2, 3, v5
  v_and_b32 v2, 1, v2
  v_lshlrev_b32 v2, 4, v2
  v_xor_b32 v2, v2, v1
  v_and_b32 v3, 15, v5
  v_lshrrev_b32 v4, 3, v3
  v_xor_b32 v4, v4, v6
  v_lshlrev_b32 v4, 4, v4
  v_lshl_add_u32 v4, v3, 5, v4
  v_lshrrev_b32 v3, 4, v5
  v_lshl_add_u32 v3, v3, 16, v4
  v_accvgpr_read_b32 v164, a16
  v_accvgpr_read_b32 v165, a17
  v_accvgpr_read_b32 v166, a18
  v_accvgpr_read_b32 v167, a19
  v_accvgpr_read_b32 v168, a20
  v_accvgpr_read_b32 v169, a21
  v_accvgpr_read_b32 v170, a22
  v_accvgpr_read_b32 v171, a23
  v_cvt_pk_bf16_f32 v152, v164, v165
  v_cvt_pk_bf16_f32 v153, v166, v167
  v_cvt_pk_bf16_f32 v154, v168, v169
  v_cvt_pk_bf16_f32 v155, v170, v171
  s_nop 0
  v_permlane32_swap_b32 v152, v154
  v_permlane32_swap_b32 v153, v155
  s_add_u32 s27, s26, 3145728
  buffer_store_dwordx4 v[152:155], v2, s[56:59], s27 offen sc1
  v_accvgpr_read_b32 v172, a24
  v_accvgpr_read_b32 v173, a25
  v_accvgpr_read_b32 v174, a26
  v_accvgpr_read_b32 v175, a27
  v_accvgpr_read_b32 v176, a28
  v_accvgpr_read_b32 v177, a29
  v_accvgpr_read_b32 v178, a30
  v_accvgpr_read_b32 v179, a31
  v_cvt_pk_bf16_f32 v156, v172, v173
  v_cvt_pk_bf16_f32 v157, v174, v175
  v_cvt_pk_bf16_f32 v158, v176, v177
  v_cvt_pk_bf16_f32 v159, v178, v179
  s_nop 0
  v_permlane32_swap_b32 v156, v158
  v_permlane32_swap_b32 v157, v159
  s_add_u32 s27, s26, 3211264
  buffer_store_dwordx4 v[156:159], v2, s[56:59], s27 offen sc1
  s_add_u32 s28, s26, 5242880
  v_accvgpr_read_b32 v164, a32
  v_accvgpr_read_b32 v165, a33
  v_accvgpr_read_b32 v166, a34
  v_accvgpr_read_b32 v167, a35
  v_accvgpr_read_b32 v168, a36
  v_accvgpr_read_b32 v169, a37
  v_accvgpr_read_b32 v170, a38
  v_accvgpr_read_b32 v171, a39
  v_cvt_pk_bf16_f32 v160, v164, v165
  v_cvt_pk_bf16_f32 v161, v166, v167
  v_cvt_pk_bf16_f32 v162, v168, v169
  v_cvt_pk_bf16_f32 v163, v170, v171
  buffer_store_dwordx4 v[160:163], v3, s[56:59], s28 offen offset:0 sc1
  v_accvgpr_read_b32 v172, a40
  v_accvgpr_read_b32 v173, a41
  v_accvgpr_read_b32 v174, a42
  v_accvgpr_read_b32 v175, a43
  v_accvgpr_read_b32 v176, a44
  v_accvgpr_read_b32 v177, a45
  v_accvgpr_read_b32 v178, a46
  v_accvgpr_read_b32 v179, a47
  v_cvt_pk_bf16_f32 v152, v172, v173
  v_cvt_pk_bf16_f32 v153, v174, v175
  v_cvt_pk_bf16_f32 v154, v176, v177
  v_cvt_pk_bf16_f32 v155, v178, v179
  buffer_store_dwordx4 v[152:155], v3, s[56:59], s28 offen offset:512 sc1
  v_accvgpr_read_b32 v164, a0
  v_accvgpr_read_b32 v165, a1
  v_accvgpr_read_b32 v166, a2
  v_accvgpr_read_b32 v167, a3
  v_accvgpr_read_b32 v168, a4
  v_accvgpr_read_b32 v169, a5
  v_accvgpr_read_b32 v170, a6
  v_accvgpr_read_b32 v171, a7
  v_mul_f32 v164, 0x3eb8aa3b, v164
  v_mul_f32 v165, 0x3eb8aa3b, v165
  v_mul_f32 v166, 0x3eb8aa3b, v166
  v_mul_f32 v167, 0x3eb8aa3b, v167
  v_mul_f32 v168, 0x3eb8aa3b, v168
  v_mul_f32 v169, 0x3eb8aa3b, v169
  v_mul_f32 v170, 0x3eb8aa3b, v170
  v_mul_f32 v171, 0x3eb8aa3b, v171
  v_cvt_pk_bf16_f32 v156, v164, v165
  v_cvt_pk_bf16_f32 v157, v166, v167
  v_cvt_pk_bf16_f32 v158, v168, v169
  v_cvt_pk_bf16_f32 v159, v170, v171
  s_nop 0
  v_permlane32_swap_b32 v156, v158
  v_permlane32_swap_b32 v157, v159
  s_add_u32 s27, s26, 1048576
  buffer_store_dwordx4 v[156:159], v1, s[56:59], s27 offen sc1
  v_accvgpr_read_b32 v172, a8
  v_accvgpr_read_b32 v173, a9
  v_accvgpr_read_b32 v174, a10
  v_accvgpr_read_b32 v175, a11
  v_accvgpr_read_b32 v176, a12
  v_accvgpr_read_b32 v177, a13
  v_accvgpr_read_b32 v178, a14
  v_accvgpr_read_b32 v179, a15
  v_mul_f32 v172, 0x3eb8aa3b, v172
  v_mul_f32 v173, 0x3eb8aa3b, v173
  v_mul_f32 v174, 0x3eb8aa3b, v174
  v_mul_f32 v175, 0x3eb8aa3b, v175
  v_mul_f32 v176, 0x3eb8aa3b, v176
  v_mul_f32 v177, 0x3eb8aa3b, v177
  v_mul_f32 v178, 0x3eb8aa3b, v178
  v_mul_f32 v179, 0x3eb8aa3b, v179
  v_cvt_pk_bf16_f32 v160, v172, v173
  v_cvt_pk_bf16_f32 v161, v174, v175
  v_cvt_pk_bf16_f32 v162, v176, v177
  v_cvt_pk_bf16_f32 v163, v178, v179
  s_nop 0
  v_permlane32_swap_b32 v160, v162
  v_permlane32_swap_b32 v161, v163
  s_add_u32 s27, s26, 1114112
  buffer_store_dwordx4 v[160:163], v1, s[56:59], s27 offen sc1
  s_waitcnt vmcnt(0)
  s_barrier
  s_mul_i32 s54, s8, 8
  s_add_u32 s54, s54, s9
  s_lshl_b32 s54, s54, 7
  s_add_u32 s54, s54, 36864
  s_cmp_eq_u32 s3, 0
  s_cselect_b32 exec_lo, 1, 0
  s_mov_b32 exec_hi, 0
  buffer_store_dword v7, v8, s[56:59], s54 offen sc1
  s_mov_b64 exec, -1
  s_cmp_lg_u32 s3, 0
  s_cbranch_scc1 L_pjw_143
  s_lshl_b32 s54, s8, 4
  s_add_u32 s54, s54, 0
  s_mul_i32 s54, s54, 3584
  v_lshrrev_b32 v1, 4, v0
  v_mul_u32_u24 v1, 3584, v1
  v_and_b32 v3, 15, v0
  v_min_u32 v3, 13, v3
  v_lshl_add_u32 v1, v3, 7, v1
  buffer_load_dword v2, v1, s[4:7], s54 offen
  s_lshl_b32 s54, s8, 18
  s_add_u32 s54, s54, 0
  v_lshlrev_b32 v1, 12, v0
  buffer_load_dword v2, v1, s[84:87], s54 offen
  s_lshl_b32 s54, s8, 18
  s_add_u32 s54, s54, 512
  v_lshlrev_b32 v1, 12, v0
  buffer_load_dword v2, v1, s[84:87], s54 offen
  s_branch L_pj_142
L_pjw_143:
  s_cmp_lg_u32 s3, 1
  s_cbranch_scc1 L_pjw_144
  s_lshl_b32 s54, s8, 4
  s_add_u32 s54, s54, 4
  s_mul_i32 s54, s54, 3584
  v_lshrrev_b32 v1, 4, v0
  v_mul_u32_u24 v1, 3584, v1
  v_and_b32 v3, 15, v0
  v_min_u32 v3, 13, v3
  v_lshl_add_u32 v1, v3, 7, v1
  buffer_load_dword v2, v1, s[4:7], s54 offen
  s_lshl_b32 s54, s8, 18
  s_add_u32 s54, s54, 128
  v_lshlrev_b32 v1, 12, v0
  buffer_load_dword v2, v1, s[84:87], s54 offen
  s_lshl_b32 s54, s8, 18
  s_add_u32 s54, s54, 640
  v_lshlrev_b32 v1, 12, v0
  buffer_load_dword v2, v1, s[84:87], s54 offen
  s_branch L_pj_142
L_pjw_144:
  s_cmp_lg_u32 s3, 2
  s_cbranch_scc1 L_pjw_145
  s_lshl_b32 s54, s8, 4
  s_add_u32 s54, s54, 8
  s_mul_i32 s54, s54, 3584
  v_lshrrev_b32 v1, 4, v0
  v_mul_u32_u24 v1, 3584, v1
  v_and_b32 v3, 15, v0
  v_min_u32 v3, 13, v3
  v_lshl_add_u32 v1, v3, 7, v1
  buffer_load_dword v2, v1, s[4:7], s54 offen
  s_lshl_b32 s54, s8, 18
  s_add_u32 s54, s54, 256
  v_lshlrev_b32 v1, 12, v0
  buffer_load_dword v2, v1, s[84:87], s54 offen
  s_branch L_pj_142
L_pjw_145:
  s_cmp_lg_u32 s3, 3
  s_cbranch_scc1 L_pjw_146
  s_lshl_b32 s54, s8, 4
  s_add_u32 s54, s54, 12
  s_mul_i32 s54, s54, 3584
  v_lshrrev_b32 v1, 4, v0
  v_mul_u32_u24 v1, 3584, v1
  v_and_b32 v3, 15, v0
  v_min_u32 v3, 13, v3
  v_lshl_add_u32 v1, v3, 7, v1
  buffer_load_dword v2, v1, s[4:7], s54 offen
  s_lshl_b32 s54, s8, 18
  s_add_u32 s54, s54, 384
  v_lshlrev_b32 v1, 12, v0
  buffer_load_dword v2, v1, s[84:87], s54 offen
  s_branch L_pj_142
L_pjw_146:
L_pj_142:
  v_lshrrev_b32 v1, 4, v0
  v_and_b32 v1, 1, v1
  v_and_b32 v2, 3, v0
  v_lshlrev_b32 v2, 3, v2
  v_lshl_add_u32 v2, v1, 11, v2
  s_lshl_b32 s54, s53, 13
  v_add_u32 v2, s54, v2
  v_xor_b32 v3, 0, v1
  v_lshlrev_b32 v3, 2, v3
  v_add_u32 v3, v3, v24
  v_lshl_add_u32 v35, v3, 5, v2
  v_add_u32 v138, 0x10000, v35
  v_add_u32 v139, 0x20000, v35
  v_xor_b32 v3, 1, v1
  v_lshlrev_b32 v3, 2, v3
  v_add_u32 v3, v3, v24
  v_lshl_add_u32 v140, v3, 5, v2
  v_add_u32 v141, 0x10000, v140
  v_add_u32 v142, 0x20000, v140
  v_lshrrev_b32 v1, 3, v5
  v_and_b32 v1, 1, v1
  v_xor_b32 v1, v1, v6
  v_lshlrev_b32 v1, 4, v1
  v_lshl_add_u32 v1, v5, 5, v1
  s_lshl_b32 s54, s52, 10
  v_add_u32 v144, s54, v1
  v_add_u32 v145, 0x10000, v144
  v_add_u32 v146, 0x20000, v144
  s_mov_b32 s20, s84
  s_mov_b32 s21, s85
  s_and_b32 s22, s13, 8388608
  s_mov_b32 s23, 0x20000
  s_lshl_b32 s14, s3, 11
  v_lshrrev_b32 v1, 3, v0
  s_lshl_b32 s54, s3, 4
  v_add_u32 v1, s54, v1
  v_lshlrev_b32 v1, 12, v1
  v_lshrrev_b32 v2, 4, v0
  v_and_b32 v3, 7, v0
  v_xor_b32 v2, v2, v3
  v_lshl_add_u32 v26, v2, 4, v1
  v_xor_b32 v2, 4, v2
  v_lshl_add_u32 v27, v2, 4, v1
  v_add_u32 v27, 31744, v27
  v_lshlrev_b32 v28, 4, v0
  s_lshl_b32 s16, s8, 18
  s_lshl_b32 s17, s9, 19
  s_add_u32 s17, s17, s14
  s_add_u32 s17, s17, 7340032
  s_and_b32 s18, s8, 7
  s_mul_i32 s18, s18, 0
  s_and_b32 s54, s9, 3
  s_mul_i32 s54, s54, 0
  s_add_u32 s18, s18, s54
  s_add_u32 s18, s18, 2
  s_and_b32 s18, s18, 31
  s_and_b32 s19, s8, 7
  s_mul_i32 s19, s19, 0
  s_and_b32 s54, s9, 3
  s_mul_i32 s54, s54, 0
  s_add_u32 s19, s19, s54
  s_add_u32 s19, s19, 1
  s_and_b32 s19, s19, 31
  s_barrier
  ds_read_b128 v[68:71], v12 offset:16384
  ds_read_b64_tr_b16 v[72:73], v35 offset:0
  ds_read_b64_tr_b16 v[74:75], v140 offset:0
  ds_read_b64_tr_b16 v[76:77], v35 offset:4096
  ds_read_b64_tr_b16 v[78:79], v140 offset:4096
  ds_read_b128 v[84:87], v15 offset:16384
  ds_read_b64_tr_b16 v[88:89], v35 offset:512
  ds_read_b64_tr_b16 v[90:91], v140 offset:512
  ds_read_b64_tr_b16 v[92:93], v35 offset:4608
  ds_read_b64_tr_b16 v[94:95], v140 offset:4608
  s_branch L_C_gentry
L_L7:
  s_mov_b32 s48, s18
  s_and_b32 s49, s19, 0xffff
  s_mov_b32 s50, 1572864
  s_mov_b32 s51, 0x20000
  s_mov_b32 s52, s32
  s_and_b32 s53, s33, 0xffff
  s_mov_b32 s54, 1024
  s_mov_b32 s55, 0x20000
  s_mov_b32 s56, s38
  s_and_b32 s57, s39, 0xffff
  s_mov_b32 s58, 33554432
  s_mov_b32 s59, 0x20000
  s_mov_b32 s80, s38
  s_and_b32 s81, s39, 0xffff
  s_and_b32 s82, s13, 33554432
  s_mov_b32 s83, 0x20000
  s_mov_b32 s76, s26
  s_and_b32 s77, s27, 0xffff
  s_and_b32 s78, s13, 8388608
  s_mov_b32 s79, 0x20000
  s_mov_b32 s60, s20
  s_and_b32 s61, s21, 0xffff
  s_mov_b32 s62, 524288
  s_mov_b32 s63, 0x20000
  s_mov_b32 s64, s30
  s_and_b32 s65, s31, 0xffff
  s_mov_b32 s66, 917504
  s_mov_b32 s67, 0x20000
  s_mov_b32 s14, s75
  s_mov_b32 s15, s75
  s_mov_b32 s16, s75
  s_mov_b32 s17, s75
  s_mov_b32 s18, s75
  s_mul_i32 s19, s73, 0
  s_mul_i32 s6, s74, 0
  s_add_u32 s19, s19, s6
  s_and_b32 s19, s19, 31
  s_mov_b32 s20, s19
  s_lshl_b32 s21, s73, 1
  s_mul_i32 s6, s74, 3
  s_add_u32 s21, s21, s6
  s_cmp_ge_u32 s21, 14
  s_cselect_b32 s6, 14, 0
  s_sub_u32 s21, s21, s6
  s_mov_b32 s22, s21
  v_lshrrev_b32 v1, 4, v0
  v_and_b32 v1, 1, v1
  v_and_b32 v2, 7, v0
  v_lshrrev_b32 v3, 2, v2
  v_xor_b32 v3, v3, v1
  v_lshlrev_b32 v3, 2, v3
  v_and_b32 v2, 3, v2
  v_or_b32 v2, v2, v3
  v_lshrrev_b32 v1, 3, v0
  s_lshl_b32 s6, s4, 4
  v_add_u32 v1, s6, v1
  s_mov_b32 s6, 3072
  v_mul_lo_u32 v1, v1, s6
  v_lshl_add_u32 v9, v2, 4, v1
  v_add_u32 v10, 23552, v9
  v_lshlrev_b32 v11, 4, v0
  s_mov_b32 m0, 155648
  s_nop 0
  buffer_load_dwordx4 v11, s[52:55], 0 offen lds
  v_lshrrev_b32 v1, 4, v0
  v_lshlrev_b32 v1, 4, v1
  v_add_u32 v28, 155648, v1
  v_and_b32 v1, 15, v0
  s_lshl_b32 s6, s4, 4
  v_add_u32 v1, s6, v1
  v_lshrrev_b32 v2, 1, v1
  v_and_b32 v2, 7, v2
  v_lshrrev_b32 v3, 4, v0
  v_add_u32 v4, 0, v3
  v_xor_b32 v4, v4, v2
  v_lshlrev_b32 v4, 4, v4
  v_lshl_add_u32 v29, v1, 7, v4
  v_add_u32 v30, 0x10000, v29
  v_add_u32 v31, 0x20000, v29
  v_add_u32 v4, 4, v3
  v_xor_b32 v4, v4, v2
  v_lshlrev_b32 v4, 4, v4
  v_lshl_add_u32 v32, v1, 7, v4
  v_add_u32 v33, 0x10000, v32
  v_add_u32 v34, 0x20000, v32
  s_add_u32 m0, s5, 0
  s_lshl_b32 s68, s84, 7
  s_add_u32 s68, s68, s69
  buffer_load_dwordx4 v5, s[40:43], s68 offen lds
  buffer_load_dwordx4 v6, s[40:43], s68 offen offset:1024 lds
  s_add_u32 m0, s5, 8192
  s_mul_i32 s68, s14, 196608
  s_add_u32 s68, s68, s72
  buffer_load_dwordx4 v9, s[48:51], s68 offen lds
  buffer_load_dwordx4 v10, s[48:51], s68 offen offset:1024 lds
  s_add_u32 m0, s5, 16384
  s_mul_i32 s68, s14, 196608
  s_add_u32 s68, s68, s72
  s_add_u32 s68, s68, 1024
  buffer_load_dwordx4 v9, s[48:51], s68 offen lds
  buffer_load_dwordx4 v10, s[48:51], s68 offen offset:1024 lds
  s_add_u32 m0, s5, 24576
  s_mul_i32 s68, s14, 196608
  s_add_u32 s68, s68, s72
  s_add_u32 s68, s68, 2048
  buffer_load_dwordx4 v9, s[48:51], s68 offen lds
  buffer_load_dwordx4 v10, s[48:51], s68 offen offset:1024 lds
  s_add_u32 s84, s84, 1
  s_and_b32 s84, s84, 7
  s_add_u32 m0, s5, 32768
  s_lshl_b32 s68, s84, 7
  s_add_u32 s68, s68, s69
  buffer_load_dwordx4 v5, s[40:43], s68 offen lds
  buffer_load_dwordx4 v6, s[40:43], s68 offen offset:1024 lds
  s_add_u32 s14, s14, 1
  s_and_b32 s14, s14, 7
  s_add_u32 m0, s5, 40960
  s_mul_i32 s68, s14, 196608
  s_add_u32 s68, s68, s72
  buffer_load_dwordx4 v9, s[48:51], s68 offen lds
  buffer_load_dwordx4 v10, s[48:51], s68 offen offset:1024 lds
  s_add_u32 m0, s5, 49152
  s_mul_i32 s68, s14, 196608
  s_add_u32 s68, s68, s72
  s_add_u32 s68, s68, 1024
  buffer_load_dwordx4 v9, s[48:51], s68 offen lds
  buffer_load_dwordx4 v10, s[48:51], s68 offen offset:1024 lds
  s_add_u32 m0, s5, 57344
  s_mul_i32 s68, s14, 196608
  s_add_u32 s68, s68, s72
  s_add_u32 s68, s68, 2048
  buffer_load_dwordx4 v9, s[48:51], s68 offen lds
  buffer_load_dwordx4 v10, s[48:51], s68 offen offset:1024 lds
  v_lshrrev_b32 v1, 3, v0
  s_lshl_b32 s6, s4, 4
  v_add_u32 v1, s6, v1
  s_mov_b32 s6, 4096
  v_mul_lo_u32 v1, v1, s6
  v_lshrrev_b32 v2, 4, v0
  v_and_b32 v3, 7, v0
  v_xor_b32 v2, v2, v3
  v_lshl_add_u32 v35, v2, 4, v1
  v_xor_b32 v2, 4, v2
  v_lshl_add_u32 v36, v2, 4, v1
  v_add_u32 v36, 31744, v36
  v_lshrrev_b32 v1, 4, v0
  v_and_b32 v1, 1, v1
  v_and_b32 v2, 7, v0
  v_lshrrev_b32 v3, 2, v2
  v_xor_b32 v3, v3, v1
  v_lshlrev_b32 v3, 2, v3
  v_and_b32 v2, 3, v2
  v_or_b32 v2, v2, v3
  v_lshrrev_b32 v1, 3, v0
  s_lshl_b32 s6, s4, 4
  v_add_u32 v1, s6, v1
  s_mov_b32 s6, 1024
  v_mul_lo_u32 v1, v1, s6
  v_lshl_add_u32 v37, v2, 4, v1
  v_add_u32 v38, 7168, v37
  s_lshl_b32 s23, s8, 18
  s_lshl_b32 s24, s9, 19
  s_add_u32 s24, s24, s5
  s_add_u32 s24, s24, 7340032
  s_lshl_b32 s25, s9, 7
  s_lshl_b32 s26, s4, 16
  s_lshl_b32 s6, s8, 11
  s_add_u32 s26, s26, s6
  s_add_u32 s26, s26, 15728640
  s_mul_i32 s27, s8, 114688
  s_add_u32 s27, s27, s5
  s_add_u32 s27, s27, 11534336
  s_waitcnt vmcnt(8)
  s_barrier
  s_add_u32 s84, s84, 1
  s_and_b32 s84, s84, 7
  s_add_u32 m0, s5, 65536
  s_lshl_b32 s68, s84, 7
  s_add_u32 s68, s68, s69
  buffer_load_dwordx4 v5, s[40:43], s68 offen lds
  s_lshl_b32 s6, s18, 7
  v_add_u32 v1, s6, v28
  ds_read_b128 v[12:15], v1 offset:0
  ds_read_b128 v[20:23], v29 offset:0
  ds_read_b128 v[16:19], v1 offset:64
  ds_read_b128 v[24:27], v32 offset:0
  buffer_load_dwordx4 v6, s[40:43], s68 offen offset:1024 lds
  s_add_u32 s14, s14, 1
  s_and_b32 s14, s14, 7
  s_add_u32 m0, s5, 73728
  s_mul_i32 s68, s14, 196608
  s_add_u32 s68, s68, s72
  buffer_load_dwordx4 v9, s[48:51], s68 offen lds
  buffer_load_dwordx4 v10, s[48:51], s68 offen offset:1024 lds
  s_add_u32 m0, s5, 81920
  s_mul_i32 s68, s14, 196608
  s_add_u32 s68, s68, s72
  s_add_u32 s68, s68, 1024
  buffer_load_dwordx4 v9, s[48:51], s68 offen lds
  buffer_load_dwordx4 v10, s[48:51], s68 offen offset:1024 lds
  s_add_u32 m0, s5, 90112
  s_mul_i32 s68, s14, 196608
  s_add_u32 s68, s68, s72
  s_add_u32 s68, s68, 2048
  buffer_load_dwordx4 v9, s[48:51], s68 offen lds
  buffer_load_dwordx4 v10, s[48:51], s68 offen offset:1024 lds
  s_waitcnt lgkmcnt(0)
  v_mfma_f32_16x16x32_bf16 a[0:3], v[12:15], v[20:23], 0
  v_mfma_f32_16x16x32_bf16 a[0:3], v[16:19], v[24:27], a[0:3]
  s_add_u32 s84, s84, 1
  s_and_b32 s84, s84, 7
  s_add_u32 m0, s5, 98304
  s_lshl_b32 s68, s84, 7
  s_add_u32 s68, s68, s69
  buffer_load_dwordx4 v5, s[40:43], s68 offen lds
  buffer_load_dwordx4 v6, s[40:43], s68 offen offset:1024 lds
  s_waitcnt vmcnt(10)
  s_barrier
  s_add_u32 s14, s14, 1
  s_and_b32 s14, s14, 7
  s_add_u32 m0, s5, 106496
  s_mul_i32 s68, s14, 196608
  s_add_u32 s68, s68, s72
  buffer_load_dwordx4 v9, s[48:51], s68 offen lds
  s_add_u32 s18, s18, 1
  s_and_b32 s18, s18, 7
  s_lshl_b32 s6, s18, 7
  v_add_u32 v1, s6, v28
  ds_read_b128 v[12:15], v1 offset:0
  ds_read_b128 v[20:23], v29 offset:32768
  ds_read_b128 v[16:19], v1 offset:64
  ds_read_b128 v[24:27], v32 offset:32768
  buffer_load_dwordx4 v10, s[48:51], s68 offen offset:1024 lds
  s_add_u32 m0, s5, 114688
  s_mul_i32 s68, s14, 196608
  s_add_u32 s68, s68, s72
  s_add_u32 s68, s68, 1024
  buffer_load_dwordx4 v9, s[48:51], s68 offen lds
  buffer_load_dwordx4 v10, s[48:51], s68 offen offset:1024 lds
  s_add_u32 m0, s5, 122880
  s_mul_i32 s68, s14, 196608
  s_add_u32 s68, s68, s72
  s_add_u32 s68, s68, 2048
  buffer_load_dwordx4 v9, s[48:51], s68 offen lds
  buffer_load_dwordx4 v10, s[48:51], s68 offen offset:1024 lds
  s_add_u32 s84, s84, 1
  s_and_b32 s84, s84, 7
  s_add_u32 m0, s5, 131072
  s_lshl_b32 s68, s84, 7
  s_add_u32 s68, s68, s69
  buffer_load_dwordx4 v5, s[40:43], s68 offen lds
  buffer_load_dwordx4 v6, s[40:43], s68 offen offset:1024 lds
  s_waitcnt lgkmcnt(0)
  v_mfma_f32_16x16x32_bf16 a[0:3], v[12:15], v[20:23], a[0:3]
  v_mfma_f32_16x16x32_bf16 a[0:3], v[16:19], v[24:27], a[0:3]
  s_add_u32 s14, s14, 1
  s_and_b32 s14, s14, 7
  s_add_u32 m0, s5, 139264
  s_mul_i32 s68, s14, 196608
  s_add_u32 s68, s68, s72
  buffer_load_dwordx4 v9, s[48:51], s68 offen lds
  buffer_load_dwordx4 v10, s[48:51], s68 offen offset:1024 lds
  s_waitcnt vmcnt(12)
  s_barrier
  s_add_u32 m0, s5, 0
  s_mul_i32 s68, s14, 196608
  s_add_u32 s68, s68, s72
  s_add_u32 s68, s68, 1024
  buffer_load_dwordx4 v9, s[48:51], s68 offen lds
  s_add_u32 s18, s18, 1
  s_and_b32 s18, s18, 7
  s_lshl_b32 s6, s18, 7
  v_add_u32 v1, s6, v28
  ds_read_b128 v[12:15], v1 offset:0
  ds_read_b128 v[20:23], v30 offset:0
  ds_read_b128 v[16:19], v1 offset:64
  ds_read_b128 v[24:27], v33 offset:0
  buffer_load_dwordx4 v10, s[48:51], s68 offen offset:1024 lds
  s_add_u32 m0, s5, 8192
  s_mul_i32 s68, s14, 196608
  s_add_u32 s68, s68, s72
  s_add_u32 s68, s68, 2048
  buffer_load_dwordx4 v9, s[48:51], s68 offen lds
  buffer_load_dwordx4 v10, s[48:51], s68 offen offset:1024 lds
  s_add_u32 s84, s84, 1
  s_and_b32 s84, s84, 7
  s_add_u32 m0, s5, 16384
  s_lshl_b32 s68, s84, 7
  s_add_u32 s68, s68, s69
  buffer_load_dwordx4 v5, s[40:43], s68 offen lds
  buffer_load_dwordx4 v6, s[40:43], s68 offen offset:1024 lds
  s_add_u32 s14, s14, 1
  s_and_b32 s14, s14, 7
  s_add_u32 m0, s5, 24576
  s_mul_i32 s68, s14, 196608
  s_add_u32 s68, s68, s72
  buffer_load_dwordx4 v9, s[48:51], s68 offen lds
  buffer_load_dwordx4 v10, s[48:51], s68 offen offset:1024 lds
  s_waitcnt lgkmcnt(0)
  v_mfma_f32_16x16x32_bf16 a[0:3], v[12:15], v[20:23], a[0:3]
  v_mfma_f32_16x16x32_bf16 a[0:3], v[16:19], v[24:27], a[0:3]
  s_add_u32 m0, s5, 147456
  s_mul_i32 s68, s14, 196608
  s_add_u32 s68, s68, s72
  s_add_u32 s68, s68, 1024
  buffer_load_dwordx4 v9, s[48:51], s68 offen lds
  buffer_load_dwordx4 v10, s[48:51], s68 offen offset:1024 lds
  s_waitcnt vmcnt(14)
  s_barrier
  s_add_u32 m0, s5, 32768
  s_mul_i32 s68, s14, 196608
  s_add_u32 s68, s68, s72
  s_add_u32 s68, s68, 2048
  buffer_load_dwordx4 v9, s[48:51], s68 offen lds
  s_add_u32 s18, s18, 1
  s_and_b32 s18, s18, 7
  s_lshl_b32 s6, s18, 7
  v_add_u32 v1, s6, v28
  ds_read_b128 v[12:15], v1 offset:0
  ds_read_b128 v[20:23], v30 offset:32768
  ds_read_b128 v[16:19], v1 offset:64
  ds_read_b128 v[24:27], v33 offset:32768
  buffer_load_dwordx4 v10, s[48:51], s68 offen offset:1024 lds
  s_add_u32 s84, s84, 1
  s_and_b32 s84, s84, 7
  s_add_u32 m0, s5, 40960
  s_lshl_b32 s68, s84, 7
  s_add_u32 s68, s68, s69
  buffer_load_dwordx4 v5, s[40:43], s68 offen lds
  buffer_load_dwordx4 v6, s[40:43], s68 offen offset:1024 lds
  s_add_u32 s14, s14, 1
  s_and_b32 s14, s14, 7
  s_add_u32 m0, s5, 49152
  s_mul_i32 s68, s14, 196608
  s_add_u32 s68, s68, s72
  buffer_load_dwordx4 v9, s[48:51], s68 offen lds
  buffer_load_dwordx4 v10, s[48:51], s68 offen offset:1024 lds
  s_add_u32 m0, s5, 57344
  s_mul_i32 s68, s14, 196608
  s_add_u32 s68, s68, s72
  s_add_u32 s68, s68, 1024
  buffer_load_dwordx4 v9, s[48:51], s68 offen lds
  s_waitcnt lgkmcnt(0)
  v_mfma_f32_16x16x32_bf16 a[0:3], v[12:15], v[20:23], a[0:3]
  v_mfma_f32_16x16x32_bf16 a[0:3], v[16:19], v[24:27], a[0:3]
  buffer_load_dwordx4 v10, s[48:51], s68 offen offset:1024 lds
  s_waitcnt vmcnt(14)
  s_barrier
  s_add_u32 m0, s5, 65536
  s_mul_i32 s68, s14, 196608
  s_add_u32 s68, s68, s72
  s_add_u32 s68, s68, 2048
  buffer_load_dwordx4 v9, s[48:51], s68 offen lds
  s_add_u32 s18, s18, 1
  s_and_b32 s18, s18, 7
  s_lshl_b32 s6, s18, 7
  v_add_u32 v1, s6, v28
  ds_read_b128 v[12:15], v1 offset:0
  ds_read_b128 v[20:23], v31 offset:0
  ds_read_b128 v[16:19], v1 offset:64
  ds_read_b128 v[24:27], v34 offset:0
  buffer_load_dwordx4 v10, s[48:51], s68 offen offset:1024 lds
  s_add_u32 s84, s84, 1
  s_and_b32 s84, s84, 7
  s_add_u32 m0, s5, 73728
  s_lshl_b32 s68, s84, 7
  s_add_u32 s68, s68, s69
  buffer_load_dwordx4 v5, s[40:43], s68 offen lds
  buffer_load_dwordx4 v6, s[40:43], s68 offen offset:1024 lds
  s_add_u32 s14, s14, 1
  s_and_b32 s14, s14, 7
  s_add_u32 m0, s5, 81920
  s_mul_i32 s68, s14, 196608
  s_add_u32 s68, s68, s72
  buffer_load_dwordx4 v9, s[48:51], s68 offen lds
  buffer_load_dwordx4 v10, s[48:51], s68 offen offset:1024 lds
  s_add_u32 m0, s5, 90112
  s_mul_i32 s68, s14, 196608
  s_add_u32 s68, s68, s72
  s_add_u32 s68, s68, 1024
  buffer_load_dwordx4 v9, s[48:51], s68 offen lds
  s_waitcnt lgkmcnt(0)
  v_mfma_f32_16x16x32_bf16 a[0:3], v[12:15], v[20:23], a[0:3]
  v_mfma_f32_16x16x32_bf16 a[0:3], v[16:19], v[24:27], a[0:3]
  buffer_load_dwordx4 v10, s[48:51], s68 offen offset:1024 lds
  s_waitcnt vmcnt(14)
  s_barrier
  s_add_u32 m0, s5, 98304
  s_mul_i32 s68, s14, 196608
  s_add_u32 s68, s68, s72
  s_add_u32 s68, s68, 2048
  buffer_load_dwordx4 v9, s[48:51], s68 offen lds
  s_add_u32 s18, s18, 1
  s_and_b32 s18, s18, 7
  s_lshl_b32 s6, s18, 7
  v_add_u32 v1, s6, v28
  ds_read_b128 v[12:15], v1 offset:0
  ds_read_b128 v[20:23], v29 offset:16384
  ds_read_b128 v[16:19], v1 offset:64
  ds_read_b128 v[24:27], v32 offset:16384
  buffer_load_dwordx4 v10, s[48:51], s68 offen offset:1024 lds
  s_waitcnt lgkmcnt(0)
  v_mfma_f32_16x16x32_bf16 a[0:3], v[12:15], v[20:23], a[0:3]
  v_mfma_f32_16x16x32_bf16 a[0:3], v[16:19], v[24:27], a[0:3]
  s_waitcnt vmcnt(8)
  s_barrier
  s_add_u32 s18, s18, 1
  s_and_b32 s18, s18, 7
  s_lshl_b32 s6, s18, 7
  v_add_u32 v1, s6, v28
  ds_read_b128 v[12:15], v1 offset:0
  ds_read_b128 v[20:23], v29 offset:40960
  ds_read_b128 v[16:19], v1 offset:64
  ds_read_b128 v[24:27], v32 offset:40960
  s_waitcnt lgkmcnt(0)
  v_mfma_f32_16x16x32_bf16 a[0:3], v[12:15], v[20:23], a[0:3]
  v_mfma_f32_16x16x32_bf16 a[0:3], v[16:19], v[24:27], a[0:3]
  s_waitcnt vmcnt(0)
  s_barrier
  s_add_u32 s18, s18, 1
  s_and_b32 s18, s18, 7
  s_lshl_b32 s6, s18, 7
  v_add_u32 v1, s6, v28
  ds_read_b128 v[12:15], v1 offset:0
  ds_read_b128 v[20:23], v30 offset:8192
  ds_read_b128 v[16:19], v1 offset:64
  ds_read_b128 v[24:27], v33 offset:8192
  s_waitcnt lgkmcnt(0)
  v_mfma_f32_16x16x32_bf16 a[0:3], v[12:15], v[20:23], a[0:3]
  v_mfma_f32_16x16x32_bf16 a[0:3], v[16:19], v[24:27], a[0:3]
  s_barrier
  s_nop 6
  v_accvgpr_read_b32 v1, a0
  v_mul_f32 v1, 0xbfb8aa3b, v1
  v_exp_f32 v1, v1
  s_nop 0
  v_add_f32 v1, 1.0, v1
  v_rcp_f32 v1, v1
  v_and_b32 v2, 15, v0
  s_lshl_b32 s6, s4, 4
  v_add_u32 v2, s6, v2
  v_lshlrev_b32 v2, 2, v2
  v_add_u32 v2, 156672, v2
  ds_write_b32 v2, v1
  v_and_b32 v154, 31, v0
  v_lshrrev_b32 v155, 5, v0
  v_lshlrev_b32 v1, 2, v155
  v_sub_u32 v1, v154, v1
  v_mov_b32 v3, 0xff800000
  v_cmp_le_i32 vcc, 0, v1
  s_nop 1
  v_cndmask_b32_e64 v104, v3, 0, vcc
  v_cndmask_b32_e64 v88, 0, v3, vcc
  v_cmp_le_i32 vcc, 1, v1
  s_nop 1
  v_cndmask_b32_e64 v105, v3, 0, vcc
  v_cndmask_b32_e64 v89, 0, v3, vcc
  v_cmp_le_i32 vcc, 2, v1
  s_nop 1
  v_cndmask_b32_e64 v106, v3, 0, vcc
  v_cndmask_b32_e64 v90, 0, v3, vcc
  v_cmp_le_i32 vcc, 3, v1
  s_nop 1
  v_cndmask_b32_e64 v107, v3, 0, vcc
  v_cndmask_b32_e64 v91, 0, v3, vcc
  v_cmp_le_i32 vcc, 8, v1
  s_nop 1
  v_cndmask_b32_e64 v108, v3, 0, vcc
  v_cndmask_b32_e64 v92, 0, v3, vcc
  v_cmp_le_i32 vcc, 9, v1
  s_nop 1
  v_cndmask_b32_e64 v109, v3, 0, vcc
  v_cndmask_b32_e64 v93, 0, v3, vcc
  v_cmp_le_i32 vcc, 10, v1
  s_nop 1
  v_cndmask_b32_e64 v110, v3, 0, vcc
  v_cndmask_b32_e64 v94, 0, v3, vcc
  v_cmp_le_i32 vcc, 11, v1
  s_nop 1
  v_cndmask_b32_e64 v111, v3, 0, vcc
  v_cndmask_b32_e64 v95, 0, v3, vcc
  v_cmp_le_i32 vcc, 16, v1
  s_nop 1
  v_cndmask_b32_e64 v112, v3, 0, vcc
  v_cndmask_b32_e64 v96, 0, v3, vcc
  v_cmp_le_i32 vcc, 17, v1
  s_nop 1
  v_cndmask_b32_e64 v113, v3, 0, vcc
  v_cndmask_b32_e64 v97, 0, v3, vcc
  v_cmp_le_i32 vcc, 18, v1
  s_nop 1
  v_cndmask_b32_e64 v114, v3, 0, vcc
  v_cndmask_b32_e64 v98, 0, v3, vcc
  v_cmp_le_i32 vcc, 19, v1
  s_nop 1
  v_cndmask_b32_e64 v115, v3, 0, vcc
  v_cndmask_b32_e64 v99, 0, v3, vcc
  v_cmp_le_i32 vcc, 24, v1
  s_nop 1
  v_cndmask_b32_e64 v116, v3, 0, vcc
  v_cndmask_b32_e64 v100, 0, v3, vcc
  v_cmp_le_i32 vcc, 25, v1
  s_nop 1
  v_cndmask_b32_e64 v117, v3, 0, vcc
  v_cndmask_b32_e64 v101, 0, v3, vcc
  v_cmp_le_i32 vcc, 26, v1
  s_nop 1
  v_cndmask_b32_e64 v118, v3, 0, vcc
  v_cndmask_b32_e64 v102, 0, v3, vcc
  v_cmp_le_i32 vcc, 27, v1
  s_nop 1
  v_cndmask_b32_e64 v119, v3, 0, vcc
  v_cndmask_b32_e64 v103, 0, v3, vcc
  v_mov_b32 v2, 0x3f803f80
  v_accvgpr_write_b32 a60, v2
  v_accvgpr_write_b32 a61, v2
  v_accvgpr_write_b32 a62, v2
  v_accvgpr_write_b32 a63, v2
  v_accvgpr_write_b32 a64, v2
  v_accvgpr_write_b32 a65, v2
  v_accvgpr_write_b32 a66, v2
  v_accvgpr_write_b32 a67, v2
  v_accvgpr_write_b32 a68, v2
  v_accvgpr_write_b32 a69, v2
  v_accvgpr_write_b32 a70, v2
  v_accvgpr_write_b32 a71, v2
  v_accvgpr_write_b32 a72, v2
  v_accvgpr_write_b32 a73, v2
  v_accvgpr_write_b32 a74, v2
  v_accvgpr_write_b32 a75, v2
  v_lshrrev_b32 v1, 3, v154
  v_and_b32 v1, 1, v1
  v_xor_b32 v1, v1, v155
  v_lshlrev_b32 v1, 4, v1
  v_lshl_add_u32 v162, v154, 5, v1
  s_lshl_b32 s6, s4, 10
  s_add_u32 s7, s6, 122880
  v_add_u32 v160, s7, v162
  v_and_b32 v1, 15, v0
  v_lshrrev_b32 v2, 3, v1
  v_xor_b32 v2, v2, v155
  v_lshlrev_b32 v2, 4, v2
  v_lshl_add_u32 v1, v1, 5, v2
  s_add_u32 s7, s6, 139264
  v_add_u32 v161, s7, v1
  v_lshlrev_b32 v1, 5, v154
  v_lshl_add_u32 v163, v155, 4, v1
  s_mov_b32 s34, 0xffff
  s_mov_b32 s35, 0xffff
  s_lshl_b32 s30, s10, 16
  s_lshl_b32 s6, s11, 13
  s_add_u32 s32, s30, s6
  s_sub_u32 s7, s6, 8192
  s_max_i32 s7, s7, 0
  s_add_u32 s31, s30, s7
  s_add_u32 s31, s31, s5
  s_add_u32 s30, s32, s5
  s_lshl_b32 s7, s4, 10
  s_add_u32 s32, s32, s7
  s_sub_u32 s28, 8, s4
  s_cmp_eq_u32 s11, 0
  s_cselect_b32 s28, s28, 0
  s_sub_u32 s29, 4, s4
  s_cmp_eq_u32 s11, 0
  s_cselect_b32 s29, s29, 0
  s_waitcnt lgkmcnt(0)
  s_barrier
  s_barrier
  s_branch L_L_gentry
L_exit:
  s_endpgm
L_code_end:

.section .rodata,"a"
.p2align 6
.amdhsa_kernel gated_mix__sliding_block__mixer_gmlp__prompt_kernel
  .amdhsa_next_free_vgpr 256
  .amdhsa_next_free_sgpr 102
  .amdhsa_accum_offset 180
  .amdhsa_group_segment_fixed_size 0
  .amdhsa_kernarg_size 96
  .amdhsa_user_sgpr_count 2
  .amdhsa_user_sgpr_kernarg_segment_ptr 1
  .amdhsa_system_sgpr_workgroup_id_x 1
.end_amdhsa_kernel
```
